```python
import torch

def _softmax(x, axis=-1):
    return torch.softmax(x, dim=axis)
def _gelu(x):
    return torch.nn.functional.gelu(x, approximate="tanh")
def _silu(x):
    return torch.nn.functional.silu(x)
def _sigmoid(x):
    return torch.sigmoid(x)
def _layernorm(x, axis=-1, eps=1e-5):
    m = x.mean(dim=axis, keepdim=True)
    v = x.var(dim=axis, keepdim=True, unbiased=False)
    return (x - m) / torch.sqrt(v + eps)
def _scatter_add(tgt, idx, src, axis=0):
    return tgt.clone().index_add_(axis, idx, src)
def _segment_sum(src, seg, n):
    out = torch.zeros((n,) + src.shape[1:], dtype=src.dtype)
    return out.index_add_(0, seg, src)
def _pad(x, pw):
    flat = tuple(v for pair in reversed(pw) for v in pair)
    return torch.nn.functional.pad(x, flat)

kernel_name = 'interleave_layers__mha_block__dense_activation_silu__prompt'

def setup_inputs():

    _w = (lambda a: (lambda t: t.to(torch.bfloat16) if t.is_floating_point() else t)(torch.as_tensor(a)))
    def _A_setup():
        B, S, D, H = 1, 2048, 576, 32
        return {
            "x": _w((lambda *s: torch.randn(*s, dtype=torch.bfloat16) * 0.05)(B, S, D)),
            "wqkv": _w((lambda *s: torch.randn(*s, dtype=torch.bfloat16) * 0.05)(D, 3 * D)),
            "wo": _w((lambda *s: torch.randn(*s, dtype=torch.bfloat16) * 0.05)(D, D)),
        }
    _A_in = _A_setup()

    def _B_setup():
        B, S, D, F = 1, 2048, 576, 4608
        return {
            "x": _w((lambda *s: torch.randn(*s, dtype=torch.bfloat16) * 0.05)(B, S, D)),
            "w1": _w((lambda *s: torch.randn(*s, dtype=torch.bfloat16) * 3.2)(D, F) * (D ** -0.5)),
            "w2": _w((lambda *s: torch.randn(*s, dtype=torch.bfloat16) * 0.4)(F, D) * (F ** -0.5)),
        }
    _B_in = _B_setup()

    return {
        "A_x": _A_in["x"],
        "A_wqkv": _A_in["wqkv"],
        "A_wo": _A_in["wo"],
        "B_x": _B_in["x"],
        "B_w1": _B_in["w1"],
        "B_w2": _B_in["w2"],
    }

def reference(A_x, A_wqkv, A_wo, B_x, B_w1, B_w2):
    def _A_ref(x, wqkv, wo):
        B, S, D = x.shape
        H = 32
        Dh = D // H
        qkv = (lambda x, *d: x.permute(*d))((x @ wqkv).reshape(B, S, 3, H, Dh), 2, 0, 3, 1, 4)
        q, k, v = qkv[0], qkv[1], qkv[2]
        scores = torch.einsum("bhqd,bhkd->bhqk", q, k) * (Dh ** -0.5)
        p = _softmax(scores, axis=-1)
        o = torch.einsum("bhqk,bhkd->bhqd", p, v)
        return (lambda x, *d: x.permute(*d))(o, 0, 2, 1, 3).reshape(B, S, D) @ wo

    def _B_ref(x, w1, w2):
        h = torch.einsum("bsd,df->bsf", x, w1)
        h = _silu(h)
        out = torch.einsum("bsf,fd->bsd", h, w2)
        return out

    x = A_x
    x = x + _A_ref(_layernorm(x, axis=-1), A_wqkv, A_wo)
    x = x + _B_ref(_layernorm(x, axis=-1), B_w1, B_w2)
    x = x + _A_ref(_layernorm(x, axis=-1), A_wqkv, A_wo)
    x = x + _B_ref(_layernorm(x, axis=-1), B_w1, B_w2)
    return x
```

```asm
; @launch kernel=k0_prep_kernel grid=(160,1,1) block=(256,1,1) lds=40960
; @launch kernel=k1_qkv0_kernel grid=(256,1,1) block=(256,1,1) lds=73728
; @launch kernel=k2_attn0_kernel grid=(256,1,1) block=(768,1,1) lds=163840
; @launch kernel=k3_wo0_kernel grid=(192,1,1) block=(192,1,1) lds=73728
; @launch kernel=k45_mlp0_kernel grid=(256,1,1) block=(256,1,1) lds=163840
; @launch kernel=k6_red0_kernel grid=(256,1,1) block=(576,1,1) lds=1024
; @launch kernel=k1_qkv1_kernel grid=(256,1,1) block=(256,1,1) lds=73728
; @launch kernel=k2_attn1_kernel grid=(256,1,1) block=(768,1,1) lds=163840
; @launch kernel=k3_wo1_kernel grid=(192,1,1) block=(192,1,1) lds=73728
; @launch kernel=k45_mlp1_kernel grid=(256,1,1) block=(256,1,1) lds=163840
; @launch kernel=k6_red1_kernel grid=(256,1,1) block=(576,1,1) lds=1024
.amdgcn_target "amdgcn-amd-amdhsa--gfx950"
.text
.globl k0_prep_kernel
.p2align 8
.type k0_prep_kernel,@function
k0_prep_kernel:
  s_cmp_ge_u32 s2, 160
  s_cbranch_scc1 k0_end
  s_getpc_b64 s[50:51]
  v_lshrrev_b32 v100, 2, v0
  v_lshlrev_b32 v100, 6, v100
  global_load_dword v101, v100, s[50:51]
  global_load_dword v102, v100, s[50:51] offset:4092
  s_load_dwordx2 s[4:5], s[0:1], 64
  s_load_dwordx2 s[12:13], s[0:1], 0
  s_load_dwordx2 s[16:17], s[0:1], 8
  v_lshrrev_b32 v1, 6, v0
  v_and_b32 v0, 63, v0
  s_nop 0
  v_readfirstlane_b32 s3, v1
  s_waitcnt lgkmcnt(0)
  s_mov_b32 s8, s4
  s_mov_b32 s9, s5
  s_mov_b32 s10, 0x10000000
  s_mov_b32 s11, 0x20000
  v_lshlrev_b32 v1, 4, v0
  v_and_b32 v2, 31, v0
  v_lshrrev_b32 v3, 5, v0
  v_mov_b32 v4, 0x3f803f80
  s_cmp_ge_u32 s2, 128
  s_cbranch_scc1 k0_pf
  s_cmp_ge_u32 s2, 64
  s_cbranch_scc1 k0_qkv
k0_x:
  s_mov_b32 s36, s12
  s_mov_b32 s37, s13
  s_mov_b32 s38, 0x240000
  s_mov_b32 s39, 0x20000
  s_lshl_b32 s14, s2, 5
  v_add_u32 v5, s14, v2
  s_movk_i32 s15, 1152
  v_mul_lo_u32 v5, v5, s15
  v_lshlrev_b32 v6, 3, v3
  v_add_u32 v5, v5, v6
  s_lshl_b32 s18, s3, 5
  buffer_load_dwordx2 v[16:17], v5, s[36:39], s18 offen offset:0
  buffer_load_dwordx2 v[18:19], v5, s[36:39], s18 offen offset:16
  buffer_load_dwordx2 v[20:21], v5, s[36:39], s18 offen offset:128
  buffer_load_dwordx2 v[22:23], v5, s[36:39], s18 offen offset:144
  buffer_load_dwordx2 v[24:25], v5, s[36:39], s18 offen offset:256
  buffer_load_dwordx2 v[26:27], v5, s[36:39], s18 offen offset:272
  buffer_load_dwordx2 v[28:29], v5, s[36:39], s18 offen offset:384
  buffer_load_dwordx2 v[30:31], v5, s[36:39], s18 offen offset:400
  buffer_load_dwordx2 v[32:33], v5, s[36:39], s18 offen offset:512
  buffer_load_dwordx2 v[34:35], v5, s[36:39], s18 offen offset:528
  buffer_load_dwordx2 v[36:37], v5, s[36:39], s18 offen offset:640
  buffer_load_dwordx2 v[38:39], v5, s[36:39], s18 offen offset:656
  buffer_load_dwordx2 v[40:41], v5, s[36:39], s18 offen offset:768
  buffer_load_dwordx2 v[42:43], v5, s[36:39], s18 offen offset:784
  buffer_load_dwordx2 v[44:45], v5, s[36:39], s18 offen offset:896
  buffer_load_dwordx2 v[46:47], v5, s[36:39], s18 offen offset:912
  buffer_load_dwordx2 v[48:49], v5, s[36:39], s18 offen offset:1024
  buffer_load_dwordx2 v[50:51], v5, s[36:39], s18 offen offset:1040
  s_mul_i32 s22, s2, 36864
  s_lshl_b32 s23, s3, 10
  s_add_u32 s22, s22, s23
  s_waitcnt vmcnt(0)
  v_lshrrev_b32 v6, 4, v2
  v_mul_u32_u24 v6, 18432, v6
  v_and_b32 v7, 15, v2
  v_lshlrev_b32 v8, 4, v3
  v_add_u32 v7, v7, v8
  v_lshlrev_b32 v7, 4, v7
  v_add_u32 v6, v6, v7
  s_mul_i32 s26, s2, 36864
  s_lshr_b32 s27, s3, 1
  s_lshl_b32 s27, s27, 10
  s_add_u32 s26, s26, s27
  s_and_b32 s27, s3, 1
  s_lshl_b32 s27, s27, 3
  s_add_u32 s26, s26, s27
  s_add_u32 s26, s26, 37748736
  v_mov_b32 v7, 0
  v_mov_b32 v8, 0
  v_dot2c_f32_bf16 v7, v16, v4
  v_dot2c_f32_bf16 v8, v16, v16
  v_dot2c_f32_bf16 v7, v17, v4
  v_dot2c_f32_bf16 v8, v17, v17
  v_dot2c_f32_bf16 v7, v18, v4
  v_dot2c_f32_bf16 v8, v18, v18
  v_dot2c_f32_bf16 v7, v19, v4
  v_dot2c_f32_bf16 v8, v19, v19
  v_dot2c_f32_bf16 v7, v20, v4
  v_dot2c_f32_bf16 v8, v20, v20
  v_dot2c_f32_bf16 v7, v21, v4
  v_dot2c_f32_bf16 v8, v21, v21
  v_dot2c_f32_bf16 v7, v22, v4
  v_dot2c_f32_bf16 v8, v22, v22
  v_dot2c_f32_bf16 v7, v23, v4
  v_dot2c_f32_bf16 v8, v23, v23
  v_dot2c_f32_bf16 v7, v24, v4
  v_dot2c_f32_bf16 v8, v24, v24
  v_dot2c_f32_bf16 v7, v25, v4
  v_dot2c_f32_bf16 v8, v25, v25
  v_dot2c_f32_bf16 v7, v26, v4
  v_dot2c_f32_bf16 v8, v26, v26
  v_dot2c_f32_bf16 v7, v27, v4
  v_dot2c_f32_bf16 v8, v27, v27
  v_dot2c_f32_bf16 v7, v28, v4
  v_dot2c_f32_bf16 v8, v28, v28
  v_dot2c_f32_bf16 v7, v29, v4
  v_dot2c_f32_bf16 v8, v29, v29
  v_dot2c_f32_bf16 v7, v30, v4
  v_dot2c_f32_bf16 v8, v30, v30
  v_dot2c_f32_bf16 v7, v31, v4
  v_dot2c_f32_bf16 v8, v31, v31
  v_dot2c_f32_bf16 v7, v32, v4
  v_dot2c_f32_bf16 v8, v32, v32
  v_dot2c_f32_bf16 v7, v33, v4
  v_dot2c_f32_bf16 v8, v33, v33
  v_dot2c_f32_bf16 v7, v34, v4
  v_dot2c_f32_bf16 v8, v34, v34
  v_dot2c_f32_bf16 v7, v35, v4
  v_dot2c_f32_bf16 v8, v35, v35
  v_dot2c_f32_bf16 v7, v36, v4
  v_dot2c_f32_bf16 v8, v36, v36
  v_dot2c_f32_bf16 v7, v37, v4
  v_dot2c_f32_bf16 v8, v37, v37
  v_dot2c_f32_bf16 v7, v38, v4
  v_dot2c_f32_bf16 v8, v38, v38
  v_dot2c_f32_bf16 v7, v39, v4
  v_dot2c_f32_bf16 v8, v39, v39
  v_dot2c_f32_bf16 v7, v40, v4
  v_dot2c_f32_bf16 v8, v40, v40
  v_dot2c_f32_bf16 v7, v41, v4
  v_dot2c_f32_bf16 v8, v41, v41
  v_dot2c_f32_bf16 v7, v42, v4
  v_dot2c_f32_bf16 v8, v42, v42
  v_dot2c_f32_bf16 v7, v43, v4
  v_dot2c_f32_bf16 v8, v43, v43
  v_dot2c_f32_bf16 v7, v44, v4
  v_dot2c_f32_bf16 v8, v44, v44
  v_dot2c_f32_bf16 v7, v45, v4
  v_dot2c_f32_bf16 v8, v45, v45
  v_dot2c_f32_bf16 v7, v46, v4
  v_dot2c_f32_bf16 v8, v46, v46
  v_dot2c_f32_bf16 v7, v47, v4
  v_dot2c_f32_bf16 v8, v47, v47
  v_dot2c_f32_bf16 v7, v48, v4
  v_dot2c_f32_bf16 v8, v48, v48
  v_dot2c_f32_bf16 v7, v49, v4
  v_dot2c_f32_bf16 v8, v49, v49
  v_dot2c_f32_bf16 v7, v50, v4
  v_dot2c_f32_bf16 v8, v50, v50
  v_dot2c_f32_bf16 v7, v51, v4
  v_dot2c_f32_bf16 v8, v51, v51
  s_nop 2
  v_mov_b32 v9, v7
  s_nop 1
  v_permlane32_swap_b32 v7, v9
  s_nop 1
  v_add_f32 v7, v7, v9
  v_mov_b32 v9, v8
  s_nop 1
  v_permlane32_swap_b32 v8, v9
  s_nop 1
  v_add_f32 v8, v8, v9
  v_lshlrev_b32 v9, 3, v2
  s_lshl_b32 s23, s3, 8
  v_add_u32 v10, s23, v9
  v_mov_b32 v12, v7
  v_mov_b32 v13, v8
  ds_write_b64 v10, v[12:13]
  buffer_store_dwordx2 v[16:17], v6, s[8:11], s26 offen
  buffer_store_dwordx2 v[18:19], v6, s[8:11], s26 offen offset:512
  s_add_u32 s26, s26, 2048
  buffer_store_dwordx2 v[20:21], v6, s[8:11], s26 offen
  buffer_store_dwordx2 v[22:23], v6, s[8:11], s26 offen offset:512
  s_add_u32 s26, s26, 2048
  buffer_store_dwordx2 v[24:25], v6, s[8:11], s26 offen
  buffer_store_dwordx2 v[26:27], v6, s[8:11], s26 offen offset:512
  s_add_u32 s26, s26, 2048
  buffer_store_dwordx2 v[28:29], v6, s[8:11], s26 offen
  buffer_store_dwordx2 v[30:31], v6, s[8:11], s26 offen offset:512
  s_add_u32 s26, s26, 2048
  buffer_store_dwordx2 v[32:33], v6, s[8:11], s26 offen
  buffer_store_dwordx2 v[34:35], v6, s[8:11], s26 offen offset:512
  s_add_u32 s26, s26, 2048
  buffer_store_dwordx2 v[36:37], v6, s[8:11], s26 offen
  buffer_store_dwordx2 v[38:39], v6, s[8:11], s26 offen offset:512
  s_add_u32 s26, s26, 2048
  buffer_store_dwordx2 v[40:41], v6, s[8:11], s26 offen
  buffer_store_dwordx2 v[42:43], v6, s[8:11], s26 offen offset:512
  s_add_u32 s26, s26, 2048
  buffer_store_dwordx2 v[44:45], v6, s[8:11], s26 offen
  buffer_store_dwordx2 v[46:47], v6, s[8:11], s26 offen offset:512
  s_add_u32 s26, s26, 2048
  buffer_store_dwordx2 v[48:49], v6, s[8:11], s26 offen
  buffer_store_dwordx2 v[50:51], v6, s[8:11], s26 offen offset:512
  s_add_u32 s26, s26, 2048
  s_waitcnt lgkmcnt(0)
  s_barrier
  ds_read_b64 v[12:13], v9
  ds_read_b64 v[14:15], v9 offset:256
  ds_read_b64 v[124:125], v9 offset:512
  ds_read_b64 v[126:127], v9 offset:768
  s_waitcnt lgkmcnt(0)
  v_add_f32 v12, v12, v14
  v_add_f32 v13, v13, v15
  v_add_f32 v124, v124, v126
  v_add_f32 v125, v125, v127
  v_add_f32 v12, v12, v124
  v_add_f32 v13, v13, v125
  v_mul_f32 v11, 0x3ae38e39, v12
  v_mul_f32 v13, 0x3ae38e39, v13
  v_fma_f32 v13, -v11, v11, v13
  v_max_f32 v13, 0, v13
  v_add_f32 v13, 0x3727c5ac, v13
  v_rsq_f32 v13, v13
  v_lshlrev_b32 v52, 16, v16
  v_and_b32 v53, 0xffff0000, v16
  v_sub_f32 v52, v52, v11
  v_sub_f32 v53, v53, v11
  v_lshlrev_b32 v54, 16, v17
  v_and_b32 v55, 0xffff0000, v17
  v_sub_f32 v54, v54, v11
  v_sub_f32 v55, v55, v11
  v_lshlrev_b32 v56, 16, v18
  v_and_b32 v57, 0xffff0000, v18
  v_sub_f32 v56, v56, v11
  v_sub_f32 v57, v57, v11
  v_lshlrev_b32 v58, 16, v19
  v_and_b32 v59, 0xffff0000, v19
  v_sub_f32 v58, v58, v11
  v_sub_f32 v59, v59, v11
  v_lshlrev_b32 v60, 16, v20
  v_and_b32 v61, 0xffff0000, v20
  v_sub_f32 v60, v60, v11
  v_sub_f32 v61, v61, v11
  v_lshlrev_b32 v62, 16, v21
  v_and_b32 v63, 0xffff0000, v21
  v_sub_f32 v62, v62, v11
  v_sub_f32 v63, v63, v11
  v_lshlrev_b32 v64, 16, v22
  v_and_b32 v65, 0xffff0000, v22
  v_sub_f32 v64, v64, v11
  v_sub_f32 v65, v65, v11
  v_lshlrev_b32 v66, 16, v23
  v_and_b32 v67, 0xffff0000, v23
  v_sub_f32 v66, v66, v11
  v_sub_f32 v67, v67, v11
  v_lshlrev_b32 v68, 16, v24
  v_and_b32 v69, 0xffff0000, v24
  v_sub_f32 v68, v68, v11
  v_sub_f32 v69, v69, v11
  v_lshlrev_b32 v70, 16, v25
  v_and_b32 v71, 0xffff0000, v25
  v_sub_f32 v70, v70, v11
  v_sub_f32 v71, v71, v11
  v_lshlrev_b32 v72, 16, v26
  v_and_b32 v73, 0xffff0000, v26
  v_sub_f32 v72, v72, v11
  v_sub_f32 v73, v73, v11
  v_lshlrev_b32 v74, 16, v27
  v_and_b32 v75, 0xffff0000, v27
  v_sub_f32 v74, v74, v11
  v_sub_f32 v75, v75, v11
  v_lshlrev_b32 v76, 16, v28
  v_and_b32 v77, 0xffff0000, v28
  v_sub_f32 v76, v76, v11
  v_sub_f32 v77, v77, v11
  v_lshlrev_b32 v78, 16, v29
  v_and_b32 v79, 0xffff0000, v29
  v_sub_f32 v78, v78, v11
  v_sub_f32 v79, v79, v11
  v_lshlrev_b32 v80, 16, v30
  v_and_b32 v81, 0xffff0000, v30
  v_sub_f32 v80, v80, v11
  v_sub_f32 v81, v81, v11
  v_lshlrev_b32 v82, 16, v31
  v_and_b32 v83, 0xffff0000, v31
  v_sub_f32 v82, v82, v11
  v_sub_f32 v83, v83, v11
  v_lshlrev_b32 v84, 16, v32
  v_and_b32 v85, 0xffff0000, v32
  v_sub_f32 v84, v84, v11
  v_sub_f32 v85, v85, v11
  v_lshlrev_b32 v86, 16, v33
  v_and_b32 v87, 0xffff0000, v33
  v_sub_f32 v86, v86, v11
  v_sub_f32 v87, v87, v11
  v_lshlrev_b32 v88, 16, v34
  v_and_b32 v89, 0xffff0000, v34
  v_sub_f32 v88, v88, v11
  v_sub_f32 v89, v89, v11
  v_lshlrev_b32 v90, 16, v35
  v_and_b32 v91, 0xffff0000, v35
  v_sub_f32 v90, v90, v11
  v_sub_f32 v91, v91, v11
  v_lshlrev_b32 v92, 16, v36
  v_and_b32 v93, 0xffff0000, v36
  v_sub_f32 v92, v92, v11
  v_sub_f32 v93, v93, v11
  v_lshlrev_b32 v94, 16, v37
  v_and_b32 v95, 0xffff0000, v37
  v_sub_f32 v94, v94, v11
  v_sub_f32 v95, v95, v11
  v_lshlrev_b32 v96, 16, v38
  v_and_b32 v97, 0xffff0000, v38
  v_sub_f32 v96, v96, v11
  v_sub_f32 v97, v97, v11
  v_lshlrev_b32 v98, 16, v39
  v_and_b32 v99, 0xffff0000, v39
  v_sub_f32 v98, v98, v11
  v_sub_f32 v99, v99, v11
  v_lshlrev_b32 v100, 16, v40
  v_and_b32 v101, 0xffff0000, v40
  v_sub_f32 v100, v100, v11
  v_sub_f32 v101, v101, v11
  v_lshlrev_b32 v102, 16, v41
  v_and_b32 v103, 0xffff0000, v41
  v_sub_f32 v102, v102, v11
  v_sub_f32 v103, v103, v11
  v_lshlrev_b32 v104, 16, v42
  v_and_b32 v105, 0xffff0000, v42
  v_sub_f32 v104, v104, v11
  v_sub_f32 v105, v105, v11
  v_lshlrev_b32 v106, 16, v43
  v_and_b32 v107, 0xffff0000, v43
  v_sub_f32 v106, v106, v11
  v_sub_f32 v107, v107, v11
  v_lshlrev_b32 v108, 16, v44
  v_and_b32 v109, 0xffff0000, v44
  v_sub_f32 v108, v108, v11
  v_sub_f32 v109, v109, v11
  v_lshlrev_b32 v110, 16, v45
  v_and_b32 v111, 0xffff0000, v45
  v_sub_f32 v110, v110, v11
  v_sub_f32 v111, v111, v11
  v_lshlrev_b32 v112, 16, v46
  v_and_b32 v113, 0xffff0000, v46
  v_sub_f32 v112, v112, v11
  v_sub_f32 v113, v113, v11
  v_lshlrev_b32 v114, 16, v47
  v_and_b32 v115, 0xffff0000, v47
  v_sub_f32 v114, v114, v11
  v_sub_f32 v115, v115, v11
  v_lshlrev_b32 v116, 16, v48
  v_and_b32 v117, 0xffff0000, v48
  v_sub_f32 v116, v116, v11
  v_sub_f32 v117, v117, v11
  v_lshlrev_b32 v118, 16, v49
  v_and_b32 v119, 0xffff0000, v49
  v_sub_f32 v118, v118, v11
  v_sub_f32 v119, v119, v11
  v_lshlrev_b32 v120, 16, v50
  v_and_b32 v121, 0xffff0000, v50
  v_sub_f32 v120, v120, v11
  v_sub_f32 v121, v121, v11
  v_lshlrev_b32 v122, 16, v51
  v_and_b32 v123, 0xffff0000, v51
  v_sub_f32 v122, v122, v11
  v_sub_f32 v123, v123, v11
  v_mul_f32 v52, v52, v13
  v_mul_f32 v53, v53, v13
  v_cvt_pk_bf16_f32 v16, v52, v53
  v_mul_f32 v54, v54, v13
  v_mul_f32 v55, v55, v13
  v_cvt_pk_bf16_f32 v17, v54, v55
  v_mul_f32 v56, v56, v13
  v_mul_f32 v57, v57, v13
  v_cvt_pk_bf16_f32 v18, v56, v57
  v_mul_f32 v58, v58, v13
  v_mul_f32 v59, v59, v13
  v_cvt_pk_bf16_f32 v19, v58, v59
  v_mul_f32 v60, v60, v13
  v_mul_f32 v61, v61, v13
  v_cvt_pk_bf16_f32 v20, v60, v61
  v_mul_f32 v62, v62, v13
  v_mul_f32 v63, v63, v13
  v_cvt_pk_bf16_f32 v21, v62, v63
  v_mul_f32 v64, v64, v13
  v_mul_f32 v65, v65, v13
  v_cvt_pk_bf16_f32 v22, v64, v65
  v_mul_f32 v66, v66, v13
  v_mul_f32 v67, v67, v13
  v_cvt_pk_bf16_f32 v23, v66, v67
  v_mul_f32 v68, v68, v13
  v_mul_f32 v69, v69, v13
  v_cvt_pk_bf16_f32 v24, v68, v69
  v_mul_f32 v70, v70, v13
  v_mul_f32 v71, v71, v13
  v_cvt_pk_bf16_f32 v25, v70, v71
  v_mul_f32 v72, v72, v13
  v_mul_f32 v73, v73, v13
  v_cvt_pk_bf16_f32 v26, v72, v73
  v_mul_f32 v74, v74, v13
  v_mul_f32 v75, v75, v13
  v_cvt_pk_bf16_f32 v27, v74, v75
  v_mul_f32 v76, v76, v13
  v_mul_f32 v77, v77, v13
  v_cvt_pk_bf16_f32 v28, v76, v77
  v_mul_f32 v78, v78, v13
  v_mul_f32 v79, v79, v13
  v_cvt_pk_bf16_f32 v29, v78, v79
  v_mul_f32 v80, v80, v13
  v_mul_f32 v81, v81, v13
  v_cvt_pk_bf16_f32 v30, v80, v81
  v_mul_f32 v82, v82, v13
  v_mul_f32 v83, v83, v13
  v_cvt_pk_bf16_f32 v31, v82, v83
  v_mul_f32 v84, v84, v13
  v_mul_f32 v85, v85, v13
  v_cvt_pk_bf16_f32 v32, v84, v85
  v_mul_f32 v86, v86, v13
  v_mul_f32 v87, v87, v13
  v_cvt_pk_bf16_f32 v33, v86, v87
  v_mul_f32 v88, v88, v13
  v_mul_f32 v89, v89, v13
  v_cvt_pk_bf16_f32 v34, v88, v89
  v_mul_f32 v90, v90, v13
  v_mul_f32 v91, v91, v13
  v_cvt_pk_bf16_f32 v35, v90, v91
  v_mul_f32 v92, v92, v13
  v_mul_f32 v93, v93, v13
  v_cvt_pk_bf16_f32 v36, v92, v93
  v_mul_f32 v94, v94, v13
  v_mul_f32 v95, v95, v13
  v_cvt_pk_bf16_f32 v37, v94, v95
  v_mul_f32 v96, v96, v13
  v_mul_f32 v97, v97, v13
  v_cvt_pk_bf16_f32 v38, v96, v97
  v_mul_f32 v98, v98, v13
  v_mul_f32 v99, v99, v13
  v_cvt_pk_bf16_f32 v39, v98, v99
  v_mul_f32 v100, v100, v13
  v_mul_f32 v101, v101, v13
  v_cvt_pk_bf16_f32 v40, v100, v101
  v_mul_f32 v102, v102, v13
  v_mul_f32 v103, v103, v13
  v_cvt_pk_bf16_f32 v41, v102, v103
  v_mul_f32 v104, v104, v13
  v_mul_f32 v105, v105, v13
  v_cvt_pk_bf16_f32 v42, v104, v105
  v_mul_f32 v106, v106, v13
  v_mul_f32 v107, v107, v13
  v_cvt_pk_bf16_f32 v43, v106, v107
  v_mul_f32 v108, v108, v13
  v_mul_f32 v109, v109, v13
  v_cvt_pk_bf16_f32 v44, v108, v109
  v_mul_f32 v110, v110, v13
  v_mul_f32 v111, v111, v13
  v_cvt_pk_bf16_f32 v45, v110, v111
  v_mul_f32 v112, v112, v13
  v_mul_f32 v113, v113, v13
  v_cvt_pk_bf16_f32 v46, v112, v113
  v_mul_f32 v114, v114, v13
  v_mul_f32 v115, v115, v13
  v_cvt_pk_bf16_f32 v47, v114, v115
  v_mul_f32 v116, v116, v13
  v_mul_f32 v117, v117, v13
  v_cvt_pk_bf16_f32 v48, v116, v117
  v_mul_f32 v118, v118, v13
  v_mul_f32 v119, v119, v13
  v_cvt_pk_bf16_f32 v49, v118, v119
  v_mul_f32 v120, v120, v13
  v_mul_f32 v121, v121, v13
  v_cvt_pk_bf16_f32 v50, v120, v121
  v_mul_f32 v122, v122, v13
  v_mul_f32 v123, v123, v13
  v_cvt_pk_bf16_f32 v51, v122, v123
  s_add_u32 s19, s22, 40894464
  buffer_store_dwordx4 v[16:19], v1, s[8:11], s19 offen
  s_add_u32 s19, s22, 40898560
  buffer_store_dwordx4 v[20:23], v1, s[8:11], s19 offen
  s_add_u32 s19, s22, 40902656
  buffer_store_dwordx4 v[24:27], v1, s[8:11], s19 offen
  s_add_u32 s19, s22, 40906752
  buffer_store_dwordx4 v[28:31], v1, s[8:11], s19 offen
  s_add_u32 s19, s22, 40910848
  buffer_store_dwordx4 v[32:35], v1, s[8:11], s19 offen
  s_add_u32 s19, s22, 40914944
  buffer_store_dwordx4 v[36:39], v1, s[8:11], s19 offen
  s_add_u32 s19, s22, 40919040
  buffer_store_dwordx4 v[40:43], v1, s[8:11], s19 offen
  s_add_u32 s19, s22, 40923136
  buffer_store_dwordx4 v[44:47], v1, s[8:11], s19 offen
  s_add_u32 s19, s22, 40927232
  buffer_store_dwordx4 v[48:51], v1, s[8:11], s19 offen
  s_branch k0_end
k0_pf:
  s_cmp_lg_u32 s2, 128
  s_cbranch_scc1 k0_nz
  v_mov_b32 v40, 0
  v_mov_b32 v41, 0
  v_mov_b32 v42, 0
  v_mov_b32 v43, 0
  s_add_u32 s14, s3, 0
  s_min_u32 s14, s14, 17
  s_lshl_b32 s14, s14, 10
  s_add_u32 s14, s14, 15728640
  buffer_store_dwordx4 v[40:43], v1, s[8:11], s14 offen
  s_add_u32 s14, s3, 4
  s_min_u32 s14, s14, 17
  s_lshl_b32 s14, s14, 10
  s_add_u32 s14, s14, 15728640
  buffer_store_dwordx4 v[40:43], v1, s[8:11], s14 offen
  s_add_u32 s14, s3, 8
  s_min_u32 s14, s14, 17
  s_lshl_b32 s14, s14, 10
  s_add_u32 s14, s14, 15728640
  buffer_store_dwordx4 v[40:43], v1, s[8:11], s14 offen
  s_add_u32 s14, s3, 12
  s_min_u32 s14, s14, 17
  s_lshl_b32 s14, s14, 10
  s_add_u32 s14, s14, 15728640
  buffer_store_dwordx4 v[40:43], v1, s[8:11], s14 offen
  s_add_u32 s14, s3, 16
  s_min_u32 s14, s14, 17
  s_lshl_b32 s14, s14, 10
  s_add_u32 s14, s14, 15728640
  buffer_store_dwordx4 v[40:43], v1, s[8:11], s14 offen
k0_nz:
  s_getpc_b64 s[50:51]
k0_pc:
  s_add_u32 s50, s50, k1_qkv0_kernel-k0_pc
  s_addc_u32 s51, s51, (k1_qkv0_kernel-k0_pc)>>32
  s_sub_u32 s52, s2, 128
  s_lshr_b32 s52, s52, 3
  s_lshl_b32 s52, s52, 2
  s_add_u32 s52, s52, s3
  s_lshl_b32 s52, s52, 10
  s_add_u32 s53, s52, 0
  s_min_u32 s53, s53, k6_red_codeend-k1_qkv0_kernel-1024
  v_add_u32 v5, s53, v1
  global_load_dwordx4 v[8:11], v5, s[50:51]
  s_add_u32 s53, s52, 16384
  s_min_u32 s53, s53, k6_red_codeend-k1_qkv0_kernel-1024
  v_add_u32 v5, s53, v1
  global_load_dwordx4 v[12:15], v5, s[50:51]
  s_add_u32 s53, s52, 32768
  s_min_u32 s53, s53, k6_red_codeend-k1_qkv0_kernel-1024
  v_add_u32 v5, s53, v1
  global_load_dwordx4 v[16:19], v5, s[50:51]
  s_add_u32 s53, s52, 49152
  s_min_u32 s53, s53, k6_red_codeend-k1_qkv0_kernel-1024
  v_add_u32 v5, s53, v1
  global_load_dwordx4 v[20:23], v5, s[50:51]
  s_branch k0_end
k0_qkv:
  s_mov_b32 s36, s16
  s_mov_b32 s37, s17
  s_mov_b32 s38, 0x1e6000
  s_mov_b32 s39, 0x20000
  s_sub_u32 s14, s2, 64
  s_lshr_b32 s15, s14, 3
  s_and_b32 s14, s14, 7
  s_mul_i32 s30, s3, 9216
  v_lshrrev_b32 v5, 2, v0
  v_and_b32 v6, 3, v0
  s_lshl_b32 s18, s15, 2
  s_add_u32 s19, s18, s14
  s_mul_i32 s19, s19, 18
  v_lshlrev_b32 v10, 3, v6
  v_add_u32 v10, s19, v10
  v_add_u32 v11, 560, v10
  v_cmp_gt_u32 vcc, 2, v6
  s_nop 1
  v_cndmask_b32 v10, v11, v10, vcc
  s_sub_u32 s19, s14, 5
  s_lshl_b32 s19, s19, 5
  v_lshlrev_b32 v12, 3, v6
  v_add_u32 v12, s19, v12
  s_mul_i32 s22, s15, 72
  s_add_u32 s22, s22, 1152
  v_add_u32 v13, s22, v12
  v_mov_b32 v16, 0x20000000
  v_cmp_gt_u32 vcc, 72, v12
  s_nop 1
  v_cndmask_b32 v13, v16, v13, vcc
  s_cmp_lt_u32 s14, 4
  s_cselect_b64 vcc, -1, 0
  v_cndmask_b32 v10, v13, v10, vcc
  v_lshlrev_b32 v10, 1, v10
  v_mul_u32_u24 v11, 3456, v5
  v_add_u32 v10, v10, v11
  v_and_b32 v12, 15, v0
  v_lshrrev_b32 v13, 1, v12
  v_and_b32 v13, 1, v13
  v_mul_u32_u24 v13, 576, v13
  v_and_b32 v14, 1, v12
  v_lshrrev_b32 v15, 2, v12
  v_lshlrev_b32 v15, 1, v15
  v_add_u32 v14, v14, v15
  v_add_u32 v14, s18, v14
  v_mul_u32_u24 v14, 18, v14
  v_add_u32 v13, v13, v14
  v_add_u32 v13, 16, v13
  v_cmp_gt_u32 vcc, 8, v12
  s_nop 1
  v_cndmask_b32 v13, v16, v13, vcc
  v_lshlrev_b32 v13, 1, v13
  v_lshrrev_b32 v14, 4, v0
  v_mul_u32_u24 v14, 3456, v14
  v_add_u32 v13, v13, v14
  s_mul_i32 s18, s3, 55296
  s_mov_b32 s23, 9
  s_mov_b32 s26, s30
  s_cmp_eq_u32 s14, 4
  s_cbranch_scc1 k0_qkv4
k0_qkvl:
  s_mov_b32 m0, s26
  s_add_u32 s26, s26, 1024
  buffer_load_dwordx4 v10, s[36:39], s18 offen lds
  s_add_u32 s18, s18, 221184
  s_sub_u32 s23, s23, 1
  s_cmp_lg_u32 s23, 0
  s_cbranch_scc1 k0_qkvl
  s_branch k0_qkvp
k0_qkv4:
  s_add_u32 m0, s26, 0
  s_add_u32 s19, s18, 0
  buffer_load_dword v13, s[36:39], s19 offen lds
  s_add_u32 m0, s26, 256
  s_add_u32 s19, s18, 13824
  buffer_load_dword v13, s[36:39], s19 offen lds
  s_add_u32 m0, s26, 512
  s_add_u32 s19, s18, 27648
  buffer_load_dword v13, s[36:39], s19 offen lds
  s_add_u32 m0, s26, 768
  s_add_u32 s19, s18, 41472
  buffer_load_dword v13, s[36:39], s19 offen lds
  s_add_u32 s26, s26, 1024
  s_add_u32 s18, s18, 221184
  s_sub_u32 s23, s23, 1
  s_cmp_lg_u32 s23, 0
  s_cbranch_scc1 k0_qkv4
k0_qkvp:
  v_lshrrev_b32 v8, 2, v0
  v_and_b32 v8, 3, v8
  v_lshlrev_b32 v9, 2, v3
  v_add_u32 v8, v8, v9
  v_lshlrev_b32 v8, 6, v8
  v_lshrrev_b32 v9, 4, v0
  v_and_b32 v9, 1, v9
  v_lshlrev_b32 v9, 5, v9
  v_add_u32 v8, v8, v9
  v_and_b32 v9, 3, v0
  v_lshlrev_b32 v9, 3, v9
  v_add_u32 v8, v8, v9
  v_add_u32 v7, s30, v8
  s_lshl_b32 s22, s15, 2
  s_and_b32 s23, s14, 3
  s_add_u32 s22, s22, s23
  s_mul_i32 s22, s22, 73728
  s_lshr_b32 s23, s14, 2
  s_xor_b32 s23, s23, 1
  s_mul_i32 s23, s23, 36
  s_add_u32 s23, s23, s3
  s_lshl_b32 s23, s23, 10
  s_add_u32 s22, s22, s23
  s_add_u32 s22, s22, 11534336
  s_mov_b32 s23, 9
  s_waitcnt vmcnt(0)
k0_qkvs:
  ds_read_b64_tr_b16 v[16:17], v7
  ds_read_b64_tr_b16 v[18:19], v7 offset:512
  v_add_u32 v7, 1024, v7
  s_waitcnt lgkmcnt(0)
  buffer_store_dwordx4 v[16:19], v1, s[8:11], s22 offen
  s_add_u32 s22, s22, 4096
  s_sub_u32 s23, s23, 1
  s_cmp_lg_u32 s23, 0
  s_nop 1
  s_cbranch_scc1 k0_qkvs
k0_end:
  s_endpgm
k0_prep_kernel_codeend:
.globl k1_qkv0_kernel
.p2align 8
.type k1_qkv0_kernel,@function
k1_qkv0_kernel:
  s_mov_b32 s34, 0x0
  s_branch k1_qkv_body
.globl k1_qkv1_kernel
.p2align 8
.type k1_qkv1_kernel,@function
k1_qkv1_kernel:
  s_mov_b32 s34, 0x3000000
  s_branch k1_qkv_body
.p2align 6
k1_qkv_body:
  s_cmp_ge_u32 s2, 256
  s_cbranch_scc1 k1_qkv_end
  s_load_dwordx2 s[4:5], s[0:1], 64
  v_lshrrev_b32 v1, 6, v0
  v_and_b32 v0, 63, v0
  s_nop 0
  v_readfirstlane_b32 s3, v1
  v_lshlrev_b32 v1, 4, v0
  v_and_b32 v2, 31, v0
  v_lshrrev_b32 v3, 5, v0
  v_add_u32 v4, 32768, v1
  s_lshr_b32 s16, s2, 3
  s_and_b32 s13, s2, 1
  s_lshl_b32 s13, s13, 2
  s_and_b32 s17, s16, 3
  s_add_u32 s13, s13, s17
  s_and_b32 s12, s2, 7
  s_lshr_b32 s12, s12, 1
  s_lshl_b32 s12, s12, 3
  s_lshr_b32 s16, s16, 2
  s_add_u32 s12, s12, s16
  s_and_b32 s15, s3, 1
  s_mul_i32 s15, s15, 36864
  s_lshr_b32 s14, s3, 1
  s_lshl_b32 s14, s14, 10
  s_add_u32 s15, s15, s14
  s_mul_i32 s14, s12, 73728
  s_add_u32 s14, s14, 40894464
  s_add_u32 s14, s14, s15
  s_lshl_b32 s20, s13, 2
  s_add_u32 s20, s20, s3
  s_mul_i32 s20, s20, 73728
  s_add_u32 s20, s20, 11534336
  s_waitcnt lgkmcnt(0)
  s_add_u32 s44, s4, s34
  s_addc_u32 s45, s5, 0
  s_mov_b32 s46, 0x6000000
  s_mov_b32 s47, 0x20000
  s_mov_b32 s8, s4
  s_mov_b32 s9, s5
  s_mov_b32 s10, 0x10000000
  s_mov_b32 s11, 0x20000
  s_cmp_eq_u32 s3, 0
  s_cselect_b32 s17, 16, 32
  s_cmp_eq_u32 s3, 3
  s_cselect_b32 s17, 8, s17
  v_mov_b32 v11, 0x7f000000
  v_cmp_gt_u32 vcc, s17, v2
  s_nop 1
  v_cndmask_b32 v11, v11, v1, vcc
  s_add_u32 m0, s15, 0
  s_add_u32 s16, s14, 0
  buffer_load_dwordx4 v1, s[44:47], s16 offen lds
  s_add_u32 m0, s15, 2048
  s_add_u32 s16, s14, 2048
  buffer_load_dwordx4 v1, s[44:47], s16 offen lds
  s_add_u32 m0, s15, 4096
  s_add_u32 s16, s14, 4096
  buffer_load_dwordx4 v1, s[44:47], s16 offen lds
  s_add_u32 m0, s15, 6144
  s_add_u32 s16, s14, 6144
  buffer_load_dwordx4 v1, s[44:47], s16 offen lds
  s_add_u32 m0, s15, 8192
  s_add_u32 s16, s14, 8192
  buffer_load_dwordx4 v1, s[44:47], s16 offen lds
  s_add_u32 m0, s15, 10240
  s_add_u32 s16, s14, 10240
  buffer_load_dwordx4 v1, s[44:47], s16 offen lds
  buffer_load_dwordx4 v[16:19], v11, s[8:11], s20 offen offset:0
  buffer_load_dwordx4 v[20:23], v11, s[8:11], s20 offen offset:1024
  buffer_load_dwordx4 v[24:27], v11, s[8:11], s20 offen offset:2048
  buffer_load_dwordx4 v[28:31], v11, s[8:11], s20 offen offset:3072
  s_add_u32 m0, s15, 12288
  s_add_u32 s16, s14, 12288
  buffer_load_dwordx4 v1, s[44:47], s16 offen lds
  s_add_u32 m0, s15, 14336
  s_add_u32 s16, s14, 14336
  buffer_load_dwordx4 v1, s[44:47], s16 offen lds
  s_add_u32 m0, s15, 16384
  s_add_u32 s16, s14, 16384
  buffer_load_dwordx4 v1, s[44:47], s16 offen lds
  s_add_u32 m0, s15, 18432
  s_add_u32 s16, s14, 18432
  buffer_load_dwordx4 v1, s[44:47], s16 offen lds
  s_add_u32 m0, s15, 20480
  s_add_u32 s16, s14, 20480
  buffer_load_dwordx4 v1, s[44:47], s16 offen lds
  s_add_u32 m0, s15, 22528
  s_add_u32 s16, s14, 22528
  buffer_load_dwordx4 v1, s[44:47], s16 offen lds
  s_add_u32 m0, s15, 24576
  s_add_u32 s16, s14, 24576
  buffer_load_dwordx4 v1, s[44:47], s16 offen lds
  s_add_u32 m0, s15, 26624
  s_add_u32 s16, s14, 26624
  buffer_load_dwordx4 v1, s[44:47], s16 offen lds
  s_add_u32 m0, s15, 28672
  s_add_u32 s16, s14, 28672
  buffer_load_dwordx4 v1, s[44:47], s16 offen lds
  s_add_u32 m0, s15, 30720
  s_add_u32 s16, s14, 30720
  buffer_load_dwordx4 v1, s[44:47], s16 offen lds
  s_add_u32 m0, s15, 32768
  s_add_u32 s16, s14, 32768
  buffer_load_dwordx4 v1, s[44:47], s16 offen lds
  s_add_u32 m0, s15, 34816
  s_add_u32 s16, s14, 34816
  buffer_load_dwordx4 v1, s[44:47], s16 offen lds
  s_lshl_b32 s21, s13, 2
  s_add_u32 s22, s21, s3
  s_lshl_b32 s23, s12, 1
  s_lshl_b32 s24, s22, 16
  s_lshl_b32 s25, s23, 10
  s_add_u32 s24, s24, s25
  s_add_u32 s24, s24, 50331648
  s_mul_i32 s25, s22, 155648
  s_mul_i32 s26, s23, 2432
  s_add_u32 s25, s25, s26
  s_add_u32 s25, s25, 53477376
  s_mov_b32 s27, 0x3eae1a93
  s_waitcnt vmcnt(16)
  s_barrier
  s_cmp_lg_u32 s3, 0
  s_cbranch_scc1 k1_qkv_v
  ds_read_b128 a[0:3], v1 offset:0
  ds_read_b128 a[4:7], v1 offset:36864
  ds_read_b128 a[8:11], v1 offset:1024
  ds_read_b128 a[12:15], v1 offset:37888
  ds_read_b128 a[16:19], v1 offset:2048
  ds_read_b128 a[20:23], v1 offset:38912
  s_waitcnt vmcnt(14)
  s_waitcnt lgkmcnt(4)
  v_mfma_f32_32x32x16_bf16 v[128:143], v[16:19], a[0:3], 0
  v_mfma_f32_32x32x16_bf16 v[144:159], v[16:19], a[4:7], 0
  ds_read_b128 a[24:27], v1 offset:3072
  ds_read_b128 a[28:31], v1 offset:39936
  s_waitcnt lgkmcnt(4)
  v_mfma_f32_32x32x16_bf16 v[128:143], v[20:23], a[8:11], v[128:143]
  v_mfma_f32_32x32x16_bf16 v[144:159], v[20:23], a[12:15], v[144:159]
  ds_read_b128 a[32:35], v1 offset:4096
  ds_read_b128 a[36:39], v1 offset:40960
  s_waitcnt vmcnt(12)
  s_waitcnt lgkmcnt(4)
  v_mfma_f32_32x32x16_bf16 v[128:143], v[24:27], a[16:19], v[128:143]
  v_mfma_f32_32x32x16_bf16 v[144:159], v[24:27], a[20:23], v[144:159]
  ds_read_b128 a[40:43], v1 offset:5120
  ds_read_b128 a[44:47], v1 offset:41984
  s_waitcnt lgkmcnt(4)
  v_mfma_f32_32x32x16_bf16 v[128:143], v[28:31], a[24:27], v[128:143]
  v_mfma_f32_32x32x16_bf16 v[144:159], v[28:31], a[28:31], v[144:159]
  s_add_u32 s20, s20, 4096
  buffer_load_dwordx4 v[32:35], v11, s[8:11], s20 offen offset:0
  buffer_load_dwordx4 v[36:39], v11, s[8:11], s20 offen offset:1024
  buffer_load_dwordx4 v[40:43], v11, s[8:11], s20 offen offset:2048
  buffer_load_dwordx4 v[44:47], v11, s[8:11], s20 offen offset:3072
  s_add_u32 s20, s20, 4096
  buffer_load_dwordx4 v[48:51], v11, s[8:11], s20 offen offset:0
  buffer_load_dwordx4 v[52:55], v11, s[8:11], s20 offen offset:1024
  buffer_load_dwordx4 v[56:59], v11, s[8:11], s20 offen offset:2048
  buffer_load_dwordx4 v[60:63], v11, s[8:11], s20 offen offset:3072
  s_add_u32 s20, s20, 4096
  buffer_load_dwordx4 v[64:67], v11, s[8:11], s20 offen offset:0
  buffer_load_dwordx4 v[68:71], v11, s[8:11], s20 offen offset:1024
  buffer_load_dwordx4 v[72:75], v11, s[8:11], s20 offen offset:2048
  buffer_load_dwordx4 v[76:79], v11, s[8:11], s20 offen offset:3072
  s_add_u32 s20, s20, 4096
  buffer_load_dwordx4 v[80:83], v11, s[8:11], s20 offen offset:0
  buffer_load_dwordx4 v[84:87], v11, s[8:11], s20 offen offset:1024
  ds_read_b128 a[48:51], v1 offset:6144
  ds_read_b128 a[52:55], v1 offset:43008
  s_waitcnt vmcnt(12)
  s_waitcnt lgkmcnt(4)
  v_mfma_f32_32x32x16_bf16 v[128:143], v[32:35], a[32:35], v[128:143]
  v_mfma_f32_32x32x16_bf16 v[144:159], v[32:35], a[36:39], v[144:159]
  buffer_load_dwordx4 v[16:19], v11, s[8:11], s20 offen offset:2048
  buffer_load_dwordx4 v[20:23], v11, s[8:11], s20 offen offset:3072
  ds_read_b128 a[56:59], v1 offset:7168
  ds_read_b128 a[60:63], v1 offset:44032
  s_waitcnt lgkmcnt(4)
  v_mfma_f32_32x32x16_bf16 v[128:143], v[36:39], a[40:43], v[128:143]
  v_mfma_f32_32x32x16_bf16 v[144:159], v[36:39], a[44:47], v[144:159]
  s_add_u32 s20, s20, 4096
  buffer_load_dwordx4 v[24:27], v11, s[8:11], s20 offen offset:0
  buffer_load_dwordx4 v[28:31], v11, s[8:11], s20 offen offset:1024
  ds_read_b128 a[64:67], v1 offset:8192
  ds_read_b128 a[68:71], v1 offset:45056
  s_waitcnt vmcnt(14)
  s_waitcnt lgkmcnt(4)
  v_mfma_f32_32x32x16_bf16 v[128:143], v[40:43], a[48:51], v[128:143]
  v_mfma_f32_32x32x16_bf16 v[144:159], v[40:43], a[52:55], v[144:159]
  buffer_load_dwordx4 v[32:35], v11, s[8:11], s20 offen offset:2048
  buffer_load_dwordx4 v[36:39], v11, s[8:11], s20 offen offset:3072
  ds_read_b128 a[72:75], v1 offset:9216
  ds_read_b128 a[76:79], v1 offset:46080
  s_waitcnt lgkmcnt(4)
  v_mfma_f32_32x32x16_bf16 v[128:143], v[44:47], a[56:59], v[128:143]
  v_mfma_f32_32x32x16_bf16 v[144:159], v[44:47], a[60:63], v[144:159]
  s_add_u32 s20, s20, 4096
  buffer_load_dwordx4 v[40:43], v11, s[8:11], s20 offen offset:0
  buffer_load_dwordx4 v[44:47], v11, s[8:11], s20 offen offset:1024
  ds_read_b128 a[80:83], v1 offset:10240
  ds_read_b128 a[84:87], v1 offset:47104
  s_waitcnt vmcnt(16)
  s_waitcnt lgkmcnt(4)
  v_mfma_f32_32x32x16_bf16 v[128:143], v[48:51], a[64:67], v[128:143]
  v_mfma_f32_32x32x16_bf16 v[144:159], v[48:51], a[68:71], v[144:159]
  buffer_load_dwordx4 v[48:51], v11, s[8:11], s20 offen offset:2048
  ds_read_b128 a[88:91], v1 offset:11264
  ds_read_b128 a[92:95], v1 offset:48128
  s_barrier
  s_waitcnt lgkmcnt(4)
  v_mfma_f32_32x32x16_bf16 v[128:143], v[52:55], a[72:75], v[128:143]
  v_mfma_f32_32x32x16_bf16 v[144:159], v[52:55], a[76:79], v[144:159]
  buffer_load_dwordx4 v[52:55], v11, s[8:11], s20 offen offset:3072
  ds_read_b128 a[96:99], v1 offset:12288
  ds_read_b128 a[100:103], v1 offset:49152
  s_waitcnt vmcnt(16)
  s_waitcnt lgkmcnt(4)
  v_mfma_f32_32x32x16_bf16 v[128:143], v[56:59], a[80:83], v[128:143]
  v_mfma_f32_32x32x16_bf16 v[144:159], v[56:59], a[84:87], v[144:159]
  s_add_u32 s20, s20, 4096
  buffer_load_dwordx4 v[56:59], v11, s[8:11], s20 offen offset:0
  ds_read_b128 a[104:107], v1 offset:13312
  ds_read_b128 a[108:111], v1 offset:50176
  s_waitcnt lgkmcnt(4)
  v_mfma_f32_32x32x16_bf16 v[128:143], v[60:63], a[88:91], v[128:143]
  v_mfma_f32_32x32x16_bf16 v[144:159], v[60:63], a[92:95], v[144:159]
  buffer_load_dwordx4 v[60:63], v11, s[8:11], s20 offen offset:1024
  ds_read_b128 a[112:115], v1 offset:14336
  ds_read_b128 a[116:119], v1 offset:51200
  s_waitcnt vmcnt(16)
  s_waitcnt lgkmcnt(4)
  v_mfma_f32_32x32x16_bf16 v[128:143], v[64:67], a[96:99], v[128:143]
  v_mfma_f32_32x32x16_bf16 v[144:159], v[64:67], a[100:103], v[144:159]
  buffer_load_dwordx4 v[64:67], v11, s[8:11], s20 offen offset:2048
  ds_read_b128 a[120:123], v1 offset:15360
  ds_read_b128 a[124:127], v1 offset:52224
  s_waitcnt lgkmcnt(4)
  v_mfma_f32_32x32x16_bf16 v[128:143], v[68:71], a[104:107], v[128:143]
  v_mfma_f32_32x32x16_bf16 v[144:159], v[68:71], a[108:111], v[144:159]
  buffer_load_dwordx4 v[68:71], v11, s[8:11], s20 offen offset:3072
  ds_read_b128 a[128:131], v1 offset:16384
  ds_read_b128 a[132:135], v1 offset:53248
  s_waitcnt vmcnt(16)
  s_waitcnt lgkmcnt(4)
  v_mfma_f32_32x32x16_bf16 v[128:143], v[72:75], a[112:115], v[128:143]
  v_mfma_f32_32x32x16_bf16 v[144:159], v[72:75], a[116:119], v[144:159]
  s_add_u32 s20, s20, 4096
  buffer_load_dwordx4 v[72:75], v11, s[8:11], s20 offen offset:0
  ds_read_b128 a[136:139], v1 offset:17408
  ds_read_b128 a[140:143], v1 offset:54272
  s_waitcnt lgkmcnt(4)
  v_mfma_f32_32x32x16_bf16 v[128:143], v[76:79], a[120:123], v[128:143]
  v_mfma_f32_32x32x16_bf16 v[144:159], v[76:79], a[124:127], v[144:159]
  buffer_load_dwordx4 v[76:79], v11, s[8:11], s20 offen offset:1024
  ds_read_b128 a[144:147], v1 offset:18432
  ds_read_b128 a[148:151], v1 offset:55296
  s_waitcnt vmcnt(16)
  s_waitcnt lgkmcnt(4)
  v_mfma_f32_32x32x16_bf16 v[128:143], v[80:83], a[128:131], v[128:143]
  v_mfma_f32_32x32x16_bf16 v[144:159], v[80:83], a[132:135], v[144:159]
  buffer_load_dwordx4 v[80:83], v11, s[8:11], s20 offen offset:2048
  ds_read_b128 a[152:155], v1 offset:19456
  ds_read_b128 a[156:159], v1 offset:56320
  s_waitcnt lgkmcnt(4)
  v_mfma_f32_32x32x16_bf16 v[128:143], v[84:87], a[136:139], v[128:143]
  v_mfma_f32_32x32x16_bf16 v[144:159], v[84:87], a[140:143], v[144:159]
  buffer_load_dwordx4 v[84:87], v11, s[8:11], s20 offen offset:3072
  ds_read_b128 a[160:163], v1 offset:20480
  ds_read_b128 a[164:167], v1 offset:57344
  s_waitcnt vmcnt(16)
  s_waitcnt lgkmcnt(4)
  v_mfma_f32_32x32x16_bf16 v[128:143], v[16:19], a[144:147], v[128:143]
  v_mfma_f32_32x32x16_bf16 v[144:159], v[16:19], a[148:151], v[144:159]
  s_add_u32 s20, s20, 4096
  buffer_load_dwordx4 v[16:19], v1, s[8:11], s20 offen offset:0
  ds_read_b128 a[168:171], v1 offset:21504
  ds_read_b128 a[172:175], v1 offset:58368
  s_waitcnt lgkmcnt(4)
  v_mfma_f32_32x32x16_bf16 v[128:143], v[20:23], a[152:155], v[128:143]
  v_mfma_f32_32x32x16_bf16 v[144:159], v[20:23], a[156:159], v[144:159]
  buffer_load_dwordx4 v[20:23], v1, s[8:11], s20 offen offset:1024
  ds_read_b128 a[176:179], v1 offset:22528
  ds_read_b128 a[180:183], v1 offset:59392
  s_waitcnt vmcnt(16)
  s_waitcnt lgkmcnt(4)
  v_mfma_f32_32x32x16_bf16 v[128:143], v[24:27], a[160:163], v[128:143]
  v_mov_b32 v5, 1.0
  v_mov_b32 v6, s27
  v_cmp_gt_u32 vcc, 32, v0
  s_nop 1
  v_cndmask_b32 v5, v5, v6, vcc
  v_mfma_f32_32x32x16_bf16 v[144:159], v[24:27], a[164:167], v[144:159]
  buffer_load_dwordx4 v[24:27], v1, s[8:11], s20 offen offset:2048
  ds_read_b128 a[184:187], v1 offset:23552
  ds_read_b128 a[188:191], v1 offset:60416
  v_lshlrev_b32 v8, 2, v2
  v_add_u32 v7, 2304, v8
  v_add_u32 v6, 19456, v8
  s_barrier
  s_waitcnt lgkmcnt(4)
  v_mfma_f32_32x32x16_bf16 v[128:143], v[28:31], a[168:171], v[128:143]
  v_cndmask_b32 v7, v7, v6, vcc
  v_mov_b32 v8, 4864
  v_mov_b32 v9, 256
  v_cndmask_b32 v8, v8, v9, vcc
  v_mov_b32 v9, 2432
  v_mov_b32 v10, 128
  v_mfma_f32_32x32x16_bf16 v[144:159], v[28:31], a[172:175], v[144:159]
  buffer_load_dwordx4 v[28:31], v1, s[8:11], s20 offen offset:3072
  ds_read_b128 a[192:195], v1 offset:24576
  ds_read_b128 a[196:199], v1 offset:61440
  v_cndmask_b32 v9, v9, v10, vcc
  s_waitcnt vmcnt(16)
  s_waitcnt lgkmcnt(4)
  v_mfma_f32_32x32x16_bf16 v[128:143], v[32:35], a[176:179], v[128:143]
  v_mfma_f32_32x32x16_bf16 v[144:159], v[32:35], a[180:183], v[144:159]
  s_add_u32 s20, s20, 4096
  buffer_load_dwordx4 v[32:35], v1, s[8:11], s20 offen offset:0
  ds_read_b128 a[200:203], v1 offset:25600
  ds_read_b128 a[204:207], v1 offset:62464
  s_waitcnt lgkmcnt(4)
  v_mfma_f32_32x32x16_bf16 v[128:143], v[36:39], a[184:187], v[128:143]
  v_mfma_f32_32x32x16_bf16 v[144:159], v[36:39], a[188:191], v[144:159]
  buffer_load_dwordx4 v[36:39], v1, s[8:11], s20 offen offset:1024
  ds_read_b128 a[208:211], v1 offset:26624
  ds_read_b128 a[212:215], v1 offset:63488
  s_waitcnt vmcnt(16)
  s_waitcnt lgkmcnt(4)
  v_mfma_f32_32x32x16_bf16 v[128:143], v[40:43], a[192:195], v[128:143]
  v_mfma_f32_32x32x16_bf16 v[144:159], v[40:43], a[196:199], v[144:159]
  buffer_load_dwordx4 v[40:43], v1, s[8:11], s20 offen offset:2048
  ds_read_b128 a[216:219], v1 offset:27648
  ds_read_b128 a[220:223], v1 offset:64512
  s_waitcnt lgkmcnt(4)
  v_mfma_f32_32x32x16_bf16 v[128:143], v[44:47], a[200:203], v[128:143]
  v_mfma_f32_32x32x16_bf16 v[144:159], v[44:47], a[204:207], v[144:159]
  buffer_load_dwordx4 v[44:47], v1, s[8:11], s20 offen offset:3072
  ds_read_b128 a[224:227], v1 offset:28672
  ds_read_b128 a[228:231], v4 offset:32768
  s_waitcnt vmcnt(16)
  s_waitcnt lgkmcnt(4)
  v_mfma_f32_32x32x16_bf16 v[128:143], v[48:51], a[208:211], v[128:143]
  v_mfma_f32_32x32x16_bf16 v[144:159], v[48:51], a[212:215], v[144:159]
  s_add_u32 s20, s20, 4096
  buffer_load_dwordx4 v[48:51], v1, s[8:11], s20 offen offset:0
  ds_read_b128 a[232:235], v1 offset:29696
  ds_read_b128 a[236:239], v4 offset:33792
  s_waitcnt lgkmcnt(4)
  v_mfma_f32_32x32x16_bf16 v[128:143], v[52:55], a[216:219], v[128:143]
  v_mfma_f32_32x32x16_bf16 v[144:159], v[52:55], a[220:223], v[144:159]
  buffer_load_dwordx4 v[52:55], v1, s[8:11], s20 offen offset:1024
  ds_read_b128 a[240:243], v1 offset:30720
  ds_read_b128 a[244:247], v4 offset:34816
  s_waitcnt vmcnt(16)
  s_waitcnt lgkmcnt(4)
  v_mfma_f32_32x32x16_bf16 v[128:143], v[56:59], a[224:227], v[128:143]
  v_mfma_f32_32x32x16_bf16 v[144:159], v[56:59], a[228:231], v[144:159]
  buffer_load_dwordx4 v[56:59], v1, s[8:11], s20 offen offset:2048
  ds_read_b128 a[248:251], v1 offset:31744
  ds_read_b128 a[252:255], v4 offset:35840
  s_waitcnt lgkmcnt(4)
  v_mfma_f32_32x32x16_bf16 v[128:143], v[60:63], a[232:235], v[128:143]
  v_mfma_f32_32x32x16_bf16 v[144:159], v[60:63], a[236:239], v[144:159]
  buffer_load_dwordx4 v[60:63], v1, s[8:11], s20 offen offset:3072
  ds_read_b128 v[160:163], v1 offset:32768
  ds_read_b128 v[164:167], v4 offset:36864
  s_waitcnt vmcnt(16)
  s_waitcnt lgkmcnt(4)
  v_mfma_f32_32x32x16_bf16 v[128:143], v[64:67], a[240:243], v[128:143]
  v_mfma_f32_32x32x16_bf16 v[144:159], v[64:67], a[244:247], v[144:159]
  s_add_u32 s20, s20, 4096
  buffer_load_dwordx4 v[64:67], v1, s[8:11], s20 offen offset:0
  ds_read_b128 v[168:171], v1 offset:33792
  ds_read_b128 v[172:175], v4 offset:37888
  s_waitcnt lgkmcnt(4)
  v_mfma_f32_32x32x16_bf16 v[128:143], v[68:71], a[248:251], v[128:143]
  v_mfma_f32_32x32x16_bf16 v[144:159], v[68:71], a[252:255], v[144:159]
  buffer_load_dwordx4 v[68:71], v1, s[8:11], s20 offen offset:1024
  ds_read_b128 v[176:179], v1 offset:34816
  ds_read_b128 v[180:183], v4 offset:38912
  s_waitcnt vmcnt(16)
  s_waitcnt lgkmcnt(4)
  v_mfma_f32_32x32x16_bf16 v[128:143], v[72:75], v[160:163], v[128:143]
  v_mfma_f32_32x32x16_bf16 v[144:159], v[72:75], v[164:167], v[144:159]
  buffer_load_dwordx4 v[72:75], v1, s[8:11], s20 offen offset:2048
  ds_read_b128 v[184:187], v1 offset:35840
  ds_read_b128 v[188:191], v4 offset:39936
  s_waitcnt lgkmcnt(4)
  v_mfma_f32_32x32x16_bf16 v[128:143], v[76:79], v[168:171], v[128:143]
  v_mfma_f32_32x32x16_bf16 v[144:159], v[76:79], v[172:175], v[144:159]
  buffer_load_dwordx4 v[76:79], v1, s[8:11], s20 offen offset:3072
  s_waitcnt vmcnt(16)
  s_waitcnt lgkmcnt(2)
  v_mfma_f32_32x32x16_bf16 v[128:143], v[80:83], v[176:179], v[128:143]
  v_mfma_f32_32x32x16_bf16 v[144:159], v[80:83], v[180:183], v[144:159]
  s_add_u32 s20, s20, 4096
  buffer_load_dwordx4 v[80:83], v1, s[8:11], s20 offen offset:0
  s_waitcnt lgkmcnt(0)
  v_mfma_f32_32x32x16_bf16 v[128:143], v[84:87], v[184:187], v[128:143]
  v_mfma_f32_32x32x16_bf16 v[144:159], v[84:87], v[188:191], v[144:159]
  buffer_load_dwordx4 v[84:87], v1, s[8:11], s20 offen offset:1024
  s_waitcnt vmcnt(16)
  v_mfma_f32_32x32x16_bf16 v[96:111], v[16:19], a[0:3], 0
  v_mfma_f32_32x32x16_bf16 v[112:127], v[16:19], a[4:7], 0
  buffer_load_dwordx4 v[16:19], v1, s[8:11], s20 offen offset:2048
  v_mfma_f32_32x32x16_bf16 v[96:111], v[20:23], a[8:11], v[96:111]
  v_mfma_f32_32x32x16_bf16 v[112:127], v[20:23], a[12:15], v[112:127]
  buffer_load_dwordx4 v[20:23], v1, s[8:11], s20 offen offset:3072
  s_waitcnt vmcnt(16)
  v_mfma_f32_32x32x16_bf16 v[96:111], v[24:27], a[16:19], v[96:111]
  v_mfma_f32_32x32x16_bf16 v[112:127], v[24:27], a[20:23], v[112:127]
  s_add_u32 s20, s20, 4096
  buffer_load_dwordx4 v[24:27], v1, s[8:11], s20 offen offset:0
  s_barrier
  v_mul_f32 v128, v5, v128
  v_mul_f32 v129, v5, v129
  v_mul_f32 v130, v5, v130
  v_mfma_f32_32x32x16_bf16 v[96:111], v[28:31], a[24:27], v[96:111]
  v_mul_f32 v131, v5, v131
  v_mul_f32 v132, v5, v132
  v_mul_f32 v133, v5, v133
  v_mul_f32 v134, v5, v134
  v_mul_f32 v135, v5, v135
  v_cvt_pk_bf16_f32 v208, v128, v129
  v_mfma_f32_32x32x16_bf16 v[112:127], v[28:31], a[28:31], v[112:127]
  buffer_load_dwordx4 v[28:31], v1, s[8:11], s20 offen offset:1024
  v_cvt_pk_bf16_f32 v209, v130, v131
  v_cvt_pk_bf16_f32 v210, v132, v133
  v_cvt_pk_bf16_f32 v211, v134, v135
  v_mov_b32 v10, v7
  ds_write_b32 v10, v208
  s_waitcnt vmcnt(16)
  v_mfma_f32_32x32x16_bf16 v[96:111], v[32:35], a[32:35], v[96:111]
  v_add_u32 v10, v10, v8
  ds_write_b32 v10, v209
  v_add_u32 v10, v10, v8
  ds_write_b32 v10, v210
  v_add_u32 v10, v10, v8
  ds_write_b32 v10, v211
  v_mfma_f32_32x32x16_bf16 v[112:127], v[32:35], a[36:39], v[112:127]
  buffer_load_dwordx4 v[32:35], v1, s[8:11], s20 offen offset:2048
  v_add_u32 v10, v10, v8
  v_add_u32 v7, v7, v9
  v_mul_f32 v144, v5, v144
  v_mul_f32 v145, v5, v145
  v_mul_f32 v146, v5, v146
  v_mfma_f32_32x32x16_bf16 v[96:111], v[36:39], a[40:43], v[96:111]
  v_mul_f32 v147, v5, v147
  v_mul_f32 v148, v5, v148
  v_mul_f32 v149, v5, v149
  v_mul_f32 v150, v5, v150
  v_mul_f32 v151, v5, v151
  v_cvt_pk_bf16_f32 v212, v144, v145
  v_mfma_f32_32x32x16_bf16 v[112:127], v[36:39], a[44:47], v[112:127]
  buffer_load_dwordx4 v[36:39], v1, s[8:11], s20 offen offset:3072
  v_cvt_pk_bf16_f32 v213, v146, v147
  v_cvt_pk_bf16_f32 v214, v148, v149
  v_cvt_pk_bf16_f32 v215, v150, v151
  v_mov_b32 v10, v7
  ds_write_b32 v10, v212
  s_waitcnt vmcnt(16)
  v_mfma_f32_32x32x16_bf16 v[96:111], v[40:43], a[48:51], v[96:111]
  v_add_u32 v10, v10, v8
  ds_write_b32 v10, v213
  v_add_u32 v10, v10, v8
  ds_write_b32 v10, v214
  v_add_u32 v10, v10, v8
  ds_write_b32 v10, v215
  v_mfma_f32_32x32x16_bf16 v[112:127], v[40:43], a[52:55], v[112:127]
  s_add_u32 s20, s20, 4096
  buffer_load_dwordx4 v[40:43], v1, s[8:11], s20 offen offset:0
  v_add_u32 v10, v10, v8
  v_add_u32 v7, v7, v9
  s_waitcnt lgkmcnt(0)
  s_barrier
  v_mfma_f32_32x32x16_bf16 v[96:111], v[44:47], a[56:59], v[96:111]
  s_mul_i32 s28, s3, 4864
  v_add_u32 v12, s28, v1
  s_lshl_b32 s28, s3, 8
  s_add_u32 s28, s28, 19456
  v_add_u32 v13, s28, v1
  ds_read_b128 v[224:227], v12 offset:1024
  v_mfma_f32_32x32x16_bf16 v[112:127], v[44:47], a[60:63], v[112:127]
  buffer_load_dwordx4 v[44:47], v1, s[8:11], s20 offen offset:1024
  ds_read_b128 v[228:231], v12 offset:2048
  ds_read_b128 v[232:235], v12 offset:3456
  ds_read_b128 v[236:239], v12 offset:4480
  ds_read_b128 v[240:243], v13
  v_mov_b32 v14, 0x7f000000
  s_waitcnt vmcnt(16)
  v_mfma_f32_32x32x16_bf16 v[96:111], v[48:51], a[64:67], v[96:111]
  v_cmp_gt_u32 vcc, 24, v0
  s_lshl_b32 s29, s22, 13
  s_lshl_b32 s30, s23, 7
  v_cndmask_b32 v15, v14, v1, vcc
  s_add_u32 s29, s29, s30
  s_add_u32 s29, s29, 52428800
  v_mfma_f32_32x32x16_bf16 v[112:127], v[48:51], a[68:71], v[112:127]
  buffer_load_dwordx4 v[48:51], v1, s[8:11], s20 offen offset:2048
  v_cmp_gt_u32 vcc, 16, v0
  s_add_u32 s30, s25, 2048
  s_add_u32 s31, s25, 4480
  v_cndmask_b32 v14, v14, v1, vcc
  s_waitcnt lgkmcnt(0)
  v_mfma_f32_32x32x16_bf16 v[96:111], v[52:55], a[72:75], v[96:111]
  buffer_store_dwordx4 v[224:227], v1, s[44:47], s25 offen offset:1024 sc1
  buffer_store_dwordx4 v[228:231], v15, s[44:47], s30 offen sc1
  buffer_store_dwordx4 v[232:235], v1, s[44:47], s25 offen offset:3456 sc1
  buffer_store_dwordx4 v[236:239], v15, s[44:47], s31 offen sc1
  buffer_store_dwordx4 v[240:243], v14, s[44:47], s29 offen sc1
  v_mfma_f32_32x32x16_bf16 v[112:127], v[52:55], a[76:79], v[112:127]
  buffer_load_dwordx4 v[52:55], v1, s[8:11], s20 offen offset:3072
  s_waitcnt vmcnt(21)
  v_mfma_f32_32x32x16_bf16 v[96:111], v[56:59], a[80:83], v[96:111]
  v_mfma_f32_32x32x16_bf16 v[112:127], v[56:59], a[84:87], v[112:127]
  s_add_u32 s20, s20, 4096
  buffer_load_dwordx4 v[56:59], v1, s[8:11], s20 offen offset:0
  v_mfma_f32_32x32x16_bf16 v[96:111], v[60:63], a[88:91], v[96:111]
  v_mfma_f32_32x32x16_bf16 v[112:127], v[60:63], a[92:95], v[112:127]
  buffer_load_dwordx4 v[60:63], v1, s[8:11], s20 offen offset:1024
  s_waitcnt vmcnt(21)
  v_mfma_f32_32x32x16_bf16 v[96:111], v[64:67], a[96:99], v[96:111]
  v_mfma_f32_32x32x16_bf16 v[112:127], v[64:67], a[100:103], v[112:127]
  buffer_load_dwordx4 v[64:67], v1, s[8:11], s20 offen offset:2048
  v_mfma_f32_32x32x16_bf16 v[96:111], v[68:71], a[104:107], v[96:111]
  v_mfma_f32_32x32x16_bf16 v[112:127], v[68:71], a[108:111], v[112:127]
  buffer_load_dwordx4 v[68:71], v1, s[8:11], s20 offen offset:3072
  s_waitcnt vmcnt(21)
  v_mfma_f32_32x32x16_bf16 v[96:111], v[72:75], a[112:115], v[96:111]
  v_mfma_f32_32x32x16_bf16 v[112:127], v[72:75], a[116:119], v[112:127]
  s_add_u32 s20, s20, 4096
  buffer_load_dwordx4 v[72:75], v1, s[8:11], s20 offen offset:0
  v_mfma_f32_32x32x16_bf16 v[96:111], v[76:79], a[120:123], v[96:111]
  v_mfma_f32_32x32x16_bf16 v[112:127], v[76:79], a[124:127], v[112:127]
  buffer_load_dwordx4 v[76:79], v1, s[8:11], s20 offen offset:1024
  s_waitcnt vmcnt(21)
  v_mfma_f32_32x32x16_bf16 v[96:111], v[80:83], a[128:131], v[96:111]
  v_mfma_f32_32x32x16_bf16 v[112:127], v[80:83], a[132:135], v[112:127]
  buffer_load_dwordx4 v[80:83], v1, s[8:11], s20 offen offset:2048
  v_mfma_f32_32x32x16_bf16 v[96:111], v[84:87], a[136:139], v[96:111]
  v_mfma_f32_32x32x16_bf16 v[112:127], v[84:87], a[140:143], v[112:127]
  buffer_load_dwordx4 v[84:87], v1, s[8:11], s20 offen offset:3072
  s_waitcnt vmcnt(21)
  v_mfma_f32_32x32x16_bf16 v[96:111], v[16:19], a[144:147], v[96:111]
  v_mfma_f32_32x32x16_bf16 v[112:127], v[16:19], a[148:151], v[112:127]
  v_mfma_f32_32x32x16_bf16 v[96:111], v[20:23], a[152:155], v[96:111]
  v_mfma_f32_32x32x16_bf16 v[112:127], v[20:23], a[156:159], v[112:127]
  s_waitcnt vmcnt(19)
  v_mfma_f32_32x32x16_bf16 v[96:111], v[24:27], a[160:163], v[96:111]
  v_mfma_f32_32x32x16_bf16 v[112:127], v[24:27], a[164:167], v[112:127]
  v_mfma_f32_32x32x16_bf16 v[96:111], v[28:31], a[168:171], v[96:111]
  v_mfma_f32_32x32x16_bf16 v[112:127], v[28:31], a[172:175], v[112:127]
  s_waitcnt vmcnt(17)
  v_mfma_f32_32x32x16_bf16 v[96:111], v[32:35], a[176:179], v[96:111]
  v_mfma_f32_32x32x16_bf16 v[112:127], v[32:35], a[180:183], v[112:127]
  v_mfma_f32_32x32x16_bf16 v[96:111], v[36:39], a[184:187], v[96:111]
  v_mfma_f32_32x32x16_bf16 v[112:127], v[36:39], a[188:191], v[112:127]
  s_waitcnt vmcnt(15)
  v_mfma_f32_32x32x16_bf16 v[96:111], v[40:43], a[192:195], v[96:111]
  v_mfma_f32_32x32x16_bf16 v[112:127], v[40:43], a[196:199], v[112:127]
  v_mfma_f32_32x32x16_bf16 v[96:111], v[44:47], a[200:203], v[96:111]
  v_mfma_f32_32x32x16_bf16 v[112:127], v[44:47], a[204:207], v[112:127]
  s_waitcnt vmcnt(14)
  v_mfma_f32_32x32x16_bf16 v[96:111], v[48:51], a[208:211], v[96:111]
  v_mfma_f32_32x32x16_bf16 v[112:127], v[48:51], a[212:215], v[112:127]
  s_waitcnt vmcnt(8)
  v_mfma_f32_32x32x16_bf16 v[96:111], v[52:55], a[216:219], v[96:111]
  v_mfma_f32_32x32x16_bf16 v[112:127], v[52:55], a[220:223], v[112:127]
  s_waitcnt vmcnt(7)
  v_mfma_f32_32x32x16_bf16 v[96:111], v[56:59], a[224:227], v[96:111]
  v_mfma_f32_32x32x16_bf16 v[112:127], v[56:59], a[228:231], v[112:127]
  s_waitcnt vmcnt(6)
  v_mfma_f32_32x32x16_bf16 v[96:111], v[60:63], a[232:235], v[96:111]
  v_mfma_f32_32x32x16_bf16 v[112:127], v[60:63], a[236:239], v[112:127]
  s_waitcnt vmcnt(5)
  v_mfma_f32_32x32x16_bf16 v[96:111], v[64:67], a[240:243], v[96:111]
  v_mfma_f32_32x32x16_bf16 v[112:127], v[64:67], a[244:247], v[112:127]
  s_waitcnt vmcnt(4)
  v_mfma_f32_32x32x16_bf16 v[96:111], v[68:71], a[248:251], v[96:111]
  v_mfma_f32_32x32x16_bf16 v[112:127], v[68:71], a[252:255], v[112:127]
  s_waitcnt vmcnt(3)
  v_mfma_f32_32x32x16_bf16 v[96:111], v[72:75], v[160:163], v[96:111]
  v_mfma_f32_32x32x16_bf16 v[112:127], v[72:75], v[164:167], v[112:127]
  s_waitcnt vmcnt(2)
  v_mfma_f32_32x32x16_bf16 v[96:111], v[76:79], v[168:171], v[96:111]
  v_mfma_f32_32x32x16_bf16 v[112:127], v[76:79], v[172:175], v[112:127]
  s_waitcnt vmcnt(1)
  v_mfma_f32_32x32x16_bf16 v[96:111], v[80:83], v[176:179], v[96:111]
  v_mfma_f32_32x32x16_bf16 v[112:127], v[80:83], v[180:183], v[112:127]
  s_waitcnt vmcnt(0)
  v_mfma_f32_32x32x16_bf16 v[96:111], v[84:87], v[184:187], v[96:111]
  v_mfma_f32_32x32x16_bf16 v[112:127], v[84:87], v[188:191], v[112:127]
  s_branch k1_qkv_fin
k1_qkv_v:
  ds_read_b128 a[0:3], v1 offset:0
  ds_read_b128 a[4:7], v1 offset:36864
  ds_read_b128 a[8:11], v1 offset:1024
  ds_read_b128 a[12:15], v1 offset:37888
  ds_read_b128 a[16:19], v1 offset:2048
  ds_read_b128 a[20:23], v1 offset:38912
  s_waitcnt vmcnt(14)
  s_waitcnt lgkmcnt(4)
  v_mfma_f32_32x32x16_bf16 v[128:143], a[0:3], v[16:19], 0
  v_mfma_f32_32x32x16_bf16 v[144:159], a[4:7], v[16:19], 0
  ds_read_b128 a[24:27], v1 offset:3072
  ds_read_b128 a[28:31], v1 offset:39936
  s_waitcnt lgkmcnt(4)
  v_mfma_f32_32x32x16_bf16 v[128:143], a[8:11], v[20:23], v[128:143]
  v_mfma_f32_32x32x16_bf16 v[144:159], a[12:15], v[20:23], v[144:159]
  ds_read_b128 a[32:35], v1 offset:4096
  ds_read_b128 a[36:39], v1 offset:40960
  s_waitcnt vmcnt(12)
  s_waitcnt lgkmcnt(4)
  v_mfma_f32_32x32x16_bf16 v[128:143], a[16:19], v[24:27], v[128:143]
  v_mfma_f32_32x32x16_bf16 v[144:159], a[20:23], v[24:27], v[144:159]
  ds_read_b128 a[40:43], v1 offset:5120
  ds_read_b128 a[44:47], v1 offset:41984
  s_waitcnt lgkmcnt(4)
  v_mfma_f32_32x32x16_bf16 v[128:143], a[24:27], v[28:31], v[128:143]
  v_mfma_f32_32x32x16_bf16 v[144:159], a[28:31], v[28:31], v[144:159]
  s_add_u32 s20, s20, 4096
  buffer_load_dwordx4 v[32:35], v11, s[8:11], s20 offen offset:0
  buffer_load_dwordx4 v[36:39], v11, s[8:11], s20 offen offset:1024
  buffer_load_dwordx4 v[40:43], v11, s[8:11], s20 offen offset:2048
  buffer_load_dwordx4 v[44:47], v11, s[8:11], s20 offen offset:3072
  s_add_u32 s20, s20, 4096
  buffer_load_dwordx4 v[48:51], v11, s[8:11], s20 offen offset:0
  buffer_load_dwordx4 v[52:55], v11, s[8:11], s20 offen offset:1024
  buffer_load_dwordx4 v[56:59], v11, s[8:11], s20 offen offset:2048
  buffer_load_dwordx4 v[60:63], v11, s[8:11], s20 offen offset:3072
  s_add_u32 s20, s20, 4096
  buffer_load_dwordx4 v[64:67], v11, s[8:11], s20 offen offset:0
  buffer_load_dwordx4 v[68:71], v11, s[8:11], s20 offen offset:1024
  buffer_load_dwordx4 v[72:75], v11, s[8:11], s20 offen offset:2048
  buffer_load_dwordx4 v[76:79], v11, s[8:11], s20 offen offset:3072
  s_add_u32 s20, s20, 4096
  buffer_load_dwordx4 v[80:83], v11, s[8:11], s20 offen offset:0
  buffer_load_dwordx4 v[84:87], v11, s[8:11], s20 offen offset:1024
  ds_read_b128 a[48:51], v1 offset:6144
  ds_read_b128 a[52:55], v1 offset:43008
  s_waitcnt vmcnt(12)
  s_waitcnt lgkmcnt(4)
  v_mfma_f32_32x32x16_bf16 v[128:143], a[32:35], v[32:35], v[128:143]
  v_mfma_f32_32x32x16_bf16 v[144:159], a[36:39], v[32:35], v[144:159]
  buffer_load_dwordx4 v[16:19], v11, s[8:11], s20 offen offset:2048
  buffer_load_dwordx4 v[20:23], v11, s[8:11], s20 offen offset:3072
  ds_read_b128 a[56:59], v1 offset:7168
  ds_read_b128 a[60:63], v1 offset:44032
  s_waitcnt lgkmcnt(4)
  v_mfma_f32_32x32x16_bf16 v[128:143], a[40:43], v[36:39], v[128:143]
  v_mfma_f32_32x32x16_bf16 v[144:159], a[44:47], v[36:39], v[144:159]
  s_add_u32 s20, s20, 4096
  buffer_load_dwordx4 v[24:27], v11, s[8:11], s20 offen offset:0
  buffer_load_dwordx4 v[28:31], v11, s[8:11], s20 offen offset:1024
  ds_read_b128 a[64:67], v1 offset:8192
  ds_read_b128 a[68:71], v1 offset:45056
  s_waitcnt vmcnt(14)
  s_waitcnt lgkmcnt(4)
  v_mfma_f32_32x32x16_bf16 v[128:143], a[48:51], v[40:43], v[128:143]
  v_mfma_f32_32x32x16_bf16 v[144:159], a[52:55], v[40:43], v[144:159]
  buffer_load_dwordx4 v[32:35], v11, s[8:11], s20 offen offset:2048
  buffer_load_dwordx4 v[36:39], v11, s[8:11], s20 offen offset:3072
  ds_read_b128 a[72:75], v1 offset:9216
  ds_read_b128 a[76:79], v1 offset:46080
  s_waitcnt lgkmcnt(4)
  v_mfma_f32_32x32x16_bf16 v[128:143], a[56:59], v[44:47], v[128:143]
  v_mfma_f32_32x32x16_bf16 v[144:159], a[60:63], v[44:47], v[144:159]
  s_add_u32 s20, s20, 4096
  buffer_load_dwordx4 v[40:43], v11, s[8:11], s20 offen offset:0
  buffer_load_dwordx4 v[44:47], v11, s[8:11], s20 offen offset:1024
  ds_read_b128 a[80:83], v1 offset:10240
  ds_read_b128 a[84:87], v1 offset:47104
  s_waitcnt vmcnt(16)
  s_waitcnt lgkmcnt(4)
  v_mfma_f32_32x32x16_bf16 v[128:143], a[64:67], v[48:51], v[128:143]
  v_mfma_f32_32x32x16_bf16 v[144:159], a[68:71], v[48:51], v[144:159]
  buffer_load_dwordx4 v[48:51], v11, s[8:11], s20 offen offset:2048
  ds_read_b128 a[88:91], v1 offset:11264
  ds_read_b128 a[92:95], v1 offset:48128
  s_barrier
  s_waitcnt lgkmcnt(4)
  v_mfma_f32_32x32x16_bf16 v[128:143], a[72:75], v[52:55], v[128:143]
  v_mfma_f32_32x32x16_bf16 v[144:159], a[76:79], v[52:55], v[144:159]
  buffer_load_dwordx4 v[52:55], v11, s[8:11], s20 offen offset:3072
  ds_read_b128 a[96:99], v1 offset:12288
  ds_read_b128 a[100:103], v1 offset:49152
  s_waitcnt vmcnt(16)
  s_waitcnt lgkmcnt(4)
  v_mfma_f32_32x32x16_bf16 v[128:143], a[80:83], v[56:59], v[128:143]
  v_mfma_f32_32x32x16_bf16 v[144:159], a[84:87], v[56:59], v[144:159]
  s_add_u32 s20, s20, 4096
  buffer_load_dwordx4 v[56:59], v11, s[8:11], s20 offen offset:0
  ds_read_b128 a[104:107], v1 offset:13312
  ds_read_b128 a[108:111], v1 offset:50176
  s_waitcnt lgkmcnt(4)
  v_mfma_f32_32x32x16_bf16 v[128:143], a[88:91], v[60:63], v[128:143]
  v_mfma_f32_32x32x16_bf16 v[144:159], a[92:95], v[60:63], v[144:159]
  buffer_load_dwordx4 v[60:63], v11, s[8:11], s20 offen offset:1024
  ds_read_b128 a[112:115], v1 offset:14336
  ds_read_b128 a[116:119], v1 offset:51200
  s_waitcnt vmcnt(16)
  s_waitcnt lgkmcnt(4)
  v_mfma_f32_32x32x16_bf16 v[128:143], a[96:99], v[64:67], v[128:143]
  v_mfma_f32_32x32x16_bf16 v[144:159], a[100:103], v[64:67], v[144:159]
  buffer_load_dwordx4 v[64:67], v11, s[8:11], s20 offen offset:2048
  ds_read_b128 a[120:123], v1 offset:15360
  ds_read_b128 a[124:127], v1 offset:52224
  s_waitcnt lgkmcnt(4)
  v_mfma_f32_32x32x16_bf16 v[128:143], a[104:107], v[68:71], v[128:143]
  v_mfma_f32_32x32x16_bf16 v[144:159], a[108:111], v[68:71], v[144:159]
  buffer_load_dwordx4 v[68:71], v11, s[8:11], s20 offen offset:3072
  ds_read_b128 a[128:131], v1 offset:16384
  ds_read_b128 a[132:135], v1 offset:53248
  s_waitcnt vmcnt(16)
  s_waitcnt lgkmcnt(4)
  v_mfma_f32_32x32x16_bf16 v[128:143], a[112:115], v[72:75], v[128:143]
  v_mfma_f32_32x32x16_bf16 v[144:159], a[116:119], v[72:75], v[144:159]
  s_add_u32 s20, s20, 4096
  buffer_load_dwordx4 v[72:75], v11, s[8:11], s20 offen offset:0
  ds_read_b128 a[136:139], v1 offset:17408
  ds_read_b128 a[140:143], v1 offset:54272
  s_waitcnt lgkmcnt(4)
  v_mfma_f32_32x32x16_bf16 v[128:143], a[120:123], v[76:79], v[128:143]
  v_mfma_f32_32x32x16_bf16 v[144:159], a[124:127], v[76:79], v[144:159]
  buffer_load_dwordx4 v[76:79], v11, s[8:11], s20 offen offset:1024
  ds_read_b128 a[144:147], v1 offset:18432
  ds_read_b128 a[148:151], v1 offset:55296
  s_waitcnt vmcnt(16)
  s_waitcnt lgkmcnt(4)
  v_mfma_f32_32x32x16_bf16 v[128:143], a[128:131], v[80:83], v[128:143]
  v_mfma_f32_32x32x16_bf16 v[144:159], a[132:135], v[80:83], v[144:159]
  buffer_load_dwordx4 v[80:83], v11, s[8:11], s20 offen offset:2048
  ds_read_b128 a[152:155], v1 offset:19456
  ds_read_b128 a[156:159], v1 offset:56320
  s_waitcnt lgkmcnt(4)
  v_mfma_f32_32x32x16_bf16 v[128:143], a[136:139], v[84:87], v[128:143]
  v_mfma_f32_32x32x16_bf16 v[144:159], a[140:143], v[84:87], v[144:159]
  buffer_load_dwordx4 v[84:87], v11, s[8:11], s20 offen offset:3072
  ds_read_b128 a[160:163], v1 offset:20480
  ds_read_b128 a[164:167], v1 offset:57344
  s_waitcnt vmcnt(16)
  s_waitcnt lgkmcnt(4)
  v_mfma_f32_32x32x16_bf16 v[128:143], a[144:147], v[16:19], v[128:143]
  v_mfma_f32_32x32x16_bf16 v[144:159], a[148:151], v[16:19], v[144:159]
  s_add_u32 s20, s20, 4096
  buffer_load_dwordx4 v[16:19], v1, s[8:11], s20 offen offset:0
  ds_read_b128 a[168:171], v1 offset:21504
  ds_read_b128 a[172:175], v1 offset:58368
  s_waitcnt lgkmcnt(4)
  v_mfma_f32_32x32x16_bf16 v[128:143], a[152:155], v[20:23], v[128:143]
  v_mfma_f32_32x32x16_bf16 v[144:159], a[156:159], v[20:23], v[144:159]
  buffer_load_dwordx4 v[20:23], v1, s[8:11], s20 offen offset:1024
  ds_read_b128 a[176:179], v1 offset:22528
  ds_read_b128 a[180:183], v1 offset:59392
  s_waitcnt vmcnt(16)
  s_waitcnt lgkmcnt(4)
  v_mfma_f32_32x32x16_bf16 v[128:143], a[160:163], v[24:27], v[128:143]
  s_sub_u32 s28, s3, 1
  s_lshl_b32 s28, s28, 5
  v_add_u32 v5, s28, v2
  v_mul_u32_u24 v6, 57, v5
  v_lshrrev_b32 v6, 10, v6
  v_mul_u32_u24 v7, 18, v6
  v_mfma_f32_32x32x16_bf16 v[144:159], a[164:167], v[24:27], v[144:159]
  buffer_load_dwordx4 v[24:27], v1, s[8:11], s20 offen offset:2048
  ds_read_b128 a[184:187], v1 offset:23552
  ds_read_b128 a[188:191], v1 offset:60416
  v_sub_u32 v7, v5, v7
  v_subrev_u32 v8, 72, v5
  v_lshrrev_b32 v9, 2, v8
  s_barrier
  s_waitcnt lgkmcnt(4)
  v_mfma_f32_32x32x16_bf16 v[128:143], a[168:171], v[28:31], v[128:143]
  v_add_u32 v9, 18, v9
  v_and_b32 v8, 3, v8
  v_cmp_gt_u32 vcc, 72, v5
  s_nop 1
  v_cndmask_b32 v6, v8, v6, vcc
  v_mfma_f32_32x32x16_bf16 v[144:159], a[172:175], v[28:31], v[144:159]
  buffer_load_dwordx4 v[28:31], v1, s[8:11], s20 offen offset:3072
  ds_read_b128 a[192:195], v1 offset:24576
  ds_read_b128 a[196:199], v1 offset:61440
  v_cndmask_b32 v7, v9, v7, vcc
  v_cmp_ne_u32 s[32:33], 18, v7
  v_mul_u32_u24 v6, 4864, v6
  s_waitcnt vmcnt(16)
  s_waitcnt lgkmcnt(4)
  v_mfma_f32_32x32x16_bf16 v[128:143], a[176:179], v[32:35], v[128:143]
  v_lshlrev_b32 v7, 4, v7
  v_add_u32 v6, v6, v7
  v_mul_u32_u24 v7, 320, v3
  v_add_u32 v6, v6, v7
  v_add_u32 v6, 1024, v6
  v_mov_b32 v8, 24576
  v_mfma_f32_32x32x16_bf16 v[144:159], a[180:183], v[32:35], v[144:159]
  s_add_u32 s20, s20, 4096
  buffer_load_dwordx4 v[32:35], v1, s[8:11], s20 offen offset:0
  ds_read_b128 a[200:203], v1 offset:25600
  ds_read_b128 a[204:207], v1 offset:62464
  v_cmp_gt_u32 vcc, 80, v5
  s_waitcnt lgkmcnt(4)
  v_mfma_f32_32x32x16_bf16 v[128:143], a[184:187], v[36:39], v[128:143]
  s_nop 1
  v_cndmask_b32 v6, v8, v6, vcc
  v_mov_b32 v9, 0x3f803f80
  v_mfma_f32_32x32x16_bf16 v[144:159], a[188:191], v[36:39], v[144:159]
  buffer_load_dwordx4 v[36:39], v1, s[8:11], s20 offen offset:1024
  ds_read_b128 a[208:211], v1 offset:26624
  ds_read_b128 a[212:215], v1 offset:63488
  s_waitcnt vmcnt(16)
  s_waitcnt lgkmcnt(4)
  v_mfma_f32_32x32x16_bf16 v[128:143], a[192:195], v[40:43], v[128:143]
  v_mfma_f32_32x32x16_bf16 v[144:159], a[196:199], v[40:43], v[144:159]
  buffer_load_dwordx4 v[40:43], v1, s[8:11], s20 offen offset:2048
  ds_read_b128 a[216:219], v1 offset:27648
  ds_read_b128 a[220:223], v1 offset:64512
  s_waitcnt lgkmcnt(4)
  v_mfma_f32_32x32x16_bf16 v[128:143], a[200:203], v[44:47], v[128:143]
  v_mfma_f32_32x32x16_bf16 v[144:159], a[204:207], v[44:47], v[144:159]
  buffer_load_dwordx4 v[44:47], v1, s[8:11], s20 offen offset:3072
  ds_read_b128 a[224:227], v1 offset:28672
  ds_read_b128 a[228:231], v4 offset:32768
  s_waitcnt vmcnt(16)
  s_waitcnt lgkmcnt(4)
  v_mfma_f32_32x32x16_bf16 v[128:143], a[208:211], v[48:51], v[128:143]
  v_mfma_f32_32x32x16_bf16 v[144:159], a[212:215], v[48:51], v[144:159]
  s_add_u32 s20, s20, 4096
  buffer_load_dwordx4 v[48:51], v1, s[8:11], s20 offen offset:0
  ds_read_b128 a[232:235], v1 offset:29696
  ds_read_b128 a[236:239], v4 offset:33792
  s_waitcnt lgkmcnt(4)
  v_mfma_f32_32x32x16_bf16 v[128:143], a[216:219], v[52:55], v[128:143]
  v_mfma_f32_32x32x16_bf16 v[144:159], a[220:223], v[52:55], v[144:159]
  buffer_load_dwordx4 v[52:55], v1, s[8:11], s20 offen offset:1024
  ds_read_b128 a[240:243], v1 offset:30720
  ds_read_b128 a[244:247], v4 offset:34816
  s_waitcnt vmcnt(16)
  s_waitcnt lgkmcnt(4)
  v_mfma_f32_32x32x16_bf16 v[128:143], a[224:227], v[56:59], v[128:143]
  v_mfma_f32_32x32x16_bf16 v[144:159], a[228:231], v[56:59], v[144:159]
  buffer_load_dwordx4 v[56:59], v1, s[8:11], s20 offen offset:2048
  ds_read_b128 a[248:251], v1 offset:31744
  ds_read_b128 a[252:255], v4 offset:35840
  s_waitcnt lgkmcnt(4)
  v_mfma_f32_32x32x16_bf16 v[128:143], a[232:235], v[60:63], v[128:143]
  v_mfma_f32_32x32x16_bf16 v[144:159], a[236:239], v[60:63], v[144:159]
  buffer_load_dwordx4 v[60:63], v1, s[8:11], s20 offen offset:3072
  ds_read_b128 v[160:163], v1 offset:32768
  ds_read_b128 v[164:167], v4 offset:36864
  s_waitcnt vmcnt(16)
  s_waitcnt lgkmcnt(4)
  v_mfma_f32_32x32x16_bf16 v[128:143], a[240:243], v[64:67], v[128:143]
  v_mfma_f32_32x32x16_bf16 v[144:159], a[244:247], v[64:67], v[144:159]
  s_add_u32 s20, s20, 4096
  buffer_load_dwordx4 v[64:67], v1, s[8:11], s20 offen offset:0
  ds_read_b128 v[168:171], v1 offset:33792
  ds_read_b128 v[172:175], v4 offset:37888
  s_waitcnt lgkmcnt(4)
  v_mfma_f32_32x32x16_bf16 v[128:143], a[248:251], v[68:71], v[128:143]
  v_mfma_f32_32x32x16_bf16 v[144:159], a[252:255], v[68:71], v[144:159]
  buffer_load_dwordx4 v[68:71], v1, s[8:11], s20 offen offset:1024
  ds_read_b128 v[176:179], v1 offset:34816
  ds_read_b128 v[180:183], v4 offset:38912
  s_waitcnt vmcnt(16)
  s_waitcnt lgkmcnt(4)
  v_mfma_f32_32x32x16_bf16 v[128:143], v[160:163], v[72:75], v[128:143]
  v_mfma_f32_32x32x16_bf16 v[144:159], v[164:167], v[72:75], v[144:159]
  buffer_load_dwordx4 v[72:75], v1, s[8:11], s20 offen offset:2048
  ds_read_b128 v[184:187], v1 offset:35840
  ds_read_b128 v[188:191], v4 offset:39936
  s_waitcnt lgkmcnt(4)
  v_mfma_f32_32x32x16_bf16 v[128:143], v[168:171], v[76:79], v[128:143]
  v_mfma_f32_32x32x16_bf16 v[144:159], v[172:175], v[76:79], v[144:159]
  buffer_load_dwordx4 v[76:79], v1, s[8:11], s20 offen offset:3072
  s_waitcnt vmcnt(16)
  s_waitcnt lgkmcnt(2)
  v_mfma_f32_32x32x16_bf16 v[128:143], v[176:179], v[80:83], v[128:143]
  v_mfma_f32_32x32x16_bf16 v[144:159], v[180:183], v[80:83], v[144:159]
  s_add_u32 s20, s20, 4096
  buffer_load_dwordx4 v[80:83], v1, s[8:11], s20 offen offset:0
  s_waitcnt lgkmcnt(0)
  v_mfma_f32_32x32x16_bf16 v[128:143], v[184:187], v[84:87], v[128:143]
  v_mfma_f32_32x32x16_bf16 v[144:159], v[188:191], v[84:87], v[144:159]
  buffer_load_dwordx4 v[84:87], v1, s[8:11], s20 offen offset:1024
  s_waitcnt vmcnt(16)
  v_mfma_f32_32x32x16_bf16 v[96:111], v[16:19], a[0:3], 0
  v_mfma_f32_32x32x16_bf16 v[112:127], v[16:19], a[4:7], 0
  buffer_load_dwordx4 v[16:19], v1, s[8:11], s20 offen offset:2048
  v_mfma_f32_32x32x16_bf16 v[96:111], v[20:23], a[8:11], v[96:111]
  v_mfma_f32_32x32x16_bf16 v[112:127], v[20:23], a[12:15], v[112:127]
  buffer_load_dwordx4 v[20:23], v1, s[8:11], s20 offen offset:3072
  s_waitcnt vmcnt(16)
  v_mfma_f32_32x32x16_bf16 v[96:111], v[24:27], a[16:19], v[96:111]
  v_mfma_f32_32x32x16_bf16 v[112:127], v[24:27], a[20:23], v[112:127]
  s_add_u32 s20, s20, 4096
  buffer_load_dwordx4 v[24:27], v1, s[8:11], s20 offen offset:0
  s_barrier
  v_cvt_pk_bf16_f32 v208, v128, v129
  v_cvt_pk_bf16_f32 v209, v130, v131
  v_cvt_pk_bf16_f32 v210, v132, v133
  v_mfma_f32_32x32x16_bf16 v[96:111], v[28:31], a[24:27], v[96:111]
  v_cvt_pk_bf16_f32 v211, v134, v135
  v_cvt_pk_bf16_f32 v212, v136, v137
  v_cvt_pk_bf16_f32 v213, v138, v139
  v_cvt_pk_bf16_f32 v214, v140, v141
  v_cvt_pk_bf16_f32 v215, v142, v143
  v_cndmask_b32 v208, v9, v208, s[32:33]
  v_mfma_f32_32x32x16_bf16 v[112:127], v[28:31], a[28:31], v[112:127]
  buffer_load_dwordx4 v[28:31], v1, s[8:11], s20 offen offset:1024
  v_cndmask_b32 v209, v9, v209, s[32:33]
  v_cndmask_b32 v210, v9, v210, s[32:33]
  v_cndmask_b32 v211, v9, v211, s[32:33]
  v_cndmask_b32 v212, v9, v212, s[32:33]
  v_cndmask_b32 v213, v9, v213, s[32:33]
  s_waitcnt vmcnt(16)
  v_mfma_f32_32x32x16_bf16 v[96:111], v[32:35], a[32:35], v[96:111]
  v_cndmask_b32 v214, v9, v214, s[32:33]
  v_cndmask_b32 v215, v9, v215, s[32:33]
  ds_write_b128 v6, v[208:211] offset:0
  ds_write_b128 v6, v[212:215] offset:640
  v_cvt_pk_bf16_f32 v216, v144, v145
  v_cvt_pk_bf16_f32 v217, v146, v147
  v_mfma_f32_32x32x16_bf16 v[112:127], v[32:35], a[36:39], v[112:127]
  buffer_load_dwordx4 v[32:35], v1, s[8:11], s20 offen offset:2048
  v_cvt_pk_bf16_f32 v218, v148, v149
  v_cvt_pk_bf16_f32 v219, v150, v151
  v_cvt_pk_bf16_f32 v220, v152, v153
  v_cvt_pk_bf16_f32 v221, v154, v155
  v_cvt_pk_bf16_f32 v222, v156, v157
  v_mfma_f32_32x32x16_bf16 v[96:111], v[36:39], a[40:43], v[96:111]
  v_cvt_pk_bf16_f32 v223, v158, v159
  v_cndmask_b32 v216, v9, v216, s[32:33]
  v_cndmask_b32 v217, v9, v217, s[32:33]
  v_cndmask_b32 v218, v9, v218, s[32:33]
  v_cndmask_b32 v219, v9, v219, s[32:33]
  v_cndmask_b32 v220, v9, v220, s[32:33]
  v_mfma_f32_32x32x16_bf16 v[112:127], v[36:39], a[44:47], v[112:127]
  buffer_load_dwordx4 v[36:39], v1, s[8:11], s20 offen offset:3072
  v_cndmask_b32 v221, v9, v221, s[32:33]
  v_cndmask_b32 v222, v9, v222, s[32:33]
  v_cndmask_b32 v223, v9, v223, s[32:33]
  ds_write_b128 v6, v[216:219] offset:2432
  ds_write_b128 v6, v[220:223] offset:3072
  s_waitcnt vmcnt(16)
  v_mfma_f32_32x32x16_bf16 v[96:111], v[40:43], a[48:51], v[96:111]
  s_waitcnt lgkmcnt(0)
  s_barrier
  s_mul_i32 s28, s3, 4864
  v_add_u32 v12, s28, v1
  s_lshl_b32 s28, s3, 8
  s_add_u32 s28, s28, 19456
  v_mfma_f32_32x32x16_bf16 v[112:127], v[40:43], a[52:55], v[112:127]
  s_add_u32 s20, s20, 4096
  buffer_load_dwordx4 v[40:43], v1, s[8:11], s20 offen offset:0
  v_add_u32 v13, s28, v1
  ds_read_b128 v[224:227], v12 offset:1024
  ds_read_b128 v[228:231], v12 offset:2048
  ds_read_b128 v[232:235], v12 offset:3456
  v_mfma_f32_32x32x16_bf16 v[96:111], v[44:47], a[56:59], v[96:111]
  ds_read_b128 v[236:239], v12 offset:4480
  ds_read_b128 v[240:243], v13
  v_mov_b32 v14, 0x7f000000
  v_cmp_gt_u32 vcc, 24, v0
  s_lshl_b32 s29, s22, 13
  s_lshl_b32 s30, s23, 7
  v_mfma_f32_32x32x16_bf16 v[112:127], v[44:47], a[60:63], v[112:127]
  buffer_load_dwordx4 v[44:47], v1, s[8:11], s20 offen offset:1024
  v_cndmask_b32 v15, v14, v1, vcc
  s_add_u32 s29, s29, s30
  s_add_u32 s29, s29, 52428800
  v_cmp_gt_u32 vcc, 16, v0
  s_add_u32 s30, s25, 2048
  s_waitcnt vmcnt(16)
  v_mfma_f32_32x32x16_bf16 v[96:111], v[48:51], a[64:67], v[96:111]
  s_add_u32 s31, s25, 4480
  v_cndmask_b32 v14, v14, v1, vcc
  s_waitcnt lgkmcnt(0)
  buffer_store_dwordx4 v[224:227], v1, s[44:47], s25 offen offset:1024 sc1
  buffer_store_dwordx4 v[228:231], v15, s[44:47], s30 offen sc1
  buffer_store_dwordx4 v[232:235], v1, s[44:47], s25 offen offset:3456 sc1
  v_mfma_f32_32x32x16_bf16 v[112:127], v[48:51], a[68:71], v[112:127]
  buffer_load_dwordx4 v[48:51], v1, s[8:11], s20 offen offset:2048
  buffer_store_dwordx4 v[236:239], v15, s[44:47], s31 offen sc1
  buffer_store_dwordx4 v[240:243], v14, s[44:47], s29 offen sc1
  v_mfma_f32_32x32x16_bf16 v[96:111], v[52:55], a[72:75], v[96:111]
  v_mfma_f32_32x32x16_bf16 v[112:127], v[52:55], a[76:79], v[112:127]
  buffer_load_dwordx4 v[52:55], v1, s[8:11], s20 offen offset:3072
  s_waitcnt vmcnt(21)
  v_mfma_f32_32x32x16_bf16 v[96:111], v[56:59], a[80:83], v[96:111]
  v_mfma_f32_32x32x16_bf16 v[112:127], v[56:59], a[84:87], v[112:127]
  s_add_u32 s20, s20, 4096
  buffer_load_dwordx4 v[56:59], v1, s[8:11], s20 offen offset:0
  v_mfma_f32_32x32x16_bf16 v[96:111], v[60:63], a[88:91], v[96:111]
  v_mfma_f32_32x32x16_bf16 v[112:127], v[60:63], a[92:95], v[112:127]
  buffer_load_dwordx4 v[60:63], v1, s[8:11], s20 offen offset:1024
  s_waitcnt vmcnt(21)
  v_mfma_f32_32x32x16_bf16 v[96:111], v[64:67], a[96:99], v[96:111]
  v_mfma_f32_32x32x16_bf16 v[112:127], v[64:67], a[100:103], v[112:127]
  buffer_load_dwordx4 v[64:67], v1, s[8:11], s20 offen offset:2048
  v_mfma_f32_32x32x16_bf16 v[96:111], v[68:71], a[104:107], v[96:111]
  v_mfma_f32_32x32x16_bf16 v[112:127], v[68:71], a[108:111], v[112:127]
  buffer_load_dwordx4 v[68:71], v1, s[8:11], s20 offen offset:3072
  s_waitcnt vmcnt(21)
  v_mfma_f32_32x32x16_bf16 v[96:111], v[72:75], a[112:115], v[96:111]
  v_mfma_f32_32x32x16_bf16 v[112:127], v[72:75], a[116:119], v[112:127]
  s_add_u32 s20, s20, 4096
  buffer_load_dwordx4 v[72:75], v1, s[8:11], s20 offen offset:0
  v_mfma_f32_32x32x16_bf16 v[96:111], v[76:79], a[120:123], v[96:111]
  v_mfma_f32_32x32x16_bf16 v[112:127], v[76:79], a[124:127], v[112:127]
  buffer_load_dwordx4 v[76:79], v1, s[8:11], s20 offen offset:1024
  s_waitcnt vmcnt(21)
  v_mfma_f32_32x32x16_bf16 v[96:111], v[80:83], a[128:131], v[96:111]
  v_mfma_f32_32x32x16_bf16 v[112:127], v[80:83], a[132:135], v[112:127]
  buffer_load_dwordx4 v[80:83], v1, s[8:11], s20 offen offset:2048
  v_mfma_f32_32x32x16_bf16 v[96:111], v[84:87], a[136:139], v[96:111]
  v_mfma_f32_32x32x16_bf16 v[112:127], v[84:87], a[140:143], v[112:127]
  buffer_load_dwordx4 v[84:87], v1, s[8:11], s20 offen offset:3072
  s_waitcnt vmcnt(21)
  v_mfma_f32_32x32x16_bf16 v[96:111], v[16:19], a[144:147], v[96:111]
  v_mfma_f32_32x32x16_bf16 v[112:127], v[16:19], a[148:151], v[112:127]
  v_mfma_f32_32x32x16_bf16 v[96:111], v[20:23], a[152:155], v[96:111]
  v_mfma_f32_32x32x16_bf16 v[112:127], v[20:23], a[156:159], v[112:127]
  s_waitcnt vmcnt(19)
  v_mfma_f32_32x32x16_bf16 v[96:111], v[24:27], a[160:163], v[96:111]
  v_mfma_f32_32x32x16_bf16 v[112:127], v[24:27], a[164:167], v[112:127]
  v_mfma_f32_32x32x16_bf16 v[96:111], v[28:31], a[168:171], v[96:111]
  v_mfma_f32_32x32x16_bf16 v[112:127], v[28:31], a[172:175], v[112:127]
  s_waitcnt vmcnt(17)
  v_mfma_f32_32x32x16_bf16 v[96:111], v[32:35], a[176:179], v[96:111]
  v_mfma_f32_32x32x16_bf16 v[112:127], v[32:35], a[180:183], v[112:127]
  v_mfma_f32_32x32x16_bf16 v[96:111], v[36:39], a[184:187], v[96:111]
  v_mfma_f32_32x32x16_bf16 v[112:127], v[36:39], a[188:191], v[112:127]
  s_waitcnt vmcnt(15)
  v_mfma_f32_32x32x16_bf16 v[96:111], v[40:43], a[192:195], v[96:111]
  v_mfma_f32_32x32x16_bf16 v[112:127], v[40:43], a[196:199], v[112:127]
  v_mfma_f32_32x32x16_bf16 v[96:111], v[44:47], a[200:203], v[96:111]
  v_mfma_f32_32x32x16_bf16 v[112:127], v[44:47], a[204:207], v[112:127]
  s_waitcnt vmcnt(11)
  v_mfma_f32_32x32x16_bf16 v[96:111], v[48:51], a[208:211], v[96:111]
  v_mfma_f32_32x32x16_bf16 v[112:127], v[48:51], a[212:215], v[112:127]
  s_waitcnt vmcnt(8)
  v_mfma_f32_32x32x16_bf16 v[96:111], v[52:55], a[216:219], v[96:111]
  v_mfma_f32_32x32x16_bf16 v[112:127], v[52:55], a[220:223], v[112:127]
  s_waitcnt vmcnt(7)
  v_mfma_f32_32x32x16_bf16 v[96:111], v[56:59], a[224:227], v[96:111]
  v_mfma_f32_32x32x16_bf16 v[112:127], v[56:59], a[228:231], v[112:127]
  s_waitcnt vmcnt(6)
  v_mfma_f32_32x32x16_bf16 v[96:111], v[60:63], a[232:235], v[96:111]
  v_mfma_f32_32x32x16_bf16 v[112:127], v[60:63], a[236:239], v[112:127]
  s_waitcnt vmcnt(5)
  v_mfma_f32_32x32x16_bf16 v[96:111], v[64:67], a[240:243], v[96:111]
  v_mfma_f32_32x32x16_bf16 v[112:127], v[64:67], a[244:247], v[112:127]
  s_waitcnt vmcnt(4)
  v_mfma_f32_32x32x16_bf16 v[96:111], v[68:71], a[248:251], v[96:111]
  v_mfma_f32_32x32x16_bf16 v[112:127], v[68:71], a[252:255], v[112:127]
  s_waitcnt vmcnt(3)
  v_mfma_f32_32x32x16_bf16 v[96:111], v[72:75], v[160:163], v[96:111]
  v_mfma_f32_32x32x16_bf16 v[112:127], v[72:75], v[164:167], v[112:127]
  s_waitcnt vmcnt(2)
  v_mfma_f32_32x32x16_bf16 v[96:111], v[76:79], v[168:171], v[96:111]
  v_mfma_f32_32x32x16_bf16 v[112:127], v[76:79], v[172:175], v[112:127]
  s_waitcnt vmcnt(1)
  v_mfma_f32_32x32x16_bf16 v[96:111], v[80:83], v[176:179], v[96:111]
  v_mfma_f32_32x32x16_bf16 v[112:127], v[80:83], v[180:183], v[112:127]
  s_waitcnt vmcnt(0)
  v_mfma_f32_32x32x16_bf16 v[96:111], v[84:87], v[184:187], v[96:111]
  v_mfma_f32_32x32x16_bf16 v[112:127], v[84:87], v[188:191], v[112:127]
k1_qkv_fin:
  s_nop 10
  v_cvt_pk_bf16_f32 v196, v104, v105
  v_cvt_pk_bf16_f32 v197, v106, v107
  v_cvt_pk_bf16_f32 v198, v108, v109
  v_cvt_pk_bf16_f32 v199, v110, v111
  buffer_store_dwordx4 v[196:199], v1, s[44:47], s25 offen offset:0 sc1
  v_cvt_pk_bf16_f32 v204, v120, v121
  v_cvt_pk_bf16_f32 v205, v122, v123
  v_cvt_pk_bf16_f32 v206, v124, v125
  v_cvt_pk_bf16_f32 v207, v126, v127
  buffer_store_dwordx4 v[204:207], v1, s[44:47], s25 offen offset:2432 sc1
  v_mul_f32 v96, s27, v96
  v_mul_f32 v97, s27, v97
  v_mul_f32 v98, s27, v98
  v_mul_f32 v99, s27, v99
  v_mul_f32 v100, s27, v100
  v_mul_f32 v101, s27, v101
  v_mul_f32 v102, s27, v102
  v_mul_f32 v103, s27, v103
  v_cvt_pk_bf16_f32 v192, v96, v97
  v_cvt_pk_bf16_f32 v193, v98, v99
  v_cvt_pk_bf16_f32 v194, v100, v101
  v_cvt_pk_bf16_f32 v195, v102, v103
  buffer_store_dwordx4 v[192:195], v1, s[44:47], s24 offen offset:0 sc1
  v_mul_f32 v112, s27, v112
  v_mul_f32 v113, s27, v113
  v_mul_f32 v114, s27, v114
  v_mul_f32 v115, s27, v115
  v_mul_f32 v116, s27, v116
  v_mul_f32 v117, s27, v117
  v_mul_f32 v118, s27, v118
  v_mul_f32 v119, s27, v119
  v_cvt_pk_bf16_f32 v200, v112, v113
  v_cvt_pk_bf16_f32 v201, v114, v115
  v_cvt_pk_bf16_f32 v202, v116, v117
  v_cvt_pk_bf16_f32 v203, v118, v119
  buffer_store_dwordx4 v[200:203], v1, s[44:47], s24 offen offset:1024 sc1
k1_qkv_end:
  s_endpgm
k1_qkv_codeend:
.globl k2_attn0_kernel
.p2align 8
.type k2_attn0_kernel,@function
k2_attn0_kernel:
  s_mov_b32 s34, 0x0
  s_branch k2_attn_body
.globl k2_attn1_kernel
.p2align 8
.type k2_attn1_kernel,@function
k2_attn1_kernel:
  s_mov_b32 s34, 0x3000000
  s_branch k2_attn_body
.p2align 6
k2_attn_body:
  s_cmp_ge_u32 s2, 256
  s_cbranch_scc1 k2_attn_end
  s_load_dwordx2 s[4:5], s[0:1], 64
  v_lshrrev_b32 v1, 6, v0
  v_and_b32 v0, 63, v0
  s_nop 0
  v_readfirstlane_b32 s3, v1
  v_lshlrev_b32 v1, 4, v0
  v_and_b32 v2, 31, v0
  v_lshrrev_b32 v3, 5, v0
  s_and_b32 s12, s2, 7
  s_lshl_b32 s12, s12, 2
  s_lshr_b32 s13, s2, 3
  s_and_b32 s13, s13, 3
  s_add_u32 s12, s12, s13
  s_lshr_b32 s13, s2, 5
  s_lshl_b32 s13, s13, 3
  s_add_u32 s13, s13, s3
  s_lshl_b32 s14, s12, 16
  s_lshl_b32 s15, s13, 10
  s_add_u32 s14, s14, s15
  s_add_u32 s14, s14, 50331648
  s_lshl_b32 s15, s12, 13
  s_lshl_b32 s16, s13, 7
  s_add_u32 s15, s15, s16
  s_add_u32 s15, s15, 52428800
  v_lshlrev_b32 v7, 2, v2
  v_mov_b32 v93, 0x7f000000
  v_cmp_gt_u32 vcc, 32, v0
  s_mul_i32 s16, s12, 155648
  s_lshl_b32 s17, s3, 10
  s_add_u32 s16, s16, s17
  s_add_u32 s16, s16, 53477376
  v_cndmask_b32 v93, v93, v7, vcc
  s_waitcnt lgkmcnt(0)
  s_add_u32 s44, s4, s34
  s_addc_u32 s45, s5, 0
  s_mov_b32 s46, 0x6000000
  s_mov_b32 s47, 0x20000
  s_mov_b32 s8, s4
  s_mov_b32 s9, s5
  s_mov_b32 s10, 0x10000000
  s_mov_b32 s11, 0x20000
  s_cmp_ge_u32 s3, 8
  s_cbranch_scc1 k2_attn_help
  buffer_load_dwordx4 v[8:11], v1, s[44:47], s14 offen
  buffer_load_dword v12, v93, s[44:47], s15 offen
  s_sub_u32 s19, s16, s17
  s_add_u32 m0, s17, 0
  s_add_u32 s18, s16, 0
  buffer_load_dwordx4 v1, s[44:47], s18 offen lds
  s_add_u32 m0, s17, 8192
  s_add_u32 s18, s16, 8192
  buffer_load_dwordx4 v1, s[44:47], s18 offen lds
  s_add_u32 m0, s17, 16384
  s_add_u32 s18, s16, 16384
  buffer_load_dwordx4 v1, s[44:47], s18 offen lds
  v_mov_b32 v4, v1
  v_add_u32 v5, 2304, v7
  v_mul_u32_u24 v94, 320, v3
  v_min_u32 v95, 19, v2
  v_lshlrev_b32 v95, 4, v95
  v_add_u32 v94, v94, v95
  v_add_u32 v6, 1024, v94
  v_mov_b32 v13, 0
  v_mov_b32 v21, 0
  v_mov_b32 v72, 0
  v_mov_b32 v73, 0
  v_mov_b32 v74, 0
  v_mov_b32 v75, 0
  v_mov_b32 v76, 0
  v_mov_b32 v77, 0
  v_mov_b32 v78, 0
  v_mov_b32 v79, 0
  v_mov_b32 v80, 0
  v_mov_b32 v81, 0
  v_mov_b32 v82, 0
  v_mov_b32 v83, 0
  v_mov_b32 v84, 0
  v_mov_b32 v85, 0
  v_mov_b32 v86, 0
  v_mov_b32 v87, 0
  v_mov_b32 v68, 0
  v_mov_b32 v28, 0
  v_mov_b32 v69, 0
  v_mov_b32 v29, 0
  v_mov_b32 v70, 0
  v_mov_b32 v30, 0
  v_mov_b32 v71, 0
  v_mov_b32 v31, 0
  s_waitcnt vmcnt(0)
  s_barrier
  ds_read_b128 v[16:19], v4
  ds_read_b32 v20, v5
  s_waitcnt lgkmcnt(0)
  v_mfma_f32_32x32x16_bf16 v[32:47], v[16:19], v[8:11], 0
  v_mfma_f32_32x32x8_bf16 v[32:47], v[20:21], v[12:13], v[32:47]
  ds_read_b128 v[16:19], v4 offset:2432
  ds_read_b32 v20, v5 offset:2432
  s_nop 10
  v_exp_f32 v32, v32
  v_exp_f32 v33, v33
  v_mfma_f32_32x32x16_bf16 v[72:87], v[28:31], v[68:71], v[72:87]
  ds_read_b128 v[24:27], v6 offset:0
  ds_read_b128 v[28:31], v6 offset:640
  s_add_u32 m0, s17, 24576
  s_add_u32 s18, s16, 24576
  buffer_load_dwordx4 v1, s[44:47], s18 offen lds
  s_add_u32 m0, s17, 32768
  s_add_u32 s18, s16, 32768
  buffer_load_dwordx4 v1, s[44:47], s18 offen lds
  v_exp_f32 v34, v34
  v_exp_f32 v35, v35
  v_cvt_pk_bf16_f32 v64, v32, v33
  s_waitcnt lgkmcnt(2)
  v_mfma_f32_32x32x16_bf16 v[48:63], v[16:19], v[8:11], 0
  v_exp_f32 v36, v36
  v_exp_f32 v37, v37
  v_cvt_pk_bf16_f32 v65, v34, v35
  v_exp_f32 v38, v38
  v_exp_f32 v39, v39
  v_mfma_f32_32x32x8_bf16 v[48:63], v[20:21], v[12:13], v[48:63]
  ds_read_b128 v[16:19], v4 offset:4864
  s_add_u32 m0, s17, 40960
  s_add_u32 s18, s16, 40960
  buffer_load_dwordx4 v1, s[44:47], s18 offen lds
  ds_read_b32 v20, v5 offset:4864
  v_cvt_pk_bf16_f32 v66, v36, v37
  v_exp_f32 v40, v40
  v_cvt_pk_bf16_f32 v67, v38, v39
  v_exp_f32 v41, v41
  v_exp_f32 v42, v42
  s_waitcnt lgkmcnt(2)
  v_mfma_f32_32x32x16_bf16 v[72:87], v[24:27], v[64:67], v[72:87]
  v_exp_f32 v43, v43
  v_cvt_pk_bf16_f32 v68, v40, v41
  v_exp_f32 v44, v44
  v_exp_f32 v45, v45
  v_cvt_pk_bf16_f32 v69, v42, v43
  v_exp_f32 v46, v46
  v_exp_f32 v47, v47
  v_cvt_pk_bf16_f32 v70, v44, v45
  v_cvt_pk_bf16_f32 v71, v46, v47
  v_exp_f32 v48, v48
  v_exp_f32 v49, v49
  v_mfma_f32_32x32x16_bf16 v[72:87], v[28:31], v[68:71], v[72:87]
  ds_read_b128 v[24:27], v6 offset:2432
  ds_read_b128 v[28:31], v6 offset:3072
  s_add_u32 m0, s17, 49152
  s_add_u32 s18, s16, 49152
  buffer_load_dwordx4 v1, s[44:47], s18 offen lds
  s_add_u32 m0, s17, 57344
  s_add_u32 s18, s16, 57344
  buffer_load_dwordx4 v1, s[44:47], s18 offen lds
  v_exp_f32 v50, v50
  v_exp_f32 v51, v51
  v_cvt_pk_bf16_f32 v64, v48, v49
  s_waitcnt lgkmcnt(2)
  v_mfma_f32_32x32x16_bf16 v[32:47], v[16:19], v[8:11], 0
  v_exp_f32 v52, v52
  v_exp_f32 v53, v53
  v_cvt_pk_bf16_f32 v65, v50, v51
  v_exp_f32 v54, v54
  v_exp_f32 v55, v55
  v_mfma_f32_32x32x8_bf16 v[32:47], v[20:21], v[12:13], v[32:47]
  ds_read_b128 v[16:19], v4 offset:7296
  s_add_u32 m0, s17, 65536
  s_add_u32 s18, s16, 65536
  buffer_load_dwordx4 v1, s[44:47], s18 offen lds
  ds_read_b32 v20, v5 offset:7296
  v_cvt_pk_bf16_f32 v66, v52, v53
  v_exp_f32 v56, v56
  v_cvt_pk_bf16_f32 v67, v54, v55
  v_exp_f32 v57, v57
  v_exp_f32 v58, v58
  s_waitcnt lgkmcnt(2)
  v_mfma_f32_32x32x16_bf16 v[72:87], v[24:27], v[64:67], v[72:87]
  v_exp_f32 v59, v59
  v_cvt_pk_bf16_f32 v68, v56, v57
  v_exp_f32 v60, v60
  v_exp_f32 v61, v61
  v_cvt_pk_bf16_f32 v69, v58, v59
  v_exp_f32 v62, v62
  v_exp_f32 v63, v63
  v_cvt_pk_bf16_f32 v70, v60, v61
  v_cvt_pk_bf16_f32 v71, v62, v63
  v_exp_f32 v32, v32
  v_exp_f32 v33, v33
  v_mfma_f32_32x32x16_bf16 v[72:87], v[28:31], v[68:71], v[72:87]
  ds_read_b128 v[24:27], v6 offset:4864
  ds_read_b128 v[28:31], v6 offset:5504
  s_add_u32 m0, s17, 73728
  s_add_u32 s18, s16, 73728
  buffer_load_dwordx4 v1, s[44:47], s18 offen lds
  s_add_u32 m0, s17, 81920
  s_add_u32 s18, s16, 81920
  buffer_load_dwordx4 v1, s[44:47], s18 offen lds
  v_exp_f32 v34, v34
  v_exp_f32 v35, v35
  v_cvt_pk_bf16_f32 v64, v32, v33
  s_waitcnt lgkmcnt(2)
  v_mfma_f32_32x32x16_bf16 v[48:63], v[16:19], v[8:11], 0
  v_exp_f32 v36, v36
  v_exp_f32 v37, v37
  v_cvt_pk_bf16_f32 v65, v34, v35
  v_exp_f32 v38, v38
  v_exp_f32 v39, v39
  v_mfma_f32_32x32x8_bf16 v[48:63], v[20:21], v[12:13], v[48:63]
  ds_read_b128 v[16:19], v4 offset:9728
  s_add_u32 m0, s17, 90112
  s_add_u32 s18, s16, 90112
  buffer_load_dwordx4 v1, s[44:47], s18 offen lds
  ds_read_b32 v20, v5 offset:9728
  v_cvt_pk_bf16_f32 v66, v36, v37
  v_exp_f32 v40, v40
  v_cvt_pk_bf16_f32 v67, v38, v39
  v_exp_f32 v41, v41
  v_exp_f32 v42, v42
  s_waitcnt lgkmcnt(2)
  v_mfma_f32_32x32x16_bf16 v[72:87], v[24:27], v[64:67], v[72:87]
  v_exp_f32 v43, v43
  v_cvt_pk_bf16_f32 v68, v40, v41
  v_exp_f32 v44, v44
  v_exp_f32 v45, v45
  v_cvt_pk_bf16_f32 v69, v42, v43
  v_exp_f32 v46, v46
  v_exp_f32 v47, v47
  v_cvt_pk_bf16_f32 v70, v44, v45
  v_cvt_pk_bf16_f32 v71, v46, v47
  v_exp_f32 v48, v48
  v_exp_f32 v49, v49
  v_mfma_f32_32x32x16_bf16 v[72:87], v[28:31], v[68:71], v[72:87]
  ds_read_b128 v[24:27], v6 offset:7296
  ds_read_b128 v[28:31], v6 offset:7936
  s_add_u32 m0, s17, 98304
  s_add_u32 s18, s16, 98304
  buffer_load_dwordx4 v1, s[44:47], s18 offen lds
  s_add_u32 s18, s3, 104
  s_min_u32 s18, s18, 109
  s_lshl_b32 s18, s18, 10
  v_exp_f32 v50, v50
  v_exp_f32 v51, v51
  v_cvt_pk_bf16_f32 v64, v48, v49
  s_waitcnt lgkmcnt(2)
  v_mfma_f32_32x32x16_bf16 v[32:47], v[16:19], v[8:11], 0
  v_exp_f32 v52, v52
  v_exp_f32 v53, v53
  v_cvt_pk_bf16_f32 v65, v50, v51
  v_exp_f32 v54, v54
  v_exp_f32 v55, v55
  v_mfma_f32_32x32x8_bf16 v[32:47], v[20:21], v[12:13], v[32:47]
  ds_read_b128 v[16:19], v4 offset:12160
  s_mov_b32 m0, s18
  s_add_u32 s18, s18, s19
  buffer_load_dwordx4 v1, s[44:47], s18 offen lds
  ds_read_b32 v20, v5 offset:12160
  v_cvt_pk_bf16_f32 v66, v52, v53
  v_exp_f32 v56, v56
  v_cvt_pk_bf16_f32 v67, v54, v55
  v_exp_f32 v57, v57
  v_exp_f32 v58, v58
  s_waitcnt lgkmcnt(2)
  v_mfma_f32_32x32x16_bf16 v[72:87], v[24:27], v[64:67], v[72:87]
  v_exp_f32 v59, v59
  v_cvt_pk_bf16_f32 v68, v56, v57
  v_exp_f32 v60, v60
  v_exp_f32 v61, v61
  v_cvt_pk_bf16_f32 v69, v58, v59
  v_exp_f32 v62, v62
  v_exp_f32 v63, v63
  v_cvt_pk_bf16_f32 v70, v60, v61
  v_cvt_pk_bf16_f32 v71, v62, v63
  v_exp_f32 v32, v32
  v_exp_f32 v33, v33
  v_mfma_f32_32x32x16_bf16 v[72:87], v[28:31], v[68:71], v[72:87]
  ds_read_b128 v[24:27], v6 offset:9728
  ds_read_b128 v[28:31], v6 offset:10368
  v_exp_f32 v34, v34
  v_exp_f32 v35, v35
  v_cvt_pk_bf16_f32 v64, v32, v33
  s_waitcnt lgkmcnt(2)
  v_mfma_f32_32x32x16_bf16 v[48:63], v[16:19], v[8:11], 0
  v_exp_f32 v36, v36
  v_exp_f32 v37, v37
  v_cvt_pk_bf16_f32 v65, v34, v35
  v_exp_f32 v38, v38
  v_exp_f32 v39, v39
  v_mfma_f32_32x32x8_bf16 v[48:63], v[20:21], v[12:13], v[48:63]
  ds_read_b128 v[16:19], v4 offset:14592
  ds_read_b32 v20, v5 offset:14592
  v_cvt_pk_bf16_f32 v66, v36, v37
  v_exp_f32 v40, v40
  v_cvt_pk_bf16_f32 v67, v38, v39
  v_exp_f32 v41, v41
  v_exp_f32 v42, v42
  s_waitcnt lgkmcnt(2)
  v_mfma_f32_32x32x16_bf16 v[72:87], v[24:27], v[64:67], v[72:87]
  v_exp_f32 v43, v43
  v_cvt_pk_bf16_f32 v68, v40, v41
  v_exp_f32 v44, v44
  v_exp_f32 v45, v45
  v_cvt_pk_bf16_f32 v69, v42, v43
  v_exp_f32 v46, v46
  v_exp_f32 v47, v47
  v_cvt_pk_bf16_f32 v70, v44, v45
  v_cvt_pk_bf16_f32 v71, v46, v47
  v_exp_f32 v48, v48
  v_exp_f32 v49, v49
  v_mfma_f32_32x32x16_bf16 v[72:87], v[28:31], v[68:71], v[72:87]
  ds_read_b128 v[24:27], v6 offset:12160
  ds_read_b128 v[28:31], v6 offset:12800
  v_exp_f32 v50, v50
  v_exp_f32 v51, v51
  v_cvt_pk_bf16_f32 v64, v48, v49
  s_waitcnt lgkmcnt(2)
  v_mfma_f32_32x32x16_bf16 v[32:47], v[16:19], v[8:11], 0
  v_exp_f32 v52, v52
  v_exp_f32 v53, v53
  v_cvt_pk_bf16_f32 v65, v50, v51
  v_exp_f32 v54, v54
  v_exp_f32 v55, v55
  v_mfma_f32_32x32x8_bf16 v[32:47], v[20:21], v[12:13], v[32:47]
  ds_read_b128 v[16:19], v4 offset:17024
  ds_read_b32 v20, v5 offset:17024
  v_cvt_pk_bf16_f32 v66, v52, v53
  v_exp_f32 v56, v56
  v_cvt_pk_bf16_f32 v67, v54, v55
  v_exp_f32 v57, v57
  v_exp_f32 v58, v58
  s_waitcnt lgkmcnt(2)
  v_mfma_f32_32x32x16_bf16 v[72:87], v[24:27], v[64:67], v[72:87]
  v_exp_f32 v59, v59
  v_cvt_pk_bf16_f32 v68, v56, v57
  v_exp_f32 v60, v60
  v_exp_f32 v61, v61
  v_cvt_pk_bf16_f32 v69, v58, v59
  v_exp_f32 v62, v62
  v_exp_f32 v63, v63
  v_cvt_pk_bf16_f32 v70, v60, v61
  v_cvt_pk_bf16_f32 v71, v62, v63
  v_exp_f32 v32, v32
  v_exp_f32 v33, v33
  v_mfma_f32_32x32x16_bf16 v[72:87], v[28:31], v[68:71], v[72:87]
  ds_read_b128 v[24:27], v6 offset:14592
  ds_read_b128 v[28:31], v6 offset:15232
  v_exp_f32 v34, v34
  v_exp_f32 v35, v35
  v_cvt_pk_bf16_f32 v64, v32, v33
  s_waitcnt lgkmcnt(2)
  v_mfma_f32_32x32x16_bf16 v[48:63], v[16:19], v[8:11], 0
  v_exp_f32 v36, v36
  v_exp_f32 v37, v37
  v_cvt_pk_bf16_f32 v65, v34, v35
  v_exp_f32 v38, v38
  v_exp_f32 v39, v39
  v_mfma_f32_32x32x8_bf16 v[48:63], v[20:21], v[12:13], v[48:63]
  ds_read_b128 v[16:19], v4 offset:19456
  ds_read_b32 v20, v5 offset:19456
  v_cvt_pk_bf16_f32 v66, v36, v37
  v_exp_f32 v40, v40
  v_cvt_pk_bf16_f32 v67, v38, v39
  v_exp_f32 v41, v41
  v_exp_f32 v42, v42
  s_waitcnt lgkmcnt(2)
  v_mfma_f32_32x32x16_bf16 v[72:87], v[24:27], v[64:67], v[72:87]
  v_exp_f32 v43, v43
  v_cvt_pk_bf16_f32 v68, v40, v41
  v_exp_f32 v44, v44
  v_exp_f32 v45, v45
  v_cvt_pk_bf16_f32 v69, v42, v43
  v_exp_f32 v46, v46
  v_exp_f32 v47, v47
  v_cvt_pk_bf16_f32 v70, v44, v45
  v_cvt_pk_bf16_f32 v71, v46, v47
  v_exp_f32 v48, v48
  v_exp_f32 v49, v49
  v_mfma_f32_32x32x16_bf16 v[72:87], v[28:31], v[68:71], v[72:87]
  ds_read_b128 v[24:27], v6 offset:17024
  ds_read_b128 v[28:31], v6 offset:17664
  v_exp_f32 v50, v50
  v_exp_f32 v51, v51
  v_cvt_pk_bf16_f32 v64, v48, v49
  s_waitcnt lgkmcnt(2)
  v_mfma_f32_32x32x16_bf16 v[32:47], v[16:19], v[8:11], 0
  v_exp_f32 v52, v52
  v_exp_f32 v53, v53
  v_cvt_pk_bf16_f32 v65, v50, v51
  v_exp_f32 v54, v54
  v_exp_f32 v55, v55
  v_mfma_f32_32x32x8_bf16 v[32:47], v[20:21], v[12:13], v[32:47]
  ds_read_b128 v[16:19], v4 offset:21888
  ds_read_b32 v20, v5 offset:21888
  v_cvt_pk_bf16_f32 v66, v52, v53
  v_exp_f32 v56, v56
  v_cvt_pk_bf16_f32 v67, v54, v55
  v_exp_f32 v57, v57
  v_exp_f32 v58, v58
  s_waitcnt lgkmcnt(2)
  v_mfma_f32_32x32x16_bf16 v[72:87], v[24:27], v[64:67], v[72:87]
  v_exp_f32 v59, v59
  v_cvt_pk_bf16_f32 v68, v56, v57
  v_exp_f32 v60, v60
  v_exp_f32 v61, v61
  v_cvt_pk_bf16_f32 v69, v58, v59
  v_exp_f32 v62, v62
  v_exp_f32 v63, v63
  v_cvt_pk_bf16_f32 v70, v60, v61
  v_cvt_pk_bf16_f32 v71, v62, v63
  v_add_u32 v4, 19456, v4
  v_add_u32 v5, 19456, v5
  v_add_u32 v6, 19456, v6
  s_waitcnt vmcnt(0)
  s_barrier
  s_mov_b32 s20, 1
.p2align 6
k2_attn_loop:
  v_exp_f32 v32, v32
  v_exp_f32 v33, v33
  v_mfma_f32_32x32x16_bf16 v[72:87], v[28:31], v[68:71], v[72:87]
  ds_read_b128 v[24:27], v6 offset:0
  ds_read_b128 v[28:31], v6 offset:640
  v_exp_f32 v34, v34
  v_exp_f32 v35, v35
  v_cvt_pk_bf16_f32 v64, v32, v33
  s_waitcnt lgkmcnt(2)
  v_mfma_f32_32x32x16_bf16 v[48:63], v[16:19], v[8:11], 0
  v_exp_f32 v36, v36
  v_exp_f32 v37, v37
  v_cvt_pk_bf16_f32 v65, v34, v35
  v_exp_f32 v38, v38
  v_exp_f32 v39, v39
  v_mfma_f32_32x32x8_bf16 v[48:63], v[20:21], v[12:13], v[48:63]
  ds_read_b128 v[16:19], v4 offset:4864
  ds_read_b32 v20, v5 offset:4864
  v_cvt_pk_bf16_f32 v66, v36, v37
  v_exp_f32 v40, v40
  v_cvt_pk_bf16_f32 v67, v38, v39
  v_exp_f32 v41, v41
  v_exp_f32 v42, v42
  s_waitcnt lgkmcnt(2)
  v_mfma_f32_32x32x16_bf16 v[72:87], v[24:27], v[64:67], v[72:87]
  v_exp_f32 v43, v43
  v_cvt_pk_bf16_f32 v68, v40, v41
  v_exp_f32 v44, v44
  v_exp_f32 v45, v45
  v_cvt_pk_bf16_f32 v69, v42, v43
  v_exp_f32 v46, v46
  v_exp_f32 v47, v47
  v_cvt_pk_bf16_f32 v70, v44, v45
  v_cvt_pk_bf16_f32 v71, v46, v47
  v_exp_f32 v48, v48
  v_exp_f32 v49, v49
  v_mfma_f32_32x32x16_bf16 v[72:87], v[28:31], v[68:71], v[72:87]
  ds_read_b128 v[24:27], v6 offset:2432
  ds_read_b128 v[28:31], v6 offset:3072
  v_exp_f32 v50, v50
  v_exp_f32 v51, v51
  v_cvt_pk_bf16_f32 v64, v48, v49
  s_waitcnt lgkmcnt(2)
  v_mfma_f32_32x32x16_bf16 v[32:47], v[16:19], v[8:11], 0
  v_exp_f32 v52, v52
  v_exp_f32 v53, v53
  v_cvt_pk_bf16_f32 v65, v50, v51
  v_exp_f32 v54, v54
  v_exp_f32 v55, v55
  v_mfma_f32_32x32x8_bf16 v[32:47], v[20:21], v[12:13], v[32:47]
  ds_read_b128 v[16:19], v4 offset:7296
  ds_read_b32 v20, v5 offset:7296
  v_cvt_pk_bf16_f32 v66, v52, v53
  v_exp_f32 v56, v56
  v_cvt_pk_bf16_f32 v67, v54, v55
  v_exp_f32 v57, v57
  v_exp_f32 v58, v58
  s_waitcnt lgkmcnt(2)
  v_mfma_f32_32x32x16_bf16 v[72:87], v[24:27], v[64:67], v[72:87]
  v_exp_f32 v59, v59
  v_cvt_pk_bf16_f32 v68, v56, v57
  v_exp_f32 v60, v60
  v_exp_f32 v61, v61
  v_cvt_pk_bf16_f32 v69, v58, v59
  v_exp_f32 v62, v62
  v_exp_f32 v63, v63
  v_cvt_pk_bf16_f32 v70, v60, v61
  v_cvt_pk_bf16_f32 v71, v62, v63
  v_exp_f32 v32, v32
  v_exp_f32 v33, v33
  v_mfma_f32_32x32x16_bf16 v[72:87], v[28:31], v[68:71], v[72:87]
  ds_read_b128 v[24:27], v6 offset:4864
  ds_read_b128 v[28:31], v6 offset:5504
  v_exp_f32 v34, v34
  v_exp_f32 v35, v35
  v_cvt_pk_bf16_f32 v64, v32, v33
  s_waitcnt lgkmcnt(2)
  v_mfma_f32_32x32x16_bf16 v[48:63], v[16:19], v[8:11], 0
  v_exp_f32 v36, v36
  v_exp_f32 v37, v37
  v_cvt_pk_bf16_f32 v65, v34, v35
  v_exp_f32 v38, v38
  v_exp_f32 v39, v39
  v_mfma_f32_32x32x8_bf16 v[48:63], v[20:21], v[12:13], v[48:63]
  ds_read_b128 v[16:19], v4 offset:9728
  ds_read_b32 v20, v5 offset:9728
  v_cvt_pk_bf16_f32 v66, v36, v37
  v_exp_f32 v40, v40
  v_cvt_pk_bf16_f32 v67, v38, v39
  v_exp_f32 v41, v41
  v_exp_f32 v42, v42
  s_waitcnt lgkmcnt(2)
  v_mfma_f32_32x32x16_bf16 v[72:87], v[24:27], v[64:67], v[72:87]
  v_exp_f32 v43, v43
  v_cvt_pk_bf16_f32 v68, v40, v41
  v_exp_f32 v44, v44
  v_exp_f32 v45, v45
  v_cvt_pk_bf16_f32 v69, v42, v43
  v_exp_f32 v46, v46
  v_exp_f32 v47, v47
  v_cvt_pk_bf16_f32 v70, v44, v45
  v_cvt_pk_bf16_f32 v71, v46, v47
  v_exp_f32 v48, v48
  v_exp_f32 v49, v49
  v_mfma_f32_32x32x16_bf16 v[72:87], v[28:31], v[68:71], v[72:87]
  ds_read_b128 v[24:27], v6 offset:7296
  ds_read_b128 v[28:31], v6 offset:7936
  v_exp_f32 v50, v50
  v_exp_f32 v51, v51
  v_cvt_pk_bf16_f32 v64, v48, v49
  s_waitcnt lgkmcnt(2)
  v_mfma_f32_32x32x16_bf16 v[32:47], v[16:19], v[8:11], 0
  v_exp_f32 v52, v52
  v_exp_f32 v53, v53
  v_cvt_pk_bf16_f32 v65, v50, v51
  v_exp_f32 v54, v54
  v_exp_f32 v55, v55
  v_mfma_f32_32x32x8_bf16 v[32:47], v[20:21], v[12:13], v[32:47]
  ds_read_b128 v[16:19], v4 offset:12160
  ds_read_b32 v20, v5 offset:12160
  v_cvt_pk_bf16_f32 v66, v52, v53
  v_exp_f32 v56, v56
  v_cvt_pk_bf16_f32 v67, v54, v55
  v_exp_f32 v57, v57
  v_exp_f32 v58, v58
  s_waitcnt lgkmcnt(2)
  v_mfma_f32_32x32x16_bf16 v[72:87], v[24:27], v[64:67], v[72:87]
  v_exp_f32 v59, v59
  v_cvt_pk_bf16_f32 v68, v56, v57
  v_exp_f32 v60, v60
  v_exp_f32 v61, v61
  v_cvt_pk_bf16_f32 v69, v58, v59
  v_exp_f32 v62, v62
  v_exp_f32 v63, v63
  v_cvt_pk_bf16_f32 v70, v60, v61
  v_cvt_pk_bf16_f32 v71, v62, v63
  v_exp_f32 v32, v32
  v_exp_f32 v33, v33
  v_mfma_f32_32x32x16_bf16 v[72:87], v[28:31], v[68:71], v[72:87]
  ds_read_b128 v[24:27], v6 offset:9728
  ds_read_b128 v[28:31], v6 offset:10368
  v_exp_f32 v34, v34
  v_exp_f32 v35, v35
  v_cvt_pk_bf16_f32 v64, v32, v33
  s_waitcnt lgkmcnt(2)
  v_mfma_f32_32x32x16_bf16 v[48:63], v[16:19], v[8:11], 0
  v_exp_f32 v36, v36
  v_exp_f32 v37, v37
  v_cvt_pk_bf16_f32 v65, v34, v35
  v_exp_f32 v38, v38
  v_exp_f32 v39, v39
  v_mfma_f32_32x32x8_bf16 v[48:63], v[20:21], v[12:13], v[48:63]
  ds_read_b128 v[16:19], v4 offset:14592
  ds_read_b32 v20, v5 offset:14592
  v_cvt_pk_bf16_f32 v66, v36, v37
  v_exp_f32 v40, v40
  v_cvt_pk_bf16_f32 v67, v38, v39
  v_exp_f32 v41, v41
  v_exp_f32 v42, v42
  s_waitcnt lgkmcnt(2)
  v_mfma_f32_32x32x16_bf16 v[72:87], v[24:27], v[64:67], v[72:87]
  v_exp_f32 v43, v43
  v_cvt_pk_bf16_f32 v68, v40, v41
  v_exp_f32 v44, v44
  v_exp_f32 v45, v45
  v_cvt_pk_bf16_f32 v69, v42, v43
  v_exp_f32 v46, v46
  v_exp_f32 v47, v47
  v_cvt_pk_bf16_f32 v70, v44, v45
  v_cvt_pk_bf16_f32 v71, v46, v47
  v_exp_f32 v48, v48
  v_exp_f32 v49, v49
  v_mfma_f32_32x32x16_bf16 v[72:87], v[28:31], v[68:71], v[72:87]
  ds_read_b128 v[24:27], v6 offset:12160
  ds_read_b128 v[28:31], v6 offset:12800
  v_exp_f32 v50, v50
  v_exp_f32 v51, v51
  v_cvt_pk_bf16_f32 v64, v48, v49
  s_waitcnt lgkmcnt(2)
  v_mfma_f32_32x32x16_bf16 v[32:47], v[16:19], v[8:11], 0
  v_exp_f32 v52, v52
  v_exp_f32 v53, v53
  v_cvt_pk_bf16_f32 v65, v50, v51
  v_exp_f32 v54, v54
  v_exp_f32 v55, v55
  v_mfma_f32_32x32x8_bf16 v[32:47], v[20:21], v[12:13], v[32:47]
  ds_read_b128 v[16:19], v4 offset:17024
  ds_read_b32 v20, v5 offset:17024
  v_cvt_pk_bf16_f32 v66, v52, v53
  v_exp_f32 v56, v56
  v_cvt_pk_bf16_f32 v67, v54, v55
  v_exp_f32 v57, v57
  v_exp_f32 v58, v58
  s_waitcnt lgkmcnt(2)
  v_mfma_f32_32x32x16_bf16 v[72:87], v[24:27], v[64:67], v[72:87]
  v_exp_f32 v59, v59
  v_cvt_pk_bf16_f32 v68, v56, v57
  v_exp_f32 v60, v60
  v_exp_f32 v61, v61
  v_cvt_pk_bf16_f32 v69, v58, v59
  v_exp_f32 v62, v62
  v_exp_f32 v63, v63
  v_cvt_pk_bf16_f32 v70, v60, v61
  v_cvt_pk_bf16_f32 v71, v62, v63
  v_exp_f32 v32, v32
  v_exp_f32 v33, v33
  v_mfma_f32_32x32x16_bf16 v[72:87], v[28:31], v[68:71], v[72:87]
  ds_read_b128 v[24:27], v6 offset:14592
  ds_read_b128 v[28:31], v6 offset:15232
  v_exp_f32 v34, v34
  v_exp_f32 v35, v35
  v_cvt_pk_bf16_f32 v64, v32, v33
  s_waitcnt lgkmcnt(2)
  v_mfma_f32_32x32x16_bf16 v[48:63], v[16:19], v[8:11], 0
  v_exp_f32 v36, v36
  v_exp_f32 v37, v37
  v_cvt_pk_bf16_f32 v65, v34, v35
  v_exp_f32 v38, v38
  v_exp_f32 v39, v39
  v_mfma_f32_32x32x8_bf16 v[48:63], v[20:21], v[12:13], v[48:63]
  ds_read_b128 v[16:19], v4 offset:19456
  ds_read_b32 v20, v5 offset:19456
  v_cvt_pk_bf16_f32 v66, v36, v37
  v_exp_f32 v40, v40
  v_cvt_pk_bf16_f32 v67, v38, v39
  v_exp_f32 v41, v41
  v_exp_f32 v42, v42
  s_waitcnt lgkmcnt(2)
  v_mfma_f32_32x32x16_bf16 v[72:87], v[24:27], v[64:67], v[72:87]
  v_exp_f32 v43, v43
  v_cvt_pk_bf16_f32 v68, v40, v41
  v_exp_f32 v44, v44
  v_exp_f32 v45, v45
  v_cvt_pk_bf16_f32 v69, v42, v43
  v_exp_f32 v46, v46
  v_exp_f32 v47, v47
  v_cvt_pk_bf16_f32 v70, v44, v45
  v_cvt_pk_bf16_f32 v71, v46, v47
  v_exp_f32 v48, v48
  v_exp_f32 v49, v49
  v_mfma_f32_32x32x16_bf16 v[72:87], v[28:31], v[68:71], v[72:87]
  ds_read_b128 v[24:27], v6 offset:17024
  ds_read_b128 v[28:31], v6 offset:17664
  v_exp_f32 v50, v50
  v_exp_f32 v51, v51
  v_cvt_pk_bf16_f32 v64, v48, v49
  s_waitcnt lgkmcnt(2)
  v_mfma_f32_32x32x16_bf16 v[32:47], v[16:19], v[8:11], 0
  v_exp_f32 v52, v52
  v_exp_f32 v53, v53
  v_cvt_pk_bf16_f32 v65, v50, v51
  v_exp_f32 v54, v54
  v_exp_f32 v55, v55
  v_mfma_f32_32x32x8_bf16 v[32:47], v[20:21], v[12:13], v[32:47]
  ds_read_b128 v[16:19], v4 offset:21888
  ds_read_b32 v20, v5 offset:21888
  v_cvt_pk_bf16_f32 v66, v52, v53
  v_exp_f32 v56, v56
  v_cvt_pk_bf16_f32 v67, v54, v55
  v_exp_f32 v57, v57
  v_exp_f32 v58, v58
  s_waitcnt lgkmcnt(2)
  v_mfma_f32_32x32x16_bf16 v[72:87], v[24:27], v[64:67], v[72:87]
  v_exp_f32 v59, v59
  v_cvt_pk_bf16_f32 v68, v56, v57
  v_exp_f32 v60, v60
  v_exp_f32 v61, v61
  v_cvt_pk_bf16_f32 v69, v58, v59
  v_exp_f32 v62, v62
  v_exp_f32 v63, v63
  v_cvt_pk_bf16_f32 v70, v60, v61
  v_cvt_pk_bf16_f32 v71, v62, v63
  v_add_u32 v4, 19456, v4
  v_add_u32 v5, 19456, v5
  v_add_u32 v6, 19456, v6
  s_sub_u32 s21, s20, 3
  s_cmp_lt_u32 s21, 2
  s_cbranch_scc0 k2_attn_nob_1
  s_barrier
k2_attn_nob_1:
  s_add_u32 s20, s20, 1
  s_cmp_lt_u32 s20, 8
  s_cbranch_scc1 k2_attn_loop
k2_attn_after:
  s_setprio 0
  v_mfma_f32_32x32x16_bf16 v[72:87], v[28:31], v[68:71], v[72:87]
  s_waitcnt lgkmcnt(0)
  s_nop 10
  v_mov_b32 v32, v82
  v_mov_b32 v33, v82
  s_nop 1
  v_permlane32_swap_b32 v32, v33
  s_nop 1
  v_add_f32 v37, |v72|, |v73|
  v_add_f32 v38, |v74|, |v75|
  v_add_f32 v39, |v76|, |v77|
  v_add_f32 v40, |v78|, |v79|
  v_add_f32 v41, |v80|, |v81|
  v_mov_b32 v34, 0x1f800000
  v_mov_b32 v35, 0x5f800000
  v_mov_b32 v36, 0x7e800000
  v_add_f32 v37, v37, v38
  v_add_f32 v39, v39, v40
  v_add_f32 v37, v37, v41
  v_add_f32 v37, v37, v39
  v_cmp_ge_f32 s[22:23], v32, v34
  v_cmp_le_f32 s[24:25], v32, v35
  v_cmp_lt_f32 s[26:27], v37, v36
  s_nop 1
  s_and_b64 s[22:23], s[22:23], s[24:25]
  s_and_b64 s[22:23], s[22:23], s[26:27]
  s_cmp_eq_u64 s[22:23], -1
  s_cbranch_scc0 k2_attn_slow
k2_attn_fin:
  v_rcp_f32 v33, v32
  s_nop 0
  v_mul_f32 v72, v72, v33
  v_mul_f32 v73, v73, v33
  v_mul_f32 v74, v74, v33
  v_mul_f32 v75, v75, v33
  v_mul_f32 v76, v76, v33
  v_mul_f32 v77, v77, v33
  v_mul_f32 v78, v78, v33
  v_mul_f32 v79, v79, v33
  v_mul_f32 v80, v80, v33
  v_mul_f32 v81, v81, v33
  v_cvt_pk_bf16_f32 v40, v72, v73
  v_cvt_pk_bf16_f32 v41, v74, v75
  v_cvt_pk_bf16_f32 v42, v76, v77
  v_cvt_pk_bf16_f32 v43, v78, v79
  v_cvt_pk_bf16_f32 v44, v80, v81
  s_mul_i32 s14, s13, 36864
  s_lshl_b32 s15, s12, 10
  s_add_u32 s15, s15, s14
  s_add_u32 s15, s15, 58720256
  buffer_store_dwordx4 v[40:43], v1, s[44:47], s15 offen
  s_lshr_b32 s16, s12, 3
  s_add_u32 s16, s16, 32
  s_lshl_b32 s16, s16, 10
  s_add_u32 s16, s16, s14
  s_lshr_b32 s17, s12, 2
  s_and_b32 s17, s17, 1
  s_lshl_b32 s17, s17, 9
  s_add_u32 s16, s16, s17
  s_and_b32 s17, s12, 3
  s_lshl_b32 s17, s17, 2
  s_add_u32 s16, s16, s17
  s_add_u32 s16, s16, 58720256
  v_lshlrev_b32 v7, 4, v2
  v_mov_b32 v93, 0x7f000000
  v_cmp_gt_u32 vcc, 32, v0
  s_nop 1
  v_cndmask_b32 v93, v93, v7, vcc
  buffer_store_dword v44, v93, s[44:47], s16 offen
  s_branch k2_attn_end
k2_attn_slow:
  v_mov_b32 v4, v1
  v_lshlrev_b32 v7, 2, v2
  v_add_u32 v5, 2304, v7
  v_mul_u32_u24 v94, 320, v3
  v_min_u32 v95, 19, v2
  v_lshlrev_b32 v95, 4, v95
  v_add_u32 v94, v94, v95
  v_add_u32 v6, 1024, v94
  v_mov_b32 v90, 0xff7fffff
  s_mov_b32 s20, 0
  v_mov_b32 v72, 0
  v_mov_b32 v73, 0
  v_mov_b32 v74, 0
  v_mov_b32 v75, 0
  v_mov_b32 v76, 0
  v_mov_b32 v77, 0
  v_mov_b32 v78, 0
  v_mov_b32 v79, 0
  v_mov_b32 v80, 0
  v_mov_b32 v81, 0
  v_mov_b32 v82, 0
  v_mov_b32 v83, 0
  v_mov_b32 v84, 0
  v_mov_b32 v85, 0
  v_mov_b32 v86, 0
  v_mov_b32 v87, 0
k2_attn_sl:
  ds_read_b128 v[16:19], v4
  ds_read_b32 v20, v5
  ds_read_b128 v[24:27], v6
  ds_read_b128 v[28:31], v6 offset:640
  s_waitcnt lgkmcnt(0)
  v_mfma_f32_32x32x16_bf16 v[32:47], v[16:19], v[8:11], 0
  v_mfma_f32_32x32x8_bf16 v[32:47], v[20:21], v[12:13], v[32:47]
  s_nop 11
  v_max_f32 v91, v32, v33
  v_max3_f32 v91, v91, v34, v35
  v_max3_f32 v91, v91, v36, v37
  v_max3_f32 v91, v91, v38, v39
  v_max3_f32 v91, v91, v40, v41
  v_max3_f32 v91, v91, v42, v43
  v_max3_f32 v91, v91, v44, v45
  v_max3_f32 v91, v91, v46, v47
  v_mov_b32 v92, v91
  s_nop 1
  v_permlane32_swap_b32 v91, v92
  s_nop 1
  v_max3_f32 v91, v91, v92, v90
  v_sub_f32 v92, v90, v91
  v_exp_f32 v92, v92
  v_mov_b32 v90, v91
  s_nop 0
  v_mul_f32 v72, v72, v92
  v_mul_f32 v73, v73, v92
  v_mul_f32 v74, v74, v92
  v_mul_f32 v75, v75, v92
  v_mul_f32 v76, v76, v92
  v_mul_f32 v77, v77, v92
  v_mul_f32 v78, v78, v92
  v_mul_f32 v79, v79, v92
  v_mul_f32 v80, v80, v92
  v_mul_f32 v81, v81, v92
  v_mul_f32 v82, v82, v92
  v_mul_f32 v83, v83, v92
  v_mul_f32 v84, v84, v92
  v_mul_f32 v85, v85, v92
  v_mul_f32 v86, v86, v92
  v_mul_f32 v87, v87, v92
  v_sub_f32 v32, v32, v91
  v_sub_f32 v33, v33, v91
  v_sub_f32 v34, v34, v91
  v_sub_f32 v35, v35, v91
  v_sub_f32 v36, v36, v91
  v_sub_f32 v37, v37, v91
  v_sub_f32 v38, v38, v91
  v_sub_f32 v39, v39, v91
  v_sub_f32 v40, v40, v91
  v_sub_f32 v41, v41, v91
  v_sub_f32 v42, v42, v91
  v_sub_f32 v43, v43, v91
  v_sub_f32 v44, v44, v91
  v_sub_f32 v45, v45, v91
  v_sub_f32 v46, v46, v91
  v_sub_f32 v47, v47, v91
  v_exp_f32 v32, v32
  v_exp_f32 v33, v33
  v_exp_f32 v34, v34
  v_exp_f32 v35, v35
  v_exp_f32 v36, v36
  v_exp_f32 v37, v37
  v_exp_f32 v38, v38
  v_exp_f32 v39, v39
  v_exp_f32 v40, v40
  v_exp_f32 v41, v41
  v_exp_f32 v42, v42
  v_exp_f32 v43, v43
  v_exp_f32 v44, v44
  v_exp_f32 v45, v45
  v_exp_f32 v46, v46
  v_exp_f32 v47, v47
  s_nop 0
  v_cvt_pk_bf16_f32 v64, v32, v33
  v_cvt_pk_bf16_f32 v65, v34, v35
  v_cvt_pk_bf16_f32 v66, v36, v37
  v_cvt_pk_bf16_f32 v67, v38, v39
  v_cvt_pk_bf16_f32 v68, v40, v41
  v_cvt_pk_bf16_f32 v69, v42, v43
  v_cvt_pk_bf16_f32 v70, v44, v45
  v_cvt_pk_bf16_f32 v71, v46, v47
  s_nop 1
  v_mfma_f32_32x32x16_bf16 v[72:87], v[24:27], v[64:67], v[72:87]
  v_mfma_f32_32x32x16_bf16 v[72:87], v[28:31], v[68:71], v[72:87]
  v_add_u32 v4, 2432, v4
  v_add_u32 v5, 2432, v5
  v_add_u32 v6, 2432, v6
  s_nop 9
  s_add_u32 s20, s20, 1
  s_cmp_lt_u32 s20, 64
  s_cbranch_scc1 k2_attn_sl
  s_nop 4
  v_mov_b32 v32, v82
  v_mov_b32 v33, v82
  s_nop 1
  v_permlane32_swap_b32 v32, v33
  s_nop 1
  s_branch k2_attn_fin
  s_branch k2_attn_end
k2_attn_help:
  s_sub_u32 s36, s3, 8
  s_sub_u32 s37, s16, s17
  s_add_u32 s38, s36, 110
  s_cmp_eq_u32 s34, 0
  s_cbranch_scc0 k2_attn_h1
  s_load_dwordx2 s[20:21], s[0:1], 16
  s_load_dwordx2 s[24:25], s[0:1], 32
  s_load_dwordx2 s[28:29], s[0:1], 40
  v_mov_b32 v4, 0x3f803f80
  v_lshrrev_b32 v5, 3, v0
  v_and_b32 v6, 7, v0
  v_lshlrev_b32 v6, 4, v6
  s_mul_i32 s31, s36, 12288
  s_add_u32 s31, s31, 112640
  v_lshrrev_b32 v15, 4, v0
  v_lshlrev_b32 v15, 2, v15
  v_lshrrev_b32 v16, 2, v0
  v_and_b32 v16, 3, v16
  v_add_u32 v15, v15, v16
  v_lshlrev_b32 v15, 7, v15
  v_and_b32 v16, 3, v0
  v_lshlrev_b32 v16, 3, v16
  v_add_u32 v15, v15, v16
  v_add_u32 v17, s31, v15
  s_waitcnt lgkmcnt(0)
  s_setprio 3
  s_barrier
  s_barrier
  s_cmp_lt_u32 s2, 144
  s_cbranch_scc1 k2_attn_wc_w1i
  s_cmp_lt_u32 s2, 252
  s_cbranch_scc1 k2_attn_wc_w2i
  s_branch k2_attn_wc_issued
k2_attn_wc_w1i:
  s_mov_b32 s40, s24
  s_mov_b32 s41, s25
  s_mov_b32 s42, 0x510000
  s_mov_b32 s43, 0x20000
  s_lshr_b32 s14, s2, 1
  s_and_b32 s15, s2, 1
  s_mul_i32 s15, s15, 9
  s_add_u32 s35, s15, s36
  s_add_u32 s39, s15, 9
  s_movk_i32 s15, 9216
  v_mul_lo_u32 v10, v5, s15
  v_add_u32 v10, v10, v6
  s_lshl_b32 s18, s14, 7
  s_mul_i32 s19, s35, 294912
  s_add_u32 s18, s18, s19
  s_mov_b32 s26, s31
  s_mov_b32 s23, s35
k2_attn_wc_w1l:
  s_add_u32 m0, s26, 0
  s_add_u32 s19, s18, 0
  buffer_load_dwordx4 v10, s[40:43], s19 offen lds
  s_add_u32 m0, s26, 1024
  s_add_u32 s19, s18, 73728
  buffer_load_dwordx4 v10, s[40:43], s19 offen lds
  s_add_u32 m0, s26, 2048
  s_add_u32 s19, s18, 147456
  buffer_load_dwordx4 v10, s[40:43], s19 offen lds
  s_add_u32 m0, s26, 3072
  s_add_u32 s19, s18, 221184
  buffer_load_dwordx4 v10, s[40:43], s19 offen lds
  s_add_u32 s26, s26, 4096
  s_add_u32 s18, s18, 1179648
  s_add_u32 s23, s23, 4
  s_cmp_lt_u32 s23, s39
  s_cbranch_scc1 k2_attn_wc_w1l
  s_cmp_ge_u32 s2, 108
  s_cbranch_scc1 k2_attn_wc_issued
  s_cmp_eq_u32 s36, 0
  s_cbranch_scc1 k2_attn_wc_issued
  s_mov_b32 s52, s20
  s_mov_b32 s53, s21
  s_mov_b32 s54, 0xa2000
  s_mov_b32 s55, 0x20000
  s_mul_i32 s22, s2, 3
  s_add_u32 s22, s22, s36
  s_sub_u32 s22, s22, 1
  s_mul_i32 s56, s22, 1821
  s_lshr_b32 s56, s56, 14
  s_mul_i32 s57, s56, 9
  s_sub_u32 s57, s22, s57
  v_add_u32 v11, 0, v5
  s_mul_i32 s18, s56, 18
  v_add_u32 v12, s18, v11
  v_lshrrev_b32 v13, 2, v11
  v_and_b32 v13, 1, v13
  v_lshlrev_b32 v13, 2, v13
  v_and_b32 v14, 3, v11
  v_add_u32 v14, 0, v14
  v_lshrrev_b32 v19, 1, v14
  v_add_u32 v13, v13, v19
  s_sub_u32 s18, s56, 32
  s_lshl_b32 s18, s18, 3
  v_add_u32 v13, s18, v13
  v_mul_u32_u24 v13, 18, v13
  v_and_b32 v14, 1, v14
  v_add_u32 v13, v13, v14
  v_add_u32 v13, 16, v13
  s_cmp_lt_u32 s56, 32
  s_cselect_b64 vcc, -1, 0
  v_cndmask_b32 v12, v13, v12, vcc
  s_movk_i32 s15, 1152
  v_mul_lo_u32 v12, v12, s15
  v_add_u32 v12, v12, v6
  s_lshl_b32 s19, s57, 7
  s_add_u32 m0, s31, 8192
  s_nop 0
  buffer_load_dwordx4 v12, s[52:55], s19 offen lds
  v_add_u32 v11, 8, v5
  s_mul_i32 s18, s56, 18
  v_add_u32 v12, s18, v11
  v_lshrrev_b32 v13, 2, v11
  v_and_b32 v13, 1, v13
  v_lshlrev_b32 v13, 2, v13
  v_and_b32 v14, 3, v11
  v_add_u32 v14, 4, v14
  v_lshrrev_b32 v19, 1, v14
  v_add_u32 v13, v13, v19
  s_sub_u32 s18, s56, 32
  s_lshl_b32 s18, s18, 3
  v_add_u32 v13, s18, v13
  v_mul_u32_u24 v13, 18, v13
  v_and_b32 v14, 1, v14
  v_add_u32 v13, v13, v14
  v_add_u32 v13, 16, v13
  s_cmp_lt_u32 s56, 32
  s_cselect_b64 vcc, -1, 0
  v_cndmask_b32 v12, v13, v12, vcc
  s_movk_i32 s15, 1152
  v_mul_lo_u32 v12, v12, s15
  v_add_u32 v12, v12, v6
  s_lshl_b32 s19, s57, 7
  s_add_u32 m0, s31, 9216
  s_nop 0
  buffer_load_dwordx4 v12, s[52:55], s19 offen lds
  s_branch k2_attn_wc_issued
k2_attn_wc_w2i:
  s_mov_b32 s40, s28
  s_mov_b32 s41, s29
  s_mov_b32 s42, 0x510000
  s_mov_b32 s43, 0x20000
  s_sub_u32 s14, s2, 144
  s_mul_i32 s14, s14, 12
  s_mul_i32 s15, s36, 3
  s_add_u32 s35, s14, s15
  s_movk_i32 s15, 1152
  v_mul_lo_u32 v10, v5, s15
  v_add_u32 v10, v10, v6
  s_mov_b32 s26, s31
  s_add_u32 s22, s35, 0
  s_mul_i32 s23, s22, 3641
  s_lshr_b32 s23, s23, 15
  s_mul_i32 s27, s23, 9
  s_sub_u32 s27, s22, s27
  s_mul_i32 s18, s23, 36864
  s_lshl_b32 s19, s27, 7
  s_add_u32 s18, s18, s19
  s_add_u32 m0, s31, 0
  s_add_u32 s19, s18, 0
  buffer_load_dwordx4 v10, s[40:43], s19 offen lds
  s_add_u32 m0, s31, 1024
  s_add_u32 s19, s18, 9216
  buffer_load_dwordx4 v10, s[40:43], s19 offen lds
  s_add_u32 m0, s31, 2048
  s_add_u32 s19, s18, 18432
  buffer_load_dwordx4 v10, s[40:43], s19 offen lds
  s_add_u32 m0, s31, 3072
  s_add_u32 s19, s18, 27648
  buffer_load_dwordx4 v10, s[40:43], s19 offen lds
  s_add_u32 s22, s35, 1
  s_mul_i32 s23, s22, 3641
  s_lshr_b32 s23, s23, 15
  s_mul_i32 s27, s23, 9
  s_sub_u32 s27, s22, s27
  s_mul_i32 s18, s23, 36864
  s_lshl_b32 s19, s27, 7
  s_add_u32 s18, s18, s19
  s_add_u32 m0, s31, 4096
  s_add_u32 s19, s18, 0
  buffer_load_dwordx4 v10, s[40:43], s19 offen lds
  s_add_u32 m0, s31, 5120
  s_add_u32 s19, s18, 9216
  buffer_load_dwordx4 v10, s[40:43], s19 offen lds
  s_add_u32 m0, s31, 6144
  s_add_u32 s19, s18, 18432
  buffer_load_dwordx4 v10, s[40:43], s19 offen lds
  s_add_u32 m0, s31, 7168
  s_add_u32 s19, s18, 27648
  buffer_load_dwordx4 v10, s[40:43], s19 offen lds
  s_add_u32 s22, s35, 2
  s_mul_i32 s23, s22, 3641
  s_lshr_b32 s23, s23, 15
  s_mul_i32 s27, s23, 9
  s_sub_u32 s27, s22, s27
  s_mul_i32 s18, s23, 36864
  s_lshl_b32 s19, s27, 7
  s_add_u32 s18, s18, s19
  s_add_u32 m0, s31, 8192
  s_add_u32 s19, s18, 0
  buffer_load_dwordx4 v10, s[40:43], s19 offen lds
  s_add_u32 m0, s31, 9216
  s_add_u32 s19, s18, 9216
  buffer_load_dwordx4 v10, s[40:43], s19 offen lds
  s_add_u32 m0, s31, 10240
  s_add_u32 s19, s18, 18432
  buffer_load_dwordx4 v10, s[40:43], s19 offen lds
  s_add_u32 m0, s31, 11264
  s_add_u32 s19, s18, 27648
  buffer_load_dwordx4 v10, s[40:43], s19 offen lds
k2_attn_wc_issued:
  s_waitcnt vmcnt(0)
  s_cmp_lt_u32 s2, 144
  s_cbranch_scc1 k2_attn_wc_w1p0
  s_cmp_lt_u32 s2, 252
  s_cbranch_scc1 k2_attn_wc_w2p0
  s_branch k2_attn_wc_done
k2_attn_wc_w1p0:
  s_mul_i32 s22, s14, 57
  s_lshr_b32 s22, s22, 9
  s_mul_i32 s23, s22, 9
  s_sub_u32 s23, s14, s23
  s_mul_i32 s26, s22, 1327104
  s_mul_i32 s27, s23, 18432
  s_add_u32 s26, s26, s27
  s_add_u32 s26, s26, 0
  s_mov_b32 s28, 0
  s_mul_i32 s28, s28, 9
  v_mov_b32 v40, 0
  v_mov_b32 v41, 0
  v_mov_b32 v42, 0
  v_mov_b32 v43, 0
  s_mov_b32 s27, s35
k2_attn_wc_w1p:
  ds_read_b64_tr_b16 v[20:21], v17 offset:0
  ds_read_b64_tr_b16 v[22:23], v17 offset:2048
  ds_read_b64_tr_b16 v[24:25], v17 offset:32
  ds_read_b64_tr_b16 v[26:27], v17 offset:2080
  ds_read_b64_tr_b16 v[28:29], v17 offset:64
  ds_read_b64_tr_b16 v[30:31], v17 offset:2112
  ds_read_b64_tr_b16 v[32:33], v17 offset:96
  ds_read_b64_tr_b16 v[34:35], v17 offset:2144
  s_add_u32 s29, s27, s28
  s_sub_u32 s33, s29, 18
  s_cmp_ge_u32 s29, 18
  s_cselect_b32 s29, s33, s29
  s_lshl_b32 s29, s29, 10
  s_add_u32 s29, s29, s26
  s_waitcnt lgkmcnt(0)
  s_add_u32 s19, s29, 0
  buffer_store_dwordx4 v[20:23], v1, s[8:11], s19 offen sc1
  v_dot2c_f32_bf16 v40, v20, v4
  v_dot2c_f32_bf16 v40, v21, v4
  v_dot2c_f32_bf16 v40, v22, v4
  v_dot2c_f32_bf16 v40, v23, v4
  s_add_u32 s19, s29, 331776
  buffer_store_dwordx4 v[24:27], v1, s[8:11], s19 offen sc1
  v_dot2c_f32_bf16 v41, v24, v4
  v_dot2c_f32_bf16 v41, v25, v4
  v_dot2c_f32_bf16 v41, v26, v4
  v_dot2c_f32_bf16 v41, v27, v4
  s_add_u32 s19, s29, 663552
  buffer_store_dwordx4 v[28:31], v1, s[8:11], s19 offen sc1
  v_dot2c_f32_bf16 v42, v28, v4
  v_dot2c_f32_bf16 v42, v29, v4
  v_dot2c_f32_bf16 v42, v30, v4
  v_dot2c_f32_bf16 v42, v31, v4
  s_add_u32 s19, s29, 995328
  buffer_store_dwordx4 v[32:35], v1, s[8:11], s19 offen sc1
  v_dot2c_f32_bf16 v43, v32, v4
  v_dot2c_f32_bf16 v43, v33, v4
  v_dot2c_f32_bf16 v43, v34, v4
  v_dot2c_f32_bf16 v43, v35, v4
  v_add_u32 v17, 4096, v17
  s_add_u32 s27, s27, 4
  s_cmp_lt_u32 s27, s39
  s_cbranch_scc1 k2_attn_wc_w1p
  s_nop 2
  v_mov_b32 v44, v40
  s_nop 1
  v_permlane16_swap_b32 v40, v44
  s_nop 1
  v_add_f32 v40, v40, v44
  v_mov_b32 v44, v40
  s_nop 1
  v_permlane32_swap_b32 v40, v44
  s_nop 1
  v_add_f32 v40, v40, v44
  v_mov_b32 v44, v41
  s_nop 1
  v_permlane16_swap_b32 v41, v44
  s_nop 1
  v_add_f32 v41, v41, v44
  v_mov_b32 v44, v41
  s_nop 1
  v_permlane32_swap_b32 v41, v44
  s_nop 1
  v_add_f32 v41, v41, v44
  v_mov_b32 v44, v42
  s_nop 1
  v_permlane16_swap_b32 v42, v44
  s_nop 1
  v_add_f32 v42, v42, v44
  v_mov_b32 v44, v42
  s_nop 1
  v_permlane32_swap_b32 v42, v44
  s_nop 1
  v_add_f32 v42, v42, v44
  v_mov_b32 v44, v43
  s_nop 1
  v_permlane16_swap_b32 v43, v44
  s_nop 1
  v_add_f32 v43, v43, v44
  v_mov_b32 v44, v43
  s_nop 1
  v_permlane32_swap_b32 v43, v44
  s_nop 1
  v_add_f32 v43, v43, v44
  v_lshrrev_b32 v45, 4, v0
  v_cmp_eq_u32 vcc, 1, v45
  s_nop 1
  v_cndmask_b32 v40, v40, v41, vcc
  v_cmp_eq_u32 vcc, 2, v45
  s_nop 1
  v_cndmask_b32 v40, v40, v42, vcc
  v_cmp_eq_u32 vcc, 3, v45
  s_nop 1
  v_cndmask_b32 v40, v40, v43, vcc
  v_lshlrev_b32 v14, 2, v0
  s_lshl_b32 s19, s36, 8
  s_add_u32 s19, s19, 162816
  v_add_u32 v15, s19, v14
  ds_write_b32 v15, v40
  s_cmp_ge_u32 s2, 108
  s_cbranch_scc1 k2_attn_wc_wdone
  s_cmp_eq_u32 s36, 0
  s_cbranch_scc1 k2_attn_wc_wdone
  v_lshrrev_b32 v8, 2, v0
  v_and_b32 v8, 3, v8
  v_lshlrev_b32 v9, 2, v3
  v_add_u32 v8, v8, v9
  v_lshlrev_b32 v8, 7, v8
  v_lshrrev_b32 v9, 4, v0
  v_and_b32 v9, 1, v9
  v_lshlrev_b32 v9, 5, v9
  v_add_u32 v8, v8, v9
  v_and_b32 v9, 3, v0
  v_lshlrev_b32 v9, 3, v9
  v_add_u32 v8, v8, v9
  s_add_u32 s19, s31, 8192
  v_add_u32 v7, s19, v8
  ds_read_b64_tr_b16 v[20:21], v7 offset:0
  ds_read_b64_tr_b16 v[22:23], v7 offset:1024
  ds_read_b64_tr_b16 v[24:25], v7 offset:64
  ds_read_b64_tr_b16 v[26:27], v7 offset:1088
  s_lshl_b32 s19, s57, 1
  s_mul_i32 s19, s19, 36864
  s_lshl_b32 s22, s56, 10
  s_add_u32 s19, s19, s22
  s_add_u32 s19, s19, 14680064
  s_waitcnt lgkmcnt(0)
  buffer_store_dwordx4 v[20:23], v1, s[8:11], s19 offen sc1
  s_add_u32 s19, s19, 36864
  buffer_store_dwordx4 v[24:27], v1, s[8:11], s19 offen sc1
k2_attn_wc_wdone:
  s_waitcnt lgkmcnt(0)
  s_branch k2_attn_wc_done
k2_attn_wc_w2p0:
  ds_read_b64_tr_b16 v[20:21], v17 offset:0
  ds_read_b64_tr_b16 v[22:23], v17 offset:2048
  ds_read_b64_tr_b16 v[24:25], v17 offset:32
  ds_read_b64_tr_b16 v[26:27], v17 offset:2080
  ds_read_b64_tr_b16 v[28:29], v17 offset:64
  ds_read_b64_tr_b16 v[30:31], v17 offset:2112
  ds_read_b64_tr_b16 v[32:33], v17 offset:96
  ds_read_b64_tr_b16 v[34:35], v17 offset:2144
  s_add_u32 s22, s35, 0
  s_mul_i32 s23, s22, 3641
  s_lshr_b32 s23, s23, 15
  s_mul_i32 s27, s23, 9
  s_sub_u32 s27, s22, s27
  s_mul_i32 s22, s23, 57
  s_lshr_b32 s22, s22, 10
  s_mul_i32 s26, s22, 18
  s_sub_u32 s23, s23, s26
  s_mul_i32 s26, s22, 1327104
  s_add_u32 s23, s23, 162
  s_lshl_b32 s23, s23, 10
  s_add_u32 s26, s26, s23
  s_add_u32 s26, s26, 0
  s_lshl_b32 s28, s27, 1
  s_add_u32 s28, s28, 0
  s_and_b32 s28, s28, 3
  s_lshr_b32 s29, s27, 1
  s_lshl_b32 s29, s29, 1
  s_add_u32 s29, s29, 0
  s_cmp_eq_u32 s27, 8
  s_cselect_b32 s28, 0, s28
  s_cselect_b32 s29, 8, s29
  s_mul_i32 s28, s28, 331776
  s_mul_i32 s29, s29, 18432
  s_add_u32 s28, s28, s29
  s_add_u32 s48, s28, s26
  s_lshl_b32 s28, s27, 1
  s_add_u32 s28, s28, 0
  s_and_b32 s28, s28, 3
  s_lshr_b32 s29, s27, 1
  s_lshl_b32 s29, s29, 1
  s_add_u32 s29, s29, 1
  s_cmp_eq_u32 s27, 8
  s_cselect_b32 s28, 1, s28
  s_cselect_b32 s29, 8, s29
  s_mul_i32 s28, s28, 331776
  s_mul_i32 s29, s29, 18432
  s_add_u32 s28, s28, s29
  s_add_u32 s49, s28, s26
  s_lshl_b32 s28, s27, 1
  s_add_u32 s28, s28, 1
  s_and_b32 s28, s28, 3
  s_lshr_b32 s29, s27, 1
  s_lshl_b32 s29, s29, 1
  s_add_u32 s29, s29, 0
  s_cmp_eq_u32 s27, 8
  s_cselect_b32 s28, 2, s28
  s_cselect_b32 s29, 8, s29
  s_mul_i32 s28, s28, 331776
  s_mul_i32 s29, s29, 18432
  s_add_u32 s28, s28, s29
  s_add_u32 s50, s28, s26
  s_lshl_b32 s28, s27, 1
  s_add_u32 s28, s28, 1
  s_and_b32 s28, s28, 3
  s_lshr_b32 s29, s27, 1
  s_lshl_b32 s29, s29, 1
  s_add_u32 s29, s29, 1
  s_cmp_eq_u32 s27, 8
  s_cselect_b32 s28, 3, s28
  s_cselect_b32 s29, 8, s29
  s_mul_i32 s28, s28, 331776
  s_mul_i32 s29, s29, 18432
  s_add_u32 s28, s28, s29
  s_add_u32 s51, s28, s26
  s_waitcnt lgkmcnt(0)
  buffer_store_dwordx4 v[20:23], v1, s[8:11], s48 offen sc1
  buffer_store_dwordx4 v[24:27], v1, s[8:11], s49 offen sc1
  buffer_store_dwordx4 v[28:31], v1, s[8:11], s50 offen sc1
  buffer_store_dwordx4 v[32:35], v1, s[8:11], s51 offen sc1
  s_nop 1
  ds_read_b64_tr_b16 v[20:21], v17 offset:4096
  ds_read_b64_tr_b16 v[22:23], v17 offset:6144
  ds_read_b64_tr_b16 v[24:25], v17 offset:4128
  ds_read_b64_tr_b16 v[26:27], v17 offset:6176
  ds_read_b64_tr_b16 v[28:29], v17 offset:4160
  ds_read_b64_tr_b16 v[30:31], v17 offset:6208
  ds_read_b64_tr_b16 v[32:33], v17 offset:4192
  ds_read_b64_tr_b16 v[34:35], v17 offset:6240
  s_add_u32 s22, s35, 1
  s_mul_i32 s23, s22, 3641
  s_lshr_b32 s23, s23, 15
  s_mul_i32 s27, s23, 9
  s_sub_u32 s27, s22, s27
  s_mul_i32 s22, s23, 57
  s_lshr_b32 s22, s22, 10
  s_mul_i32 s26, s22, 18
  s_sub_u32 s23, s23, s26
  s_mul_i32 s26, s22, 1327104
  s_add_u32 s23, s23, 162
  s_lshl_b32 s23, s23, 10
  s_add_u32 s26, s26, s23
  s_add_u32 s26, s26, 0
  s_lshl_b32 s28, s27, 1
  s_add_u32 s28, s28, 0
  s_and_b32 s28, s28, 3
  s_lshr_b32 s29, s27, 1
  s_lshl_b32 s29, s29, 1
  s_add_u32 s29, s29, 0
  s_cmp_eq_u32 s27, 8
  s_cselect_b32 s28, 0, s28
  s_cselect_b32 s29, 8, s29
  s_mul_i32 s28, s28, 331776
  s_mul_i32 s29, s29, 18432
  s_add_u32 s28, s28, s29
  s_add_u32 s48, s28, s26
  s_lshl_b32 s28, s27, 1
  s_add_u32 s28, s28, 0
  s_and_b32 s28, s28, 3
  s_lshr_b32 s29, s27, 1
  s_lshl_b32 s29, s29, 1
  s_add_u32 s29, s29, 1
  s_cmp_eq_u32 s27, 8
  s_cselect_b32 s28, 1, s28
  s_cselect_b32 s29, 8, s29
  s_mul_i32 s28, s28, 331776
  s_mul_i32 s29, s29, 18432
  s_add_u32 s28, s28, s29
  s_add_u32 s49, s28, s26
  s_lshl_b32 s28, s27, 1
  s_add_u32 s28, s28, 1
  s_and_b32 s28, s28, 3
  s_lshr_b32 s29, s27, 1
  s_lshl_b32 s29, s29, 1
  s_add_u32 s29, s29, 0
  s_cmp_eq_u32 s27, 8
  s_cselect_b32 s28, 2, s28
  s_cselect_b32 s29, 8, s29
  s_mul_i32 s28, s28, 331776
  s_mul_i32 s29, s29, 18432
  s_add_u32 s28, s28, s29
  s_add_u32 s50, s28, s26
  s_lshl_b32 s28, s27, 1
  s_add_u32 s28, s28, 1
  s_and_b32 s28, s28, 3
  s_lshr_b32 s29, s27, 1
  s_lshl_b32 s29, s29, 1
  s_add_u32 s29, s29, 1
  s_cmp_eq_u32 s27, 8
  s_cselect_b32 s28, 3, s28
  s_cselect_b32 s29, 8, s29
  s_mul_i32 s28, s28, 331776
  s_mul_i32 s29, s29, 18432
  s_add_u32 s28, s28, s29
  s_add_u32 s51, s28, s26
  s_waitcnt lgkmcnt(0)
  buffer_store_dwordx4 v[20:23], v1, s[8:11], s48 offen sc1
  buffer_store_dwordx4 v[24:27], v1, s[8:11], s49 offen sc1
  buffer_store_dwordx4 v[28:31], v1, s[8:11], s50 offen sc1
  buffer_store_dwordx4 v[32:35], v1, s[8:11], s51 offen sc1
  s_nop 1
  ds_read_b64_tr_b16 v[20:21], v17 offset:8192
  ds_read_b64_tr_b16 v[22:23], v17 offset:10240
  ds_read_b64_tr_b16 v[24:25], v17 offset:8224
  ds_read_b64_tr_b16 v[26:27], v17 offset:10272
  ds_read_b64_tr_b16 v[28:29], v17 offset:8256
  ds_read_b64_tr_b16 v[30:31], v17 offset:10304
  ds_read_b64_tr_b16 v[32:33], v17 offset:8288
  ds_read_b64_tr_b16 v[34:35], v17 offset:10336
  s_add_u32 s22, s35, 2
  s_mul_i32 s23, s22, 3641
  s_lshr_b32 s23, s23, 15
  s_mul_i32 s27, s23, 9
  s_sub_u32 s27, s22, s27
  s_mul_i32 s22, s23, 57
  s_lshr_b32 s22, s22, 10
  s_mul_i32 s26, s22, 18
  s_sub_u32 s23, s23, s26
  s_mul_i32 s26, s22, 1327104
  s_add_u32 s23, s23, 162
  s_lshl_b32 s23, s23, 10
  s_add_u32 s26, s26, s23
  s_add_u32 s26, s26, 0
  s_lshl_b32 s28, s27, 1
  s_add_u32 s28, s28, 0
  s_and_b32 s28, s28, 3
  s_lshr_b32 s29, s27, 1
  s_lshl_b32 s29, s29, 1
  s_add_u32 s29, s29, 0
  s_cmp_eq_u32 s27, 8
  s_cselect_b32 s28, 0, s28
  s_cselect_b32 s29, 8, s29
  s_mul_i32 s28, s28, 331776
  s_mul_i32 s29, s29, 18432
  s_add_u32 s28, s28, s29
  s_add_u32 s48, s28, s26
  s_lshl_b32 s28, s27, 1
  s_add_u32 s28, s28, 0
  s_and_b32 s28, s28, 3
  s_lshr_b32 s29, s27, 1
  s_lshl_b32 s29, s29, 1
  s_add_u32 s29, s29, 1
  s_cmp_eq_u32 s27, 8
  s_cselect_b32 s28, 1, s28
  s_cselect_b32 s29, 8, s29
  s_mul_i32 s28, s28, 331776
  s_mul_i32 s29, s29, 18432
  s_add_u32 s28, s28, s29
  s_add_u32 s49, s28, s26
  s_lshl_b32 s28, s27, 1
  s_add_u32 s28, s28, 1
  s_and_b32 s28, s28, 3
  s_lshr_b32 s29, s27, 1
  s_lshl_b32 s29, s29, 1
  s_add_u32 s29, s29, 0
  s_cmp_eq_u32 s27, 8
  s_cselect_b32 s28, 2, s28
  s_cselect_b32 s29, 8, s29
  s_mul_i32 s28, s28, 331776
  s_mul_i32 s29, s29, 18432
  s_add_u32 s28, s28, s29
  s_add_u32 s50, s28, s26
  s_lshl_b32 s28, s27, 1
  s_add_u32 s28, s28, 1
  s_and_b32 s28, s28, 3
  s_lshr_b32 s29, s27, 1
  s_lshl_b32 s29, s29, 1
  s_add_u32 s29, s29, 1
  s_cmp_eq_u32 s27, 8
  s_cselect_b32 s28, 3, s28
  s_cselect_b32 s29, 8, s29
  s_mul_i32 s28, s28, 331776
  s_mul_i32 s29, s29, 18432
  s_add_u32 s28, s28, s29
  s_add_u32 s51, s28, s26
  s_waitcnt lgkmcnt(0)
  buffer_store_dwordx4 v[20:23], v1, s[8:11], s48 offen sc1
  buffer_store_dwordx4 v[24:27], v1, s[8:11], s49 offen sc1
  buffer_store_dwordx4 v[28:31], v1, s[8:11], s50 offen sc1
  buffer_store_dwordx4 v[32:35], v1, s[8:11], s51 offen sc1
  s_nop 1
k2_attn_wc_done:
  s_barrier
  s_cmp_ge_u32 s2, 144
  s_cbranch_scc1 k2_attn_wc_fin
  s_cmp_lg_u32 s36, 0
  s_cbranch_scc1 k2_attn_wc_fin
  v_lshlrev_b32 v14, 2, v0
  v_add_u32 v15, 162816, v14
  ds_read_b32 v16, v15
  ds_read_b32 v17, v15 offset:256
  ds_read_b32 v18, v15 offset:512
  ds_read_b32 v19, v15 offset:768
  s_waitcnt lgkmcnt(0)
  v_add_f32 v16, v16, v17
  v_add_f32 v18, v18, v19
  v_add_f32 v16, v16, v18
  s_lshr_b32 s19, s2, 1
  s_lshl_b32 s19, s19, 8
  s_add_u32 s19, s19, 15728640
  buffer_atomic_add_f32 v16, v14, s[8:11], s19 offen
k2_attn_wc_fin:
  s_add_u32 s18, s38, 0
  s_min_u32 s18, s18, 151
  s_lshl_b32 s18, s18, 10
  s_mov_b32 m0, s18
  s_add_u32 s18, s18, s37
  buffer_load_dwordx4 v1, s[44:47], s18 offen lds
  s_add_u32 s18, s38, 4
  s_min_u32 s18, s18, 151
  s_lshl_b32 s18, s18, 10
  s_mov_b32 m0, s18
  s_add_u32 s18, s18, s37
  buffer_load_dwordx4 v1, s[44:47], s18 offen lds
  s_add_u32 s18, s38, 8
  s_min_u32 s18, s18, 151
  s_lshl_b32 s18, s18, 10
  s_mov_b32 m0, s18
  s_add_u32 s18, s18, s37
  buffer_load_dwordx4 v1, s[44:47], s18 offen lds
  s_add_u32 s18, s38, 12
  s_min_u32 s18, s18, 151
  s_lshl_b32 s18, s18, 10
  s_mov_b32 m0, s18
  s_add_u32 s18, s18, s37
  buffer_load_dwordx4 v1, s[44:47], s18 offen lds
  s_add_u32 s18, s38, 16
  s_min_u32 s18, s18, 151
  s_lshl_b32 s18, s18, 10
  s_mov_b32 m0, s18
  s_add_u32 s18, s18, s37
  buffer_load_dwordx4 v1, s[44:47], s18 offen lds
  s_add_u32 s18, s38, 20
  s_min_u32 s18, s18, 151
  s_lshl_b32 s18, s18, 10
  s_mov_b32 m0, s18
  s_add_u32 s18, s18, s37
  buffer_load_dwordx4 v1, s[44:47], s18 offen lds
  s_add_u32 s18, s38, 24
  s_min_u32 s18, s18, 151
  s_lshl_b32 s18, s18, 10
  s_mov_b32 m0, s18
  s_add_u32 s18, s18, s37
  buffer_load_dwordx4 v1, s[44:47], s18 offen lds
  s_add_u32 s18, s38, 28
  s_min_u32 s18, s18, 151
  s_lshl_b32 s18, s18, 10
  s_mov_b32 m0, s18
  s_add_u32 s18, s18, s37
  buffer_load_dwordx4 v1, s[44:47], s18 offen lds
  s_add_u32 s18, s38, 32
  s_min_u32 s18, s18, 151
  s_lshl_b32 s18, s18, 10
  s_mov_b32 m0, s18
  s_add_u32 s18, s18, s37
  buffer_load_dwordx4 v1, s[44:47], s18 offen lds
  s_add_u32 s18, s38, 36
  s_min_u32 s18, s18, 151
  s_lshl_b32 s18, s18, 10
  s_mov_b32 m0, s18
  s_add_u32 s18, s18, s37
  buffer_load_dwordx4 v1, s[44:47], s18 offen lds
  s_add_u32 s18, s38, 40
  s_min_u32 s18, s18, 151
  s_lshl_b32 s18, s18, 10
  s_mov_b32 m0, s18
  s_add_u32 s18, s18, s37
  buffer_load_dwordx4 v1, s[44:47], s18 offen lds
  s_branch k2_attn_h2
k2_attn_h1:
  s_barrier
  s_barrier
  s_add_u32 s18, s38, 0
  s_min_u32 s18, s18, 151
  s_lshl_b32 s18, s18, 10
  s_mov_b32 m0, s18
  s_add_u32 s18, s18, s37
  buffer_load_dwordx4 v1, s[44:47], s18 offen lds
  s_add_u32 s18, s38, 4
  s_min_u32 s18, s18, 151
  s_lshl_b32 s18, s18, 10
  s_mov_b32 m0, s18
  s_add_u32 s18, s18, s37
  buffer_load_dwordx4 v1, s[44:47], s18 offen lds
  s_add_u32 s18, s38, 8
  s_min_u32 s18, s18, 151
  s_lshl_b32 s18, s18, 10
  s_mov_b32 m0, s18
  s_add_u32 s18, s18, s37
  buffer_load_dwordx4 v1, s[44:47], s18 offen lds
  s_add_u32 s18, s38, 12
  s_min_u32 s18, s18, 151
  s_lshl_b32 s18, s18, 10
  s_mov_b32 m0, s18
  s_add_u32 s18, s18, s37
  buffer_load_dwordx4 v1, s[44:47], s18 offen lds
  s_add_u32 s18, s38, 16
  s_min_u32 s18, s18, 151
  s_lshl_b32 s18, s18, 10
  s_mov_b32 m0, s18
  s_add_u32 s18, s18, s37
  buffer_load_dwordx4 v1, s[44:47], s18 offen lds
  s_add_u32 s18, s38, 20
  s_min_u32 s18, s18, 151
  s_lshl_b32 s18, s18, 10
  s_mov_b32 m0, s18
  s_add_u32 s18, s18, s37
  buffer_load_dwordx4 v1, s[44:47], s18 offen lds
  s_add_u32 s18, s38, 24
  s_min_u32 s18, s18, 151
  s_lshl_b32 s18, s18, 10
  s_mov_b32 m0, s18
  s_add_u32 s18, s18, s37
  buffer_load_dwordx4 v1, s[44:47], s18 offen lds
  s_add_u32 s18, s38, 28
  s_min_u32 s18, s18, 151
  s_lshl_b32 s18, s18, 10
  s_mov_b32 m0, s18
  s_add_u32 s18, s18, s37
  buffer_load_dwordx4 v1, s[44:47], s18 offen lds
  s_add_u32 s18, s38, 32
  s_min_u32 s18, s18, 151
  s_lshl_b32 s18, s18, 10
  s_mov_b32 m0, s18
  s_add_u32 s18, s18, s37
  buffer_load_dwordx4 v1, s[44:47], s18 offen lds
  s_add_u32 s18, s38, 36
  s_min_u32 s18, s18, 151
  s_lshl_b32 s18, s18, 10
  s_mov_b32 m0, s18
  s_add_u32 s18, s18, s37
  buffer_load_dwordx4 v1, s[44:47], s18 offen lds
  s_add_u32 s18, s38, 40
  s_min_u32 s18, s18, 151
  s_lshl_b32 s18, s18, 10
  s_mov_b32 m0, s18
  s_add_u32 s18, s18, s37
  buffer_load_dwordx4 v1, s[44:47], s18 offen lds
  s_barrier
k2_attn_h2:
  s_waitcnt vmcnt(0)
  s_barrier
  s_lshr_b32 s18, s2, 3
  s_lshl_b32 s18, s18, 2
  s_add_u32 s18, s18, s36
  s_add_u32 s19, s18, 0
  s_min_u32 s19, s19, 647
  s_lshl_b32 s19, s19, 10
  s_add_u32 s19, s19, 14680064
  buffer_load_dwordx4 v[104:107], v1, s[8:11], s19 offen
  s_add_u32 s19, s18, 128
  s_min_u32 s19, s19, 647
  s_lshl_b32 s19, s19, 10
  s_add_u32 s19, s19, 14680064
  buffer_load_dwordx4 v[108:111], v1, s[8:11], s19 offen
  s_add_u32 s19, s18, 256
  s_min_u32 s19, s19, 647
  s_lshl_b32 s19, s19, 10
  s_add_u32 s19, s19, 14680064
  buffer_load_dwordx4 v[112:115], v1, s[8:11], s19 offen
  s_add_u32 s19, s18, 384
  s_min_u32 s19, s19, 647
  s_lshl_b32 s19, s19, 10
  s_add_u32 s19, s19, 14680064
  buffer_load_dwordx4 v[116:119], v1, s[8:11], s19 offen
  s_add_u32 s19, s18, 512
  s_min_u32 s19, s19, 647
  s_lshl_b32 s19, s19, 10
  s_add_u32 s19, s19, 14680064
  buffer_load_dwordx4 v[104:107], v1, s[8:11], s19 offen
  s_add_u32 s19, s18, 640
  s_min_u32 s19, s19, 647
  s_lshl_b32 s19, s19, 10
  s_add_u32 s19, s19, 14680064
  buffer_load_dwordx4 v[108:111], v1, s[8:11], s19 offen
  s_getpc_b64 s[50:51]
k2_attn_pc_2:
  s_add_u32 s50, s50, k3_wo0_kernel-k2_attn_pc_2
  s_addc_u32 s51, s51, (k3_wo0_kernel-k2_attn_pc_2)>>32
  s_lshr_b32 s52, s2, 3
  s_and_b32 s52, s52, 31
  s_mul_i32 s52, s52, 4
  s_add_u32 s52, s52, s36
  s_lshl_b32 s52, s52, 10
  s_min_u32 s52, s52, k6_red_codeend-k3_wo0_kernel-1024
  v_lshlrev_b32 v96, 4, v0
  v_add_u32 v96, s52, v96
  global_load_dwordx4 v[98:101], v96, s[50:51]
k2_attn_end:
  s_endpgm
k2_attn_codeend:
.globl k3_wo0_kernel
.p2align 8
.type k3_wo0_kernel,@function
k3_wo0_kernel:
  s_mov_b32 s34, 0x0
  s_branch k3_wo_body
.globl k3_wo1_kernel
.p2align 8
.type k3_wo1_kernel,@function
k3_wo1_kernel:
  s_mov_b32 s34, 0x3000000
  s_branch k3_wo_body
.p2align 6
k3_wo_body:
  s_cmp_ge_u32 s2, 192
  s_cbranch_scc1 k3_wo_end
  s_load_dwordx2 s[4:5], s[0:1], 64
  v_lshrrev_b32 v1, 6, v0
  v_and_b32 v0, 63, v0
  s_nop 0
  v_readfirstlane_b32 s3, v1
  v_lshlrev_b32 v1, 4, v0
  v_and_b32 v2, 31, v0
  v_lshrrev_b32 v3, 5, v0
  v_add_u32 v4, 32768, v1
  s_lshr_b32 s12, s2, 3
  s_mul_i32 s13, s12, 43
  s_lshr_b32 s13, s13, 8
  s_mul_i32 s14, s13, 6
  s_sub_u32 s14, s12, s14
  s_lshl_b32 s13, s13, 3
  s_and_b32 s12, s2, 7
  s_add_u32 s12, s12, s13
  s_mul_i32 s13, s14, 3
  s_add_u32 s13, s13, s3
  s_mul_i32 s14, s12, 73728
  s_add_u32 s15, s14, 58720256
  s_mul_i32 s20, s13, 36864
  s_add_u32 s20, s20, 14680064
  s_waitcnt lgkmcnt(0)
  s_add_u32 s44, s4, s34
  s_addc_u32 s45, s5, 0
  s_mov_b32 s46, 0x6000000
  s_mov_b32 s47, 0x20000
  s_mov_b32 s8, s4
  s_mov_b32 s9, s5
  s_mov_b32 s10, 0x10000000
  s_mov_b32 s11, 0x20000
  s_add_u32 s17, s3, 0
  s_and_b32 s18, s17, 1
  s_mul_i32 s18, s18, 36864
  s_lshr_b32 s17, s17, 1
  s_lshl_b32 s17, s17, 10
  s_add_u32 m0, s17, s18
  s_add_u32 s17, m0, s15
  buffer_load_dwordx4 v1, s[44:47], s17 offen lds
  s_add_u32 s17, s3, 3
  s_and_b32 s18, s17, 1
  s_mul_i32 s18, s18, 36864
  s_lshr_b32 s17, s17, 1
  s_lshl_b32 s17, s17, 10
  s_add_u32 m0, s17, s18
  s_add_u32 s17, m0, s15
  buffer_load_dwordx4 v1, s[44:47], s17 offen lds
  s_add_u32 s17, s3, 6
  s_and_b32 s18, s17, 1
  s_mul_i32 s18, s18, 36864
  s_lshr_b32 s17, s17, 1
  s_lshl_b32 s17, s17, 10
  s_add_u32 m0, s17, s18
  s_add_u32 s17, m0, s15
  buffer_load_dwordx4 v1, s[44:47], s17 offen lds
  s_add_u32 s17, s3, 9
  s_and_b32 s18, s17, 1
  s_mul_i32 s18, s18, 36864
  s_lshr_b32 s17, s17, 1
  s_lshl_b32 s17, s17, 10
  s_add_u32 m0, s17, s18
  s_add_u32 s17, m0, s15
  buffer_load_dwordx4 v1, s[44:47], s17 offen lds
  s_add_u32 s17, s3, 12
  s_and_b32 s18, s17, 1
  s_mul_i32 s18, s18, 36864
  s_lshr_b32 s17, s17, 1
  s_lshl_b32 s17, s17, 10
  s_add_u32 m0, s17, s18
  s_add_u32 s17, m0, s15
  buffer_load_dwordx4 v1, s[44:47], s17 offen lds
  s_add_u32 s17, s3, 15
  s_and_b32 s18, s17, 1
  s_mul_i32 s18, s18, 36864
  s_lshr_b32 s17, s17, 1
  s_lshl_b32 s17, s17, 10
  s_add_u32 m0, s17, s18
  s_add_u32 s17, m0, s15
  buffer_load_dwordx4 v1, s[44:47], s17 offen lds
  s_add_u32 s17, s3, 18
  s_and_b32 s18, s17, 1
  s_mul_i32 s18, s18, 36864
  s_lshr_b32 s17, s17, 1
  s_lshl_b32 s17, s17, 10
  s_add_u32 m0, s17, s18
  s_add_u32 s17, m0, s15
  buffer_load_dwordx4 v1, s[44:47], s17 offen lds
  s_add_u32 s17, s3, 21
  s_and_b32 s18, s17, 1
  s_mul_i32 s18, s18, 36864
  s_lshr_b32 s17, s17, 1
  s_lshl_b32 s17, s17, 10
  s_add_u32 m0, s17, s18
  s_add_u32 s17, m0, s15
  buffer_load_dwordx4 v1, s[44:47], s17 offen lds
  buffer_load_dwordx4 v[16:19], v1, s[8:11], s20 offen offset:0
  buffer_load_dwordx4 v[20:23], v1, s[8:11], s20 offen offset:1024
  buffer_load_dwordx4 v[24:27], v1, s[8:11], s20 offen offset:2048
  buffer_load_dwordx4 v[28:31], v1, s[8:11], s20 offen offset:3072
  s_add_u32 s20, s20, 4096
  buffer_load_dwordx4 v[32:35], v1, s[8:11], s20 offen offset:0
  buffer_load_dwordx4 v[36:39], v1, s[8:11], s20 offen offset:1024
  buffer_load_dwordx4 v[40:43], v1, s[8:11], s20 offen offset:2048
  buffer_load_dwordx4 v[44:47], v1, s[8:11], s20 offen offset:3072
  s_add_u32 s20, s20, 4096
  buffer_load_dwordx4 v[48:51], v1, s[8:11], s20 offen offset:0
  s_add_u32 s17, s3, 24
  s_and_b32 s18, s17, 1
  s_mul_i32 s18, s18, 36864
  s_lshr_b32 s17, s17, 1
  s_lshl_b32 s17, s17, 10
  s_add_u32 m0, s17, s18
  s_add_u32 s17, m0, s15
  buffer_load_dwordx4 v1, s[44:47], s17 offen lds
  s_add_u32 s17, s3, 27
  s_and_b32 s18, s17, 1
  s_mul_i32 s18, s18, 36864
  s_lshr_b32 s17, s17, 1
  s_lshl_b32 s17, s17, 10
  s_add_u32 m0, s17, s18
  s_add_u32 s17, m0, s15
  buffer_load_dwordx4 v1, s[44:47], s17 offen lds
  s_add_u32 s17, s3, 30
  s_and_b32 s18, s17, 1
  s_mul_i32 s18, s18, 36864
  s_lshr_b32 s17, s17, 1
  s_lshl_b32 s17, s17, 10
  s_add_u32 m0, s17, s18
  s_add_u32 s17, m0, s15
  buffer_load_dwordx4 v1, s[44:47], s17 offen lds
  s_add_u32 s17, s3, 33
  s_and_b32 s18, s17, 1
  s_mul_i32 s18, s18, 36864
  s_lshr_b32 s17, s17, 1
  s_lshl_b32 s17, s17, 10
  s_add_u32 m0, s17, s18
  s_add_u32 s17, m0, s15
  buffer_load_dwordx4 v1, s[44:47], s17 offen lds
  s_add_u32 s17, s3, 36
  s_and_b32 s18, s17, 1
  s_mul_i32 s18, s18, 36864
  s_lshr_b32 s17, s17, 1
  s_lshl_b32 s17, s17, 10
  s_add_u32 m0, s17, s18
  s_add_u32 s17, m0, s15
  buffer_load_dwordx4 v1, s[44:47], s17 offen lds
  s_add_u32 s17, s3, 39
  s_and_b32 s18, s17, 1
  s_mul_i32 s18, s18, 36864
  s_lshr_b32 s17, s17, 1
  s_lshl_b32 s17, s17, 10
  s_add_u32 m0, s17, s18
  s_add_u32 s17, m0, s15
  buffer_load_dwordx4 v1, s[44:47], s17 offen lds
  s_add_u32 s17, s3, 42
  s_and_b32 s18, s17, 1
  s_mul_i32 s18, s18, 36864
  s_lshr_b32 s17, s17, 1
  s_lshl_b32 s17, s17, 10
  s_add_u32 m0, s17, s18
  s_add_u32 s17, m0, s15
  buffer_load_dwordx4 v1, s[44:47], s17 offen lds
  s_add_u32 s17, s3, 45
  s_and_b32 s18, s17, 1
  s_mul_i32 s18, s18, 36864
  s_lshr_b32 s17, s17, 1
  s_lshl_b32 s17, s17, 10
  s_add_u32 m0, s17, s18
  s_add_u32 s17, m0, s15
  buffer_load_dwordx4 v1, s[44:47], s17 offen lds
  s_add_u32 s17, s3, 48
  s_and_b32 s18, s17, 1
  s_mul_i32 s18, s18, 36864
  s_lshr_b32 s17, s17, 1
  s_lshl_b32 s17, s17, 10
  s_add_u32 m0, s17, s18
  s_add_u32 s17, m0, s15
  buffer_load_dwordx4 v1, s[44:47], s17 offen lds
  s_add_u32 s17, s3, 51
  s_and_b32 s18, s17, 1
  s_mul_i32 s18, s18, 36864
  s_lshr_b32 s17, s17, 1
  s_lshl_b32 s17, s17, 10
  s_add_u32 m0, s17, s18
  s_add_u32 s17, m0, s15
  buffer_load_dwordx4 v1, s[44:47], s17 offen lds
  s_add_u32 s17, s3, 54
  s_and_b32 s18, s17, 1
  s_mul_i32 s18, s18, 36864
  s_lshr_b32 s17, s17, 1
  s_lshl_b32 s17, s17, 10
  s_add_u32 m0, s17, s18
  s_add_u32 s17, m0, s15
  buffer_load_dwordx4 v1, s[44:47], s17 offen lds
  s_add_u32 s17, s3, 57
  s_and_b32 s18, s17, 1
  s_mul_i32 s18, s18, 36864
  s_lshr_b32 s17, s17, 1
  s_lshl_b32 s17, s17, 10
  s_add_u32 m0, s17, s18
  s_add_u32 s17, m0, s15
  buffer_load_dwordx4 v1, s[44:47], s17 offen lds
  s_add_u32 s17, s3, 60
  s_and_b32 s18, s17, 1
  s_mul_i32 s18, s18, 36864
  s_lshr_b32 s17, s17, 1
  s_lshl_b32 s17, s17, 10
  s_add_u32 m0, s17, s18
  s_add_u32 s17, m0, s15
  buffer_load_dwordx4 v1, s[44:47], s17 offen lds
  s_add_u32 s17, s3, 63
  s_and_b32 s18, s17, 1
  s_mul_i32 s18, s18, 36864
  s_lshr_b32 s17, s17, 1
  s_lshl_b32 s17, s17, 10
  s_add_u32 m0, s17, s18
  s_add_u32 s17, m0, s15
  buffer_load_dwordx4 v1, s[44:47], s17 offen lds
  s_add_u32 s17, s3, 66
  s_and_b32 s18, s17, 1
  s_mul_i32 s18, s18, 36864
  s_lshr_b32 s17, s17, 1
  s_lshl_b32 s17, s17, 10
  s_add_u32 m0, s17, s18
  s_add_u32 s17, m0, s15
  buffer_load_dwordx4 v1, s[44:47], s17 offen lds
  s_add_u32 s17, s3, 69
  s_and_b32 s18, s17, 1
  s_mul_i32 s18, s18, 36864
  s_lshr_b32 s17, s17, 1
  s_lshl_b32 s17, s17, 10
  s_add_u32 m0, s17, s18
  s_add_u32 s17, m0, s15
  buffer_load_dwordx4 v1, s[44:47], s17 offen lds
  s_lshl_b32 s21, s13, 10
  s_add_u32 s21, s21, s14
  s_add_u32 s22, s21, 37748736
  s_add_u32 s23, s22, 36864
  s_add_u32 s24, s21, 61865984
  s_add_u32 s25, s24, 36864
  s_waitcnt vmcnt(25)
  s_barrier
  ds_read_b128 a[0:3], v1 offset:0
  ds_read_b128 a[4:7], v1 offset:36864
  ds_read_b128 a[8:11], v1 offset:1024
  ds_read_b128 a[12:15], v1 offset:37888
  ds_read_b128 a[16:19], v1 offset:2048
  ds_read_b128 a[20:23], v1 offset:38912
  s_waitcnt vmcnt(23)
  s_waitcnt lgkmcnt(4)
  v_mfma_f32_32x32x16_bf16 v[96:111], v[16:19], a[0:3], 0
  v_mfma_f32_32x32x16_bf16 v[112:127], v[16:19], a[4:7], 0
  ds_read_b128 a[24:27], v1 offset:3072
  ds_read_b128 a[28:31], v1 offset:39936
  s_waitcnt lgkmcnt(4)
  v_mfma_f32_32x32x16_bf16 v[96:111], v[20:23], a[8:11], v[96:111]
  v_mfma_f32_32x32x16_bf16 v[112:127], v[20:23], a[12:15], v[112:127]
  ds_read_b128 a[32:35], v1 offset:4096
  ds_read_b128 a[36:39], v1 offset:40960
  s_waitcnt vmcnt(21)
  s_waitcnt lgkmcnt(4)
  v_mfma_f32_32x32x16_bf16 v[96:111], v[24:27], a[16:19], v[96:111]
  v_mfma_f32_32x32x16_bf16 v[112:127], v[24:27], a[20:23], v[112:127]
  ds_read_b128 a[40:43], v1 offset:5120
  ds_read_b128 a[44:47], v1 offset:41984
  s_waitcnt lgkmcnt(4)
  v_mfma_f32_32x32x16_bf16 v[96:111], v[28:31], a[24:27], v[96:111]
  v_mfma_f32_32x32x16_bf16 v[112:127], v[28:31], a[28:31], v[112:127]
  ds_read_b128 a[48:51], v1 offset:6144
  ds_read_b128 a[52:55], v1 offset:43008
  s_waitcnt vmcnt(19)
  s_waitcnt lgkmcnt(4)
  v_mfma_f32_32x32x16_bf16 v[96:111], v[32:35], a[32:35], v[96:111]
  v_mfma_f32_32x32x16_bf16 v[112:127], v[32:35], a[36:39], v[112:127]
  ds_read_b128 a[56:59], v1 offset:7168
  ds_read_b128 a[60:63], v1 offset:44032
  s_waitcnt lgkmcnt(4)
  v_mfma_f32_32x32x16_bf16 v[96:111], v[36:39], a[40:43], v[96:111]
  v_mfma_f32_32x32x16_bf16 v[112:127], v[36:39], a[44:47], v[112:127]
  ds_read_b128 a[64:67], v1 offset:8192
  ds_read_b128 a[68:71], v1 offset:45056
  s_waitcnt vmcnt(17)
  s_waitcnt lgkmcnt(4)
  v_mfma_f32_32x32x16_bf16 v[96:111], v[40:43], a[48:51], v[96:111]
  v_mfma_f32_32x32x16_bf16 v[112:127], v[40:43], a[52:55], v[112:127]
  ds_read_b128 a[72:75], v1 offset:9216
  ds_read_b128 a[76:79], v1 offset:46080
  s_waitcnt lgkmcnt(4)
  v_mfma_f32_32x32x16_bf16 v[96:111], v[44:47], a[56:59], v[96:111]
  v_mfma_f32_32x32x16_bf16 v[112:127], v[44:47], a[60:63], v[112:127]
  ds_read_b128 a[80:83], v1 offset:10240
  ds_read_b128 a[84:87], v1 offset:47104
  s_waitcnt vmcnt(16)
  s_waitcnt lgkmcnt(4)
  v_mfma_f32_32x32x16_bf16 v[96:111], v[48:51], a[64:67], v[96:111]
  v_mfma_f32_32x32x16_bf16 v[112:127], v[48:51], a[68:71], v[112:127]
  buffer_load_dwordx4 v[52:55], v1, s[8:11], s20 offen offset:1024
  buffer_load_dwordx4 v[56:59], v1, s[8:11], s20 offen offset:2048
  buffer_load_dwordx4 v[60:63], v1, s[8:11], s20 offen offset:3072
  s_add_u32 s20, s20, 4096
  buffer_load_dwordx4 v[64:67], v1, s[8:11], s20 offen offset:0
  buffer_load_dwordx4 v[68:71], v1, s[8:11], s20 offen offset:1024
  buffer_load_dwordx4 v[72:75], v1, s[8:11], s20 offen offset:2048
  buffer_load_dwordx4 v[76:79], v1, s[8:11], s20 offen offset:3072
  s_add_u32 s20, s20, 4096
  buffer_load_dwordx4 v[80:83], v1, s[8:11], s20 offen offset:0
  buffer_load_dwordx4 v[84:87], v1, s[8:11], s20 offen offset:1024
  buffer_load_dwordx4 v[16:19], v1, s[8:11], s20 offen offset:2048
  ds_read_b128 a[88:91], v1 offset:11264
  ds_read_b128 a[92:95], v1 offset:48128
  s_waitcnt vmcnt(18)
  s_barrier
  s_waitcnt vmcnt(9)
  s_waitcnt lgkmcnt(4)
  v_mfma_f32_32x32x16_bf16 v[96:111], v[52:55], a[72:75], v[96:111]
  v_mfma_f32_32x32x16_bf16 v[112:127], v[52:55], a[76:79], v[112:127]
  buffer_load_dwordx4 v[20:23], v1, s[8:11], s20 offen offset:3072
  s_add_u32 s20, s20, 4096
  buffer_load_dwordx4 v[24:27], v1, s[8:11], s20 offen offset:0
  ds_read_b128 a[96:99], v1 offset:12288
  ds_read_b128 a[100:103], v1 offset:49152
  s_waitcnt vmcnt(10)
  s_waitcnt lgkmcnt(4)
  v_mfma_f32_32x32x16_bf16 v[96:111], v[56:59], a[80:83], v[96:111]
  v_mfma_f32_32x32x16_bf16 v[112:127], v[56:59], a[84:87], v[112:127]
  buffer_load_dwordx4 v[28:31], v1, s[8:11], s20 offen offset:1024
  buffer_load_dwordx4 v[32:35], v1, s[8:11], s20 offen offset:2048
  ds_read_b128 a[104:107], v1 offset:13312
  ds_read_b128 a[108:111], v1 offset:50176
  s_waitcnt vmcnt(11)
  s_waitcnt lgkmcnt(4)
  v_mfma_f32_32x32x16_bf16 v[96:111], v[60:63], a[88:91], v[96:111]
  v_mfma_f32_32x32x16_bf16 v[112:127], v[60:63], a[92:95], v[112:127]
  buffer_load_dwordx4 v[36:39], v1, s[8:11], s20 offen offset:3072
  s_add_u32 s20, s20, 4096
  buffer_load_dwordx4 v[40:43], v1, s[8:11], s20 offen offset:0
  ds_read_b128 a[112:115], v1 offset:14336
  ds_read_b128 a[116:119], v1 offset:51200
  s_waitcnt vmcnt(12)
  s_waitcnt lgkmcnt(4)
  v_mfma_f32_32x32x16_bf16 v[96:111], v[64:67], a[96:99], v[96:111]
  v_mfma_f32_32x32x16_bf16 v[112:127], v[64:67], a[100:103], v[112:127]
  buffer_load_dwordx4 v[44:47], v1, s[8:11], s20 offen offset:1024
  buffer_load_dwordx4 v[48:51], v1, s[8:11], s20 offen offset:2048
  v_lshrrev_b32 v6, 4, v2
  v_mul_u32_u24 v6, 18432, v6
  v_and_b32 v7, 15, v2
  v_lshlrev_b32 v8, 4, v3
  v_add_u32 v7, v7, v8
  v_lshlrev_b32 v7, 4, v7
  v_add_u32 v216, v6, v7
  buffer_load_dwordx4 v[200:203], v216, s[44:47], s22 offen offset:0
  buffer_load_dwordx4 v[204:207], v216, s[44:47], s22 offen offset:512
  buffer_load_dwordx4 v[208:211], v216, s[44:47], s23 offen offset:0
  buffer_load_dwordx4 v[212:215], v216, s[44:47], s23 offen offset:512
  ds_read_b128 a[120:123], v1 offset:15360
  ds_read_b128 a[124:127], v1 offset:52224
  s_waitcnt vmcnt(16)
  s_waitcnt lgkmcnt(4)
  v_mfma_f32_32x32x16_bf16 v[96:111], v[68:71], a[104:107], v[96:111]
  v_mfma_f32_32x32x16_bf16 v[112:127], v[68:71], a[108:111], v[112:127]
  buffer_load_dwordx4 v[52:55], v1, s[8:11], s20 offen offset:3072
  s_add_u32 s20, s20, 4096
  buffer_load_dwordx4 v[56:59], v1, s[8:11], s20 offen offset:0
  ds_read_b128 a[128:131], v1 offset:16384
  ds_read_b128 a[132:135], v1 offset:53248
  s_waitcnt lgkmcnt(4)
  v_mfma_f32_32x32x16_bf16 v[96:111], v[72:75], a[112:115], v[96:111]
  v_mfma_f32_32x32x16_bf16 v[112:127], v[72:75], a[116:119], v[112:127]
  buffer_load_dwordx4 v[60:63], v1, s[8:11], s20 offen offset:1024
  buffer_load_dwordx4 v[64:67], v1, s[8:11], s20 offen offset:2048
  ds_read_b128 a[136:139], v1 offset:17408
  ds_read_b128 a[140:143], v1 offset:54272
  s_waitcnt vmcnt(18)
  s_waitcnt lgkmcnt(4)
  v_mfma_f32_32x32x16_bf16 v[96:111], v[76:79], a[120:123], v[96:111]
  v_mfma_f32_32x32x16_bf16 v[112:127], v[76:79], a[124:127], v[112:127]
  buffer_load_dwordx4 v[68:71], v1, s[8:11], s20 offen offset:3072
  s_add_u32 s20, s20, 4096
  buffer_load_dwordx4 v[72:75], v1, s[8:11], s20 offen offset:0
  ds_read_b128 a[144:147], v1 offset:18432
  ds_read_b128 a[148:151], v1 offset:55296
  s_waitcnt lgkmcnt(4)
  v_mfma_f32_32x32x16_bf16 v[96:111], v[80:83], a[128:131], v[96:111]
  v_mfma_f32_32x32x16_bf16 v[112:127], v[80:83], a[132:135], v[112:127]
  buffer_load_dwordx4 v[76:79], v1, s[8:11], s20 offen offset:1024
  buffer_load_dwordx4 v[80:83], v1, s[8:11], s20 offen offset:2048
  ds_read_b128 a[152:155], v1 offset:19456
  ds_read_b128 a[156:159], v1 offset:56320
  s_waitcnt vmcnt(20)
  s_waitcnt lgkmcnt(4)
  v_mfma_f32_32x32x16_bf16 v[96:111], v[84:87], a[136:139], v[96:111]
  v_mfma_f32_32x32x16_bf16 v[112:127], v[84:87], a[140:143], v[112:127]
  buffer_load_dwordx4 v[84:87], v1, s[8:11], s20 offen offset:3072
  ds_read_b128 a[160:163], v1 offset:20480
  ds_read_b128 a[164:167], v1 offset:57344
  s_waitcnt lgkmcnt(4)
  v_mfma_f32_32x32x16_bf16 v[96:111], v[16:19], a[144:147], v[96:111]
  v_mfma_f32_32x32x16_bf16 v[112:127], v[16:19], a[148:151], v[112:127]
  ds_read_b128 a[168:171], v1 offset:21504
  ds_read_b128 a[172:175], v1 offset:58368
  s_waitcnt vmcnt(19)
  s_waitcnt lgkmcnt(4)
  v_mfma_f32_32x32x16_bf16 v[96:111], v[20:23], a[152:155], v[96:111]
  v_mfma_f32_32x32x16_bf16 v[112:127], v[20:23], a[156:159], v[112:127]
  ds_read_b128 a[176:179], v1 offset:22528
  ds_read_b128 a[180:183], v1 offset:59392
  s_waitcnt lgkmcnt(4)
  v_mfma_f32_32x32x16_bf16 v[96:111], v[24:27], a[160:163], v[96:111]
  s_lshl_b32 s26, s12, 1
  s_mul_i32 s26, s26, 4608
  s_lshr_b32 s27, s13, 1
  s_lshl_b32 s27, s27, 9
  s_add_u32 s26, s26, s27
  s_and_b32 s27, s13, 1
  v_mfma_f32_32x32x16_bf16 v[112:127], v[24:27], a[164:167], v[112:127]
  ds_read_b128 a[184:187], v1 offset:23552
  ds_read_b128 a[188:191], v1 offset:60416
  s_lshl_b32 s27, s27, 3
  s_add_u32 s26, s26, s27
  s_add_u32 s26, s26, 65011712
  v_lshlrev_b32 v5, 4, v2
  s_barrier
  s_waitcnt vmcnt(17)
  s_waitcnt lgkmcnt(4)
  v_mfma_f32_32x32x16_bf16 v[96:111], v[28:31], a[168:171], v[96:111]
  v_mfma_f32_32x32x16_bf16 v[112:127], v[28:31], a[172:175], v[112:127]
  ds_read_b128 a[192:195], v1 offset:24576
  ds_read_b128 a[196:199], v1 offset:61440
  s_waitcnt lgkmcnt(4)
  v_mfma_f32_32x32x16_bf16 v[96:111], v[32:35], a[176:179], v[96:111]
  v_mfma_f32_32x32x16_bf16 v[112:127], v[32:35], a[180:183], v[112:127]
  ds_read_b128 a[200:203], v1 offset:25600
  ds_read_b128 a[204:207], v1 offset:62464
  s_waitcnt vmcnt(15)
  s_waitcnt lgkmcnt(4)
  v_mfma_f32_32x32x16_bf16 v[96:111], v[36:39], a[184:187], v[96:111]
  v_mfma_f32_32x32x16_bf16 v[112:127], v[36:39], a[188:191], v[112:127]
  ds_read_b128 a[208:211], v1 offset:26624
  ds_read_b128 a[212:215], v1 offset:63488
  s_waitcnt lgkmcnt(4)
  v_mfma_f32_32x32x16_bf16 v[96:111], v[40:43], a[192:195], v[96:111]
  v_mfma_f32_32x32x16_bf16 v[112:127], v[40:43], a[196:199], v[112:127]
  ds_read_b128 a[216:219], v1 offset:27648
  ds_read_b128 a[220:223], v1 offset:64512
  s_waitcnt vmcnt(13)
  s_waitcnt lgkmcnt(4)
  v_mfma_f32_32x32x16_bf16 v[96:111], v[44:47], a[200:203], v[96:111]
  v_mfma_f32_32x32x16_bf16 v[112:127], v[44:47], a[204:207], v[112:127]
  ds_read_b128 a[224:227], v1 offset:28672
  ds_read_b128 a[228:231], v4 offset:32768
  s_waitcnt lgkmcnt(4)
  v_mfma_f32_32x32x16_bf16 v[96:111], v[48:51], a[208:211], v[96:111]
  v_mfma_f32_32x32x16_bf16 v[112:127], v[48:51], a[212:215], v[112:127]
  ds_read_b128 a[232:235], v1 offset:29696
  ds_read_b128 a[236:239], v4 offset:33792
  s_waitcnt vmcnt(8)
  s_waitcnt lgkmcnt(4)
  v_mfma_f32_32x32x16_bf16 v[96:111], v[52:55], a[216:219], v[96:111]
  v_mfma_f32_32x32x16_bf16 v[112:127], v[52:55], a[220:223], v[112:127]
  ds_read_b128 a[240:243], v1 offset:30720
  ds_read_b128 a[244:247], v4 offset:34816
  s_waitcnt vmcnt(7)
  s_waitcnt lgkmcnt(4)
  v_mfma_f32_32x32x16_bf16 v[96:111], v[56:59], a[224:227], v[96:111]
  v_mfma_f32_32x32x16_bf16 v[112:127], v[56:59], a[228:231], v[112:127]
  ds_read_b128 a[248:251], v1 offset:31744
  ds_read_b128 a[252:255], v4 offset:35840
  s_waitcnt vmcnt(6)
  s_waitcnt lgkmcnt(4)
  v_mfma_f32_32x32x16_bf16 v[96:111], v[60:63], a[232:235], v[96:111]
  v_mfma_f32_32x32x16_bf16 v[112:127], v[60:63], a[236:239], v[112:127]
  ds_read_b128 v[160:163], v1 offset:32768
  ds_read_b128 v[164:167], v4 offset:36864
  s_waitcnt vmcnt(5)
  s_waitcnt lgkmcnt(4)
  v_mfma_f32_32x32x16_bf16 v[96:111], v[64:67], a[240:243], v[96:111]
  v_mfma_f32_32x32x16_bf16 v[112:127], v[64:67], a[244:247], v[112:127]
  ds_read_b128 v[168:171], v1 offset:33792
  ds_read_b128 v[172:175], v4 offset:37888
  s_waitcnt vmcnt(4)
  s_waitcnt lgkmcnt(4)
  v_mfma_f32_32x32x16_bf16 v[96:111], v[68:71], a[248:251], v[96:111]
  v_mfma_f32_32x32x16_bf16 v[112:127], v[68:71], a[252:255], v[112:127]
  ds_read_b128 v[176:179], v1 offset:34816
  ds_read_b128 v[180:183], v4 offset:38912
  s_waitcnt vmcnt(3)
  s_waitcnt lgkmcnt(4)
  v_mfma_f32_32x32x16_bf16 v[96:111], v[72:75], v[160:163], v[96:111]
  v_mfma_f32_32x32x16_bf16 v[112:127], v[72:75], v[164:167], v[112:127]
  ds_read_b128 v[184:187], v1 offset:35840
  ds_read_b128 v[188:191], v4 offset:39936
  s_waitcnt vmcnt(2)
  s_waitcnt lgkmcnt(4)
  v_mfma_f32_32x32x16_bf16 v[96:111], v[76:79], v[168:171], v[96:111]
  v_mfma_f32_32x32x16_bf16 v[112:127], v[76:79], v[172:175], v[112:127]
  s_waitcnt vmcnt(1)
  s_waitcnt lgkmcnt(2)
  v_mfma_f32_32x32x16_bf16 v[96:111], v[80:83], v[176:179], v[96:111]
  v_mfma_f32_32x32x16_bf16 v[112:127], v[80:83], v[180:183], v[112:127]
  s_waitcnt vmcnt(0)
  s_waitcnt lgkmcnt(0)
  v_mfma_f32_32x32x16_bf16 v[96:111], v[84:87], v[184:187], v[96:111]
  v_mfma_f32_32x32x16_bf16 v[112:127], v[84:87], v[188:191], v[112:127]
  s_nop 8
  v_lshlrev_b32 v6, 16, v200
  v_and_b32 v7, 0xffff0000, v200
  v_add_f32 v96, v96, v6
  v_add_f32 v97, v97, v7
  v_lshlrev_b32 v6, 16, v201
  v_and_b32 v7, 0xffff0000, v201
  v_add_f32 v98, v98, v6
  v_add_f32 v99, v99, v7
  v_lshlrev_b32 v6, 16, v202
  v_and_b32 v7, 0xffff0000, v202
  v_add_f32 v104, v104, v6
  v_add_f32 v105, v105, v7
  v_lshlrev_b32 v6, 16, v203
  v_and_b32 v7, 0xffff0000, v203
  v_add_f32 v106, v106, v6
  v_add_f32 v107, v107, v7
  v_lshlrev_b32 v6, 16, v204
  v_and_b32 v7, 0xffff0000, v204
  v_add_f32 v100, v100, v6
  v_add_f32 v101, v101, v7
  v_lshlrev_b32 v6, 16, v205
  v_and_b32 v7, 0xffff0000, v205
  v_add_f32 v102, v102, v6
  v_add_f32 v103, v103, v7
  v_lshlrev_b32 v6, 16, v206
  v_and_b32 v7, 0xffff0000, v206
  v_add_f32 v108, v108, v6
  v_add_f32 v109, v109, v7
  v_lshlrev_b32 v6, 16, v207
  v_and_b32 v7, 0xffff0000, v207
  v_add_f32 v110, v110, v6
  v_add_f32 v111, v111, v7
  v_cvt_pk_bf16_f32 v224, v96, v97
  v_cvt_pk_bf16_f32 v225, v98, v99
  v_cvt_pk_bf16_f32 v226, v104, v105
  v_cvt_pk_bf16_f32 v227, v106, v107
  v_cvt_pk_bf16_f32 v228, v100, v101
  v_cvt_pk_bf16_f32 v229, v102, v103
  v_cvt_pk_bf16_f32 v230, v108, v109
  v_cvt_pk_bf16_f32 v231, v110, v111
  buffer_store_dwordx4 v[224:227], v216, s[44:47], s24 offen
  buffer_store_dwordx4 v[228:231], v216, s[44:47], s24 offen offset:512
  v_lshlrev_b32 v6, 16, v208
  v_and_b32 v7, 0xffff0000, v208
  v_add_f32 v112, v112, v6
  v_add_f32 v113, v113, v7
  v_lshlrev_b32 v6, 16, v209
  v_and_b32 v7, 0xffff0000, v209
  v_add_f32 v114, v114, v6
  v_add_f32 v115, v115, v7
  v_lshlrev_b32 v6, 16, v210
  v_and_b32 v7, 0xffff0000, v210
  v_add_f32 v120, v120, v6
  v_add_f32 v121, v121, v7
  v_lshlrev_b32 v6, 16, v211
  v_and_b32 v7, 0xffff0000, v211
  v_add_f32 v122, v122, v6
  v_add_f32 v123, v123, v7
  v_lshlrev_b32 v6, 16, v212
  v_and_b32 v7, 0xffff0000, v212
  v_add_f32 v116, v116, v6
  v_add_f32 v117, v117, v7
  v_lshlrev_b32 v6, 16, v213
  v_and_b32 v7, 0xffff0000, v213
  v_add_f32 v118, v118, v6
  v_add_f32 v119, v119, v7
  v_lshlrev_b32 v6, 16, v214
  v_and_b32 v7, 0xffff0000, v214
  v_add_f32 v124, v124, v6
  v_add_f32 v125, v125, v7
  v_lshlrev_b32 v6, 16, v215
  v_and_b32 v7, 0xffff0000, v215
  v_add_f32 v126, v126, v6
  v_add_f32 v127, v127, v7
  v_cvt_pk_bf16_f32 v232, v112, v113
  v_cvt_pk_bf16_f32 v233, v114, v115
  v_cvt_pk_bf16_f32 v234, v120, v121
  v_cvt_pk_bf16_f32 v235, v122, v123
  v_cvt_pk_bf16_f32 v236, v116, v117
  v_cvt_pk_bf16_f32 v237, v118, v119
  v_cvt_pk_bf16_f32 v238, v124, v125
  v_cvt_pk_bf16_f32 v239, v126, v127
  buffer_store_dwordx4 v[232:235], v216, s[44:47], s25 offen
  buffer_store_dwordx4 v[236:239], v216, s[44:47], s25 offen offset:512
  v_add_f32 v8, v96, v97
  v_add_f32 v10, v112, v113
  v_mul_f32 v9, v96, v96
  v_mul_f32 v11, v112, v112
  v_add_f32 v8, v8, v98
  v_add_f32 v10, v10, v114
  v_add_f32 v8, v8, v99
  v_add_f32 v10, v10, v115
  v_add_f32 v8, v8, v100
  v_add_f32 v10, v10, v116
  v_add_f32 v8, v8, v101
  v_add_f32 v10, v10, v117
  v_add_f32 v8, v8, v102
  v_add_f32 v10, v10, v118
  v_add_f32 v8, v8, v103
  v_add_f32 v10, v10, v119
  v_add_f32 v8, v8, v104
  v_add_f32 v10, v10, v120
  v_add_f32 v8, v8, v105
  v_add_f32 v10, v10, v121
  v_add_f32 v8, v8, v106
  v_add_f32 v10, v10, v122
  v_add_f32 v8, v8, v107
  v_add_f32 v10, v10, v123
  v_add_f32 v8, v8, v108
  v_add_f32 v10, v10, v124
  v_add_f32 v8, v8, v109
  v_add_f32 v10, v10, v125
  v_add_f32 v8, v8, v110
  v_add_f32 v10, v10, v126
  v_add_f32 v8, v8, v111
  v_add_f32 v10, v10, v127
  v_fmac_f32 v9, v97, v97
  v_fmac_f32 v11, v113, v113
  v_fmac_f32 v9, v98, v98
  v_fmac_f32 v11, v114, v114
  v_fmac_f32 v9, v99, v99
  v_fmac_f32 v11, v115, v115
  v_fmac_f32 v9, v100, v100
  v_fmac_f32 v11, v116, v116
  v_fmac_f32 v9, v101, v101
  v_fmac_f32 v11, v117, v117
  v_fmac_f32 v9, v102, v102
  v_fmac_f32 v11, v118, v118
  v_fmac_f32 v9, v103, v103
  v_fmac_f32 v11, v119, v119
  v_fmac_f32 v9, v104, v104
  v_fmac_f32 v11, v120, v120
  v_fmac_f32 v9, v105, v105
  v_fmac_f32 v11, v121, v121
  v_fmac_f32 v9, v106, v106
  v_fmac_f32 v11, v122, v122
  v_fmac_f32 v9, v107, v107
  v_fmac_f32 v11, v123, v123
  v_fmac_f32 v9, v108, v108
  v_fmac_f32 v11, v124, v124
  v_fmac_f32 v9, v109, v109
  v_fmac_f32 v11, v125, v125
  v_fmac_f32 v9, v110, v110
  v_fmac_f32 v11, v126, v126
  v_fmac_f32 v9, v111, v111
  v_fmac_f32 v11, v127, v127
  v_mov_b32 v12, v8
  v_mov_b32 v13, v9
  v_mov_b32 v14, v10
  v_mov_b32 v15, v11
  s_nop 0
  v_permlane32_swap_b32 v8, v12
  v_permlane32_swap_b32 v9, v13
  v_permlane32_swap_b32 v10, v14
  v_permlane32_swap_b32 v11, v15
  s_nop 0
  v_add_f32 v8, v8, v12
  v_add_f32 v9, v9, v13
  v_add_f32 v10, v10, v14
  v_add_f32 v11, v11, v15
  v_mul_f32 v12, 0xbd000000, v8
  v_mul_f32 v14, 0xbd000000, v10
  v_fmac_f32 v9, v12, v8
  v_fmac_f32 v11, v14, v10
  buffer_store_dwordx2 v[8:9], v5, s[44:47], s26 offen
  s_add_u32 s26, s26, 4608
  buffer_store_dwordx2 v[10:11], v5, s[44:47], s26 offen
k3_wo_end:
  s_endpgm
k3_wo_codeend:
.globl k45_mlp0_kernel
.p2align 8
.type k45_mlp0_kernel,@function
k45_mlp0_kernel:
  s_mov_b32 s34, 0x0
  s_branch k45_mlp_body
.globl k45_mlp1_kernel
.p2align 8
.type k45_mlp1_kernel,@function
k45_mlp1_kernel:
  s_mov_b32 s34, 0x3000000
  s_branch k45_mlp_body
.p2align 6
k45_mlp_body:
  s_cmp_ge_u32 s2, 256
  s_cbranch_scc1 k45_mlp_end
  s_load_dwordx2 s[4:5], s[0:1], 64
  v_lshrrev_b32 v1, 6, v0
  v_and_b32 v0, 63, v0
  s_nop 0
  v_readfirstlane_b32 s3, v1
  v_lshlrev_b32 v1, 4, v0
  v_lshrrev_b32 v3, 4, v0
  s_lshr_b32 s16, s2, 3
  s_and_b32 s13, s2, 3
  s_lshl_b32 s13, s13, 1
  s_and_b32 s17, s16, 1
  s_add_u32 s13, s13, s17
  s_and_b32 s12, s2, 7
  s_lshr_b32 s12, s12, 2
  s_lshl_b32 s12, s12, 4
  s_lshr_b32 s16, s16, 1
  s_add_u32 s12, s12, s16
  s_mul_i32 s19, s3, 18432
  s_mul_i32 s18, s12, 73728
  s_add_u32 s18, s18, 61865984
  s_add_u32 s18, s18, s19
  s_lshl_b32 s20, s13, 2
  s_add_u32 s20, s20, s3
  s_mul_i32 s20, s20, 331776
  s_add_u32 s20, s20, 0
  s_waitcnt lgkmcnt(0)
  s_add_u32 s44, s4, s34
  s_addc_u32 s45, s5, 0
  s_mov_b32 s46, 0x6000000
  s_mov_b32 s47, 0x20000
  s_mov_b32 s8, s4
  s_mov_b32 s9, s5
  s_mov_b32 s10, 0x10000000
  s_mov_b32 s11, 0x20000
  s_mov_b32 s17, 0
  s_mul_i32 s17, s17, 9216
  s_add_u32 s14, s18, s17
  s_sub_u32 s15, s18, s17
  s_add_u32 m0, s19, 0
  s_add_u32 s21, s14, 0
  buffer_load_dwordx4 v1, s[44:47], s21 offen lds
  s_add_u32 m0, s19, 1024
  s_add_u32 s21, s14, 1024
  buffer_load_dwordx4 v1, s[44:47], s21 offen lds
  s_add_u32 m0, s19, 2048
  s_add_u32 s21, s14, 2048
  buffer_load_dwordx4 v1, s[44:47], s21 offen lds
  s_add_u32 m0, s19, 3072
  s_add_u32 s21, s14, 3072
  buffer_load_dwordx4 v1, s[44:47], s21 offen lds
  s_add_u32 m0, s19, 4096
  s_add_u32 s21, s14, 4096
  buffer_load_dwordx4 v1, s[44:47], s21 offen lds
  s_add_u32 m0, s19, 5120
  s_add_u32 s21, s14, 5120
  buffer_load_dwordx4 v1, s[44:47], s21 offen lds
  buffer_load_dwordx4 v[104:107], v1, s[8:11], s20 offen offset:0
  buffer_load_dwordx4 v[108:111], v1, s[8:11], s20 offen offset:1024
  buffer_load_dwordx4 v[112:115], v1, s[8:11], s20 offen offset:2048
  buffer_load_dwordx4 v[116:119], v1, s[8:11], s20 offen offset:3072
  s_add_u32 s20, s20, 4096
  buffer_load_dwordx4 v[120:123], v1, s[8:11], s20 offen offset:0
  buffer_load_dwordx4 v[124:127], v1, s[8:11], s20 offen offset:1024
  s_add_u32 m0, s19, 6144
  s_add_u32 s21, s14, 6144
  buffer_load_dwordx4 v1, s[44:47], s21 offen lds
  s_add_u32 m0, s19, 7168
  s_add_u32 s21, s14, 7168
  buffer_load_dwordx4 v1, s[44:47], s21 offen lds
  s_add_u32 m0, s19, 8192
  s_add_u32 s21, s14, 8192
  buffer_load_dwordx4 v1, s[44:47], s21 offen lds
  s_add_u32 m0, s19, 9216
  s_add_u32 s21, s15, 9216
  buffer_load_dwordx4 v1, s[44:47], s21 offen lds
  s_add_u32 m0, s19, 10240
  s_add_u32 s21, s15, 10240
  buffer_load_dwordx4 v1, s[44:47], s21 offen lds
  s_add_u32 m0, s19, 11264
  s_add_u32 s21, s15, 11264
  buffer_load_dwordx4 v1, s[44:47], s21 offen lds
  s_add_u32 m0, s19, 12288
  s_add_u32 s21, s15, 12288
  buffer_load_dwordx4 v1, s[44:47], s21 offen lds
  s_add_u32 m0, s19, 13312
  s_add_u32 s21, s15, 13312
  buffer_load_dwordx4 v1, s[44:47], s21 offen lds
  s_add_u32 m0, s19, 14336
  s_add_u32 s21, s15, 14336
  buffer_load_dwordx4 v1, s[44:47], s21 offen lds
  s_add_u32 m0, s19, 15360
  s_add_u32 s21, s15, 15360
  buffer_load_dwordx4 v1, s[44:47], s21 offen lds
  s_add_u32 m0, s19, 16384
  s_add_u32 s21, s15, 16384
  buffer_load_dwordx4 v1, s[44:47], s21 offen lds
  s_add_u32 m0, s19, 17408
  s_add_u32 s21, s15, 17408
  buffer_load_dwordx4 v1, s[44:47], s21 offen lds
  s_lshl_b32 s16, s12, 1
  s_mul_i32 s16, s16, 4608
  s_add_u32 s16, s16, 65011712
  s_add_u32 s17, s3, 0
  s_min_u32 s17, s17, 8
  s_lshl_b32 s17, s17, 10
  s_add_u32 m0, s17, 151552
  s_add_u32 s21, s16, s17
  buffer_load_dwordx4 v1, s[44:47], s21 offen lds
  s_add_u32 s17, s3, 4
  s_min_u32 s17, s17, 8
  s_lshl_b32 s17, s17, 10
  s_add_u32 m0, s17, 151552
  s_add_u32 s21, s16, s17
  buffer_load_dwordx4 v1, s[44:47], s21 offen lds
  s_add_u32 s17, s3, 8
  s_min_u32 s17, s17, 8
  s_lshl_b32 s17, s17, 10
  s_add_u32 m0, s17, 151552
  s_add_u32 s21, s16, s17
  buffer_load_dwordx4 v1, s[44:47], s21 offen lds
  s_mul_i32 s22, s13, 2304
  s_add_u32 s22, s22, 15728640
  s_lshl_b32 s23, s3, 10
  s_add_u32 s22, s22, s23
  s_add_u32 m0, s23, 147456
  s_nop 0
  buffer_load_dwordx4 v1, s[8:11], s22 offen lds
  v_lshrrev_b32 v2, 5, v0
  v_mul_u32_u24 v2, 4608, v2
  v_and_b32 v60, 31, v0
  v_lshlrev_b32 v60, 4, v60
  v_add_u32 v2, v2, v60
  v_add_u32 v2, 151552, v2
  v_add_u32 v4, 0, v1
  v_add_u32 v8, 73728, v1
  v_add_u32 v5, 18432, v1
  v_add_u32 v9, 92160, v1
  v_add_u32 v6, 36864, v1
  v_add_u32 v10, 110592, v1
  v_add_u32 v7, 55296, v1
  v_add_u32 v11, 129024, v1
  s_lshr_b32 s21, s3, 1
  s_lshl_b32 s21, s21, 10
  s_and_b32 s17, s3, 1
  s_lshl_b32 s17, s17, 3
  s_add_u32 s21, s21, s17
  v_add_u32 v12, s21, v8
  v_add_u32 v13, s21, v9
  v_add_u32 v14, s21, v10
  v_add_u32 v15, s21, v11
  v_lshlrev_b32 v28, 4, v3
  s_lshl_b32 s21, s3, 6
  s_add_u32 s21, s21, 147456
  v_add_u32 v28, s21, v28
  s_mul_i32 s26, s12, 73728
  s_mul_i32 s21, s13, 2359296
  s_add_u32 s26, s26, s21
  s_add_u32 s26, s26, 67108864
  s_lshl_b32 s21, s3, 10
  s_add_u32 s28, s26, s21
  s_lshr_b32 s21, s3, 1
  s_add_u32 s21, s21, 16
  s_lshl_b32 s21, s21, 10
  s_and_b32 s17, s3, 1
  s_lshl_b32 s17, s17, 3
  s_add_u32 s21, s21, s17
  s_add_u32 s30, s26, s21
  v_mov_b32 v30, 1.0
  v_mov_b32 v31, 1.0
  s_waitcnt vmcnt(22)
  s_barrier
  ds_read_b128 a[0:3], v4 offset:0
  ds_read_b128 a[4:7], v5 offset:0
  ds_read_b128 a[8:11], v6 offset:0
  ds_read_b128 a[12:15], v7 offset:0
  ds_read_b128 a[16:19], v4 offset:1024
  ds_read_b128 a[20:23], v5 offset:1024
  ds_read_b128 a[24:27], v6 offset:1024
  ds_read_b128 a[28:31], v7 offset:1024
  s_waitcnt vmcnt(20)
  s_waitcnt lgkmcnt(4)
  v_mfma_f32_16x16x32_bf16 v[72:75], v[104:107], a[0:3], 0
  v_mfma_f32_16x16x32_bf16 v[76:79], v[104:107], a[4:7], 0
  v_mfma_f32_16x16x32_bf16 v[80:83], v[104:107], a[8:11], 0
  v_mfma_f32_16x16x32_bf16 v[84:87], v[104:107], a[12:15], 0
  ds_read_b128 a[32:35], v4 offset:2048
  ds_read_b128 a[36:39], v5 offset:2048
  ds_read_b128 a[40:43], v6 offset:2048
  ds_read_b128 a[44:47], v7 offset:2048
  s_waitcnt lgkmcnt(4)
  v_mfma_f32_16x16x32_bf16 v[72:75], v[108:111], a[16:19], v[72:75]
  v_mfma_f32_16x16x32_bf16 v[76:79], v[108:111], a[20:23], v[76:79]
  v_mfma_f32_16x16x32_bf16 v[80:83], v[108:111], a[24:27], v[80:83]
  v_mfma_f32_16x16x32_bf16 v[84:87], v[108:111], a[28:31], v[84:87]
  ds_read_b128 a[48:51], v4 offset:3072
  ds_read_b128 a[52:55], v5 offset:3072
  ds_read_b128 a[56:59], v6 offset:3072
  ds_read_b128 a[60:63], v7 offset:3072
  s_waitcnt vmcnt(18)
  s_waitcnt lgkmcnt(4)
  v_mfma_f32_16x16x32_bf16 v[72:75], v[112:115], a[32:35], v[72:75]
  v_mfma_f32_16x16x32_bf16 v[76:79], v[112:115], a[36:39], v[76:79]
  v_mfma_f32_16x16x32_bf16 v[80:83], v[112:115], a[40:43], v[80:83]
  v_mfma_f32_16x16x32_bf16 v[84:87], v[112:115], a[44:47], v[84:87]
  ds_read_b128 a[64:67], v4 offset:4096
  ds_read_b128 a[68:71], v5 offset:4096
  ds_read_b128 a[72:75], v6 offset:4096
  ds_read_b128 a[76:79], v7 offset:4096
  s_waitcnt lgkmcnt(4)
  v_mfma_f32_16x16x32_bf16 v[72:75], v[116:119], a[48:51], v[72:75]
  v_mfma_f32_16x16x32_bf16 v[76:79], v[116:119], a[52:55], v[76:79]
  v_mfma_f32_16x16x32_bf16 v[80:83], v[116:119], a[56:59], v[80:83]
  v_mfma_f32_16x16x32_bf16 v[84:87], v[116:119], a[60:63], v[84:87]
  ds_read_b128 a[80:83], v4 offset:5120
  ds_read_b128 a[84:87], v5 offset:5120
  ds_read_b128 a[88:91], v6 offset:5120
  ds_read_b128 a[92:95], v7 offset:5120
  s_waitcnt vmcnt(10)
  s_barrier
  s_waitcnt lgkmcnt(4)
  v_mfma_f32_16x16x32_bf16 v[72:75], v[120:123], a[64:67], v[72:75]
  v_mfma_f32_16x16x32_bf16 v[76:79], v[120:123], a[68:71], v[76:79]
  v_mfma_f32_16x16x32_bf16 v[80:83], v[120:123], a[72:75], v[80:83]
  v_mfma_f32_16x16x32_bf16 v[84:87], v[120:123], a[76:79], v[84:87]
  ds_read_b128 a[96:99], v4 offset:6144
  ds_read_b128 a[100:103], v5 offset:6144
  ds_read_b128 a[104:107], v6 offset:6144
  ds_read_b128 a[108:111], v7 offset:6144
  s_waitcnt lgkmcnt(4)
  v_mfma_f32_16x16x32_bf16 v[72:75], v[124:127], a[80:83], v[72:75]
  v_mfma_f32_16x16x32_bf16 v[76:79], v[124:127], a[84:87], v[76:79]
  v_mfma_f32_16x16x32_bf16 v[80:83], v[124:127], a[88:91], v[80:83]
  v_mfma_f32_16x16x32_bf16 v[84:87], v[124:127], a[92:95], v[84:87]
  buffer_load_dwordx4 v[128:131], v1, s[8:11], s20 offen offset:2048
  buffer_load_dwordx4 v[132:135], v1, s[8:11], s20 offen offset:3072
  s_add_u32 s20, s20, 4096
  buffer_load_dwordx4 v[136:139], v1, s[8:11], s20 offen offset:0
  buffer_load_dwordx4 v[140:143], v1, s[8:11], s20 offen offset:1024
  buffer_load_dwordx4 v[144:147], v1, s[8:11], s20 offen offset:2048
  buffer_load_dwordx4 v[148:151], v1, s[8:11], s20 offen offset:3072
  s_add_u32 s20, s20, 4096
  buffer_load_dwordx4 v[152:155], v1, s[8:11], s20 offen offset:0
  buffer_load_dwordx4 v[156:159], v1, s[8:11], s20 offen offset:1024
  buffer_load_dwordx4 v[160:163], v1, s[8:11], s20 offen offset:2048
  buffer_load_dwordx4 v[164:167], v1, s[8:11], s20 offen offset:3072
  ds_read_b128 a[112:115], v4 offset:7168
  ds_read_b128 a[116:119], v5 offset:7168
  ds_read_b128 a[120:123], v6 offset:7168
  ds_read_b128 a[124:127], v7 offset:7168
  s_waitcnt vmcnt(9)
  s_waitcnt lgkmcnt(4)
  v_mfma_f32_16x16x32_bf16 v[72:75], v[128:131], a[96:99], v[72:75]
  v_mfma_f32_16x16x32_bf16 v[76:79], v[128:131], a[100:103], v[76:79]
  v_mfma_f32_16x16x32_bf16 v[80:83], v[128:131], a[104:107], v[80:83]
  v_mfma_f32_16x16x32_bf16 v[84:87], v[128:131], a[108:111], v[84:87]
  s_add_u32 s20, s20, 4096
  buffer_load_dwordx4 v[168:171], v1, s[8:11], s20 offen offset:0
  buffer_load_dwordx4 v[172:175], v1, s[8:11], s20 offen offset:1024
  ds_read_b128 a[128:131], v4 offset:8192
  ds_read_b128 a[132:135], v5 offset:8192
  ds_read_b128 a[136:139], v6 offset:8192
  ds_read_b128 a[140:143], v7 offset:8192
  s_waitcnt vmcnt(10)
  s_waitcnt lgkmcnt(4)
  v_mfma_f32_16x16x32_bf16 v[72:75], v[132:135], a[112:115], v[72:75]
  v_mfma_f32_16x16x32_bf16 v[76:79], v[132:135], a[116:119], v[76:79]
  v_mfma_f32_16x16x32_bf16 v[80:83], v[132:135], a[120:123], v[80:83]
  v_mfma_f32_16x16x32_bf16 v[84:87], v[132:135], a[124:127], v[84:87]
  buffer_load_dwordx4 v[176:179], v1, s[8:11], s20 offen offset:2048
  buffer_load_dwordx4 v[180:183], v1, s[8:11], s20 offen offset:3072
  ds_read_b128 a[144:147], v4 offset:9216
  ds_read_b128 a[148:151], v5 offset:9216
  ds_read_b128 a[152:155], v6 offset:9216
  ds_read_b128 a[156:159], v7 offset:9216
  s_waitcnt vmcnt(11)
  s_waitcnt lgkmcnt(4)
  v_mfma_f32_16x16x32_bf16 v[72:75], v[136:139], a[128:131], v[72:75]
  v_mfma_f32_16x16x32_bf16 v[76:79], v[136:139], a[132:135], v[76:79]
  v_mfma_f32_16x16x32_bf16 v[80:83], v[136:139], a[136:139], v[80:83]
  v_mfma_f32_16x16x32_bf16 v[84:87], v[136:139], a[140:143], v[84:87]
  s_add_u32 s20, s20, 4096
  buffer_load_dwordx4 v[184:187], v1, s[8:11], s20 offen offset:0
  buffer_load_dwordx4 v[188:191], v1, s[8:11], s20 offen offset:1024
  ds_read_b128 a[160:163], v4 offset:10240
  ds_read_b128 a[164:167], v5 offset:10240
  ds_read_b128 a[168:171], v6 offset:10240
  ds_read_b128 a[172:175], v7 offset:10240
  s_waitcnt vmcnt(12)
  s_waitcnt lgkmcnt(4)
  v_mfma_f32_16x16x32_bf16 v[72:75], v[140:143], a[144:147], v[72:75]
  v_mfma_f32_16x16x32_bf16 v[76:79], v[140:143], a[148:151], v[76:79]
  v_mfma_f32_16x16x32_bf16 v[80:83], v[140:143], a[152:155], v[80:83]
  v_mfma_f32_16x16x32_bf16 v[84:87], v[140:143], a[156:159], v[84:87]
  buffer_load_dwordx4 v[104:107], v1, s[8:11], s20 offen offset:2048
  buffer_load_dwordx4 v[108:111], v1, s[8:11], s20 offen offset:3072
  ds_read_b128 a[176:179], v4 offset:11264
  ds_read_b128 a[180:183], v5 offset:11264
  ds_read_b128 a[184:187], v6 offset:11264
  ds_read_b128 a[188:191], v7 offset:11264
  s_barrier
  s_waitcnt vmcnt(12)
  s_waitcnt lgkmcnt(4)
  v_mfma_f32_16x16x32_bf16 v[72:75], v[144:147], a[160:163], v[72:75]
  v_mfma_f32_16x16x32_bf16 v[76:79], v[144:147], a[164:167], v[76:79]
  v_mfma_f32_16x16x32_bf16 v[80:83], v[144:147], a[168:171], v[80:83]
  v_mfma_f32_16x16x32_bf16 v[84:87], v[144:147], a[172:175], v[84:87]
  s_add_u32 s20, s20, 4096
  buffer_load_dwordx4 v[112:115], v1, s[8:11], s20 offen offset:0
  buffer_load_dwordx4 v[116:119], v1, s[8:11], s20 offen offset:1024
  ds_read_b128 a[192:195], v4 offset:12288
  ds_read_b128 a[196:199], v5 offset:12288
  ds_read_b128 a[200:203], v6 offset:12288
  ds_read_b128 a[204:207], v7 offset:12288
  s_waitcnt lgkmcnt(4)
  v_mfma_f32_16x16x32_bf16 v[72:75], v[148:151], a[176:179], v[72:75]
  ds_read_b128 v[88:91], v2 offset:0
  ds_read_b128 v[92:95], v2 offset:512
  v_mfma_f32_16x16x32_bf16 v[76:79], v[148:151], a[180:183], v[76:79]
  ds_read_b128 v[96:99], v2 offset:1024
  ds_read_b128 v[100:103], v2 offset:1536
  v_mfma_f32_16x16x32_bf16 v[80:83], v[148:151], a[184:187], v[80:83]
  ds_read_b128 v[40:43], v2 offset:2048
  ds_read_b128 v[44:47], v2 offset:2560
  v_mfma_f32_16x16x32_bf16 v[84:87], v[148:151], a[188:191], v[84:87]
  buffer_load_dwordx4 v[120:123], v1, s[8:11], s20 offen offset:2048
  buffer_load_dwordx4 v[124:127], v1, s[8:11], s20 offen offset:3072
  ds_read_b128 a[208:211], v4 offset:13312
  ds_read_b128 a[212:215], v5 offset:13312
  ds_read_b128 a[216:219], v6 offset:13312
  ds_read_b128 a[220:223], v7 offset:13312
  s_waitcnt vmcnt(14)
  s_waitcnt lgkmcnt(10)
  v_mfma_f32_16x16x32_bf16 v[72:75], v[152:155], a[192:195], v[72:75]
  v_mfma_f32_16x16x32_bf16 v[76:79], v[152:155], a[196:199], v[76:79]
  v_mfma_f32_16x16x32_bf16 v[80:83], v[152:155], a[200:203], v[80:83]
  ds_read_b128 v[48:51], v2 offset:3072
  ds_read_b128 v[52:55], v2 offset:3584
  v_mfma_f32_16x16x32_bf16 v[84:87], v[152:155], a[204:207], v[84:87]
  s_add_u32 s20, s20, 4096
  buffer_load_dwordx4 v[128:131], v1, s[8:11], s20 offen offset:0
  buffer_load_dwordx4 v[132:135], v1, s[8:11], s20 offen offset:1024
  ds_read_b128 a[224:227], v4 offset:14336
  ds_read_b128 a[228:231], v5 offset:14336
  ds_read_b128 a[232:235], v6 offset:14336
  ds_read_b128 a[236:239], v7 offset:14336
  s_waitcnt lgkmcnt(6)
  v_mfma_f32_16x16x32_bf16 v[72:75], v[156:159], a[208:211], v[72:75]
  v_mfma_f32_16x16x32_bf16 v[76:79], v[156:159], a[212:215], v[76:79]
  v_mfma_f32_16x16x32_bf16 v[80:83], v[156:159], a[216:219], v[80:83]
  ds_read_b128 v[56:59], v2 offset:4096
  s_waitcnt lgkmcnt(0)
  v_mfma_f32_16x16x32_bf16 v[84:87], v[156:159], a[220:223], v[84:87]
  buffer_load_dwordx4 v[136:139], v1, s[8:11], s20 offen offset:2048
  buffer_load_dwordx4 v[140:143], v1, s[8:11], s20 offen offset:3072
  ds_read_b128 a[240:243], v4 offset:15360
  ds_read_b128 a[244:247], v5 offset:15360
  ds_read_b128 a[248:251], v6 offset:15360
  ds_read_b128 a[252:255], v7 offset:15360
  s_waitcnt vmcnt(16)
  v_mfma_f32_16x16x32_bf16 v[72:75], v[160:163], a[224:227], v[72:75]
  v_mfma_f32_16x16x32_bf16 v[76:79], v[160:163], a[228:231], v[76:79]
  v_mfma_f32_16x16x32_bf16 v[80:83], v[160:163], a[232:235], v[80:83]
  v_add_f32 v60, v88, v90
  v_add_f32 v62, v89, v91
  v_mfma_f32_16x16x32_bf16 v[84:87], v[160:163], a[236:239], v[84:87]
  s_add_u32 s20, s20, 4096
  buffer_load_dwordx4 v[144:147], v1, s[8:11], s20 offen offset:0
  buffer_load_dwordx4 v[148:151], v1, s[8:11], s20 offen offset:1024
  ds_read_b128 v[192:195], v4 offset:16384
  ds_read_b128 v[196:199], v5 offset:16384
  ds_read_b128 v[200:203], v6 offset:16384
  ds_read_b128 v[204:207], v7 offset:16384
  s_waitcnt lgkmcnt(4)
  v_mfma_f32_16x16x32_bf16 v[72:75], v[164:167], a[240:243], v[72:75]
  v_mfma_f32_16x16x32_bf16 v[76:79], v[164:167], a[244:247], v[76:79]
  v_mfma_f32_16x16x32_bf16 v[80:83], v[164:167], a[248:251], v[80:83]
  v_mul_f32 v61, v88, v88
  v_fmac_f32 v61, v90, v90
  v_mfma_f32_16x16x32_bf16 v[84:87], v[164:167], a[252:255], v[84:87]
  buffer_load_dwordx4 v[152:155], v1, s[8:11], s20 offen offset:2048
  buffer_load_dwordx4 v[156:159], v1, s[8:11], s20 offen offset:3072
  ds_read_b128 v[208:211], v4 offset:17408
  ds_read_b128 v[212:215], v5 offset:17408
  ds_read_b128 v[216:219], v6 offset:17408
  ds_read_b128 v[220:223], v7 offset:17408
  s_waitcnt vmcnt(18)
  s_waitcnt lgkmcnt(4)
  v_mfma_f32_16x16x32_bf16 v[72:75], v[168:171], v[192:195], v[72:75]
  v_mfma_f32_16x16x32_bf16 v[76:79], v[168:171], v[196:199], v[76:79]
  v_mfma_f32_16x16x32_bf16 v[80:83], v[168:171], v[200:203], v[80:83]
  v_add_f32 v60, v60, v92
  v_add_f32 v62, v62, v93
  v_mfma_f32_16x16x32_bf16 v[84:87], v[168:171], v[204:207], v[84:87]
  s_add_u32 s20, s20, 4096
  buffer_load_dwordx4 v[160:163], v1, s[8:11], s20 offen offset:0
  buffer_load_dwordx4 v[164:167], v1, s[8:11], s20 offen offset:1024
  s_waitcnt lgkmcnt(0)
  v_mfma_f32_16x16x32_bf16 v[72:75], v[172:175], v[208:211], v[72:75]
  v_fmac_f32 v61, v92, v92
  v_mfma_f32_16x16x32_bf16 v[76:79], v[172:175], v[212:215], v[76:79]
  v_add_f32 v60, v60, v94
  v_add_f32 v62, v62, v95
  v_mfma_f32_16x16x32_bf16 v[80:83], v[172:175], v[216:219], v[80:83]
  v_fmac_f32 v61, v94, v94
  v_add_f32 v60, v60, v96
  v_mfma_f32_16x16x32_bf16 v[84:87], v[172:175], v[220:223], v[84:87]
  buffer_load_dwordx4 v[168:171], v1, s[8:11], s20 offen offset:2048
  buffer_load_dwordx4 v[172:175], v1, s[8:11], s20 offen offset:3072
  v_add_f32 v62, v62, v97
  v_fmac_f32 v61, v96, v96
  v_add_f32 v60, v60, v98
  v_add_f32 v62, v62, v99
  v_fmac_f32 v61, v98, v98
  v_add_f32 v60, v60, v100
  v_add_f32 v62, v62, v101
  v_fmac_f32 v61, v100, v100
  v_add_f32 v60, v60, v102
  v_add_f32 v62, v62, v103
  v_fmac_f32 v61, v102, v102
  v_add_f32 v60, v60, v40
  v_add_f32 v62, v62, v41
  v_fmac_f32 v61, v40, v40
  v_add_f32 v60, v60, v42
  v_add_f32 v62, v62, v43
  v_fmac_f32 v61, v42, v42
  v_add_f32 v60, v60, v44
  v_add_f32 v62, v62, v45
  v_fmac_f32 v61, v44, v44
  v_add_f32 v60, v60, v46
  v_add_f32 v62, v62, v47
  v_fmac_f32 v61, v46, v46
  v_add_f32 v60, v60, v48
  v_add_f32 v62, v62, v49
  v_fmac_f32 v61, v48, v48
  v_add_f32 v60, v60, v50
  v_add_f32 v62, v62, v51
  v_fmac_f32 v61, v50, v50
  v_add_f32 v60, v60, v52
  v_add_f32 v62, v62, v53
  v_fmac_f32 v61, v52, v52
  v_add_f32 v60, v60, v54
  v_add_f32 v62, v62, v55
  v_fmac_f32 v61, v54, v54
  v_add_f32 v60, v60, v56
  v_add_f32 v62, v62, v57
  v_fmac_f32 v61, v56, v56
  v_add_f32 v60, v60, v58
  v_add_f32 v62, v62, v59
  v_fmac_f32 v61, v58, v58
  v_fmac_f32 v62, 0x3d000000, v61
  v_mul_f32 v61, 0x3ae38e39, v60
  v_fma_f32 v62, -v60, v61, v62
  v_max_f32 v62, 0, v62
  v_mov_b32 v60, v61
  v_mov_b32 v63, 0x3727c5ac
  v_fmac_f32 v63, 0x3ae38e39, v62
  v_rsq_f32 v24, v63
  v_sub_f32 v16, 0, v60
  s_nop 0
  v_mov_b32 v18, v16
  s_nop 1
  v_permlane32_swap_b32 v16, v18
  v_mov_b32 v17, v16
  v_mov_b32 v19, v18
  s_nop 1
  v_permlane16_swap_b32 v16, v17
  v_permlane16_swap_b32 v18, v19
  v_mov_b32 v26, v24
  s_nop 1
  v_permlane32_swap_b32 v24, v26
  v_mov_b32 v25, v24
  v_mov_b32 v27, v26
  s_nop 1
  v_permlane16_swap_b32 v24, v25
  v_permlane16_swap_b32 v26, v27
  s_nop 1
  v_mul_f32 v20, 0xbfb8aa3b, v24
  v_mul_f32 v21, 0xbfb8aa3b, v25
  v_mul_f32 v22, 0xbfb8aa3b, v26
  v_mul_f32 v23, 0xbfb8aa3b, v27
  ds_read_b128 v[32:35], v28 offset:0
  s_waitcnt vmcnt(20)
  v_mfma_f32_16x16x32_bf16 v[88:91], v[176:179], a[0:3], 0
  v_mfma_f32_16x16x32_bf16 v[92:95], v[176:179], a[4:7], 0
  v_mfma_f32_16x16x32_bf16 v[96:99], v[176:179], a[8:11], 0
  v_mfma_f32_16x16x32_bf16 v[100:103], v[176:179], a[12:15], 0
  s_add_u32 s20, s20, 4096
  buffer_load_dwordx4 v[176:179], v1, s[8:11], s20 offen offset:0
  v_mfma_f32_16x16x32_bf16 v[88:91], v[180:183], a[16:19], v[88:91]
  v_mfma_f32_16x16x32_bf16 v[92:95], v[180:183], a[20:23], v[92:95]
  v_mfma_f32_16x16x32_bf16 v[96:99], v[180:183], a[24:27], v[96:99]
  ds_read_b128 v[36:39], v28 offset:256
  s_waitcnt lgkmcnt(1)
  v_mfma_f32_16x16x32_bf16 v[100:103], v[180:183], a[28:31], v[100:103]
  buffer_load_dwordx4 v[180:183], v1, s[8:11], s20 offen offset:1024
  v_fmac_f32 v72, v32, v16
  s_waitcnt vmcnt(20)
  v_mfma_f32_16x16x32_bf16 v[88:91], v[184:187], a[32:35], v[88:91]
  v_fmac_f32 v73, v33, v16
  v_fmac_f32 v74, v34, v16
  v_mfma_f32_16x16x32_bf16 v[92:95], v[184:187], a[36:39], v[92:95]
  v_fmac_f32 v75, v35, v16
  v_fmac_f32 v76, v32, v17
  v_mfma_f32_16x16x32_bf16 v[96:99], v[184:187], a[40:43], v[96:99]
  v_fmac_f32 v77, v33, v17
  v_fmac_f32 v78, v34, v17
  v_mfma_f32_16x16x32_bf16 v[100:103], v[184:187], a[44:47], v[100:103]
  buffer_load_dwordx4 v[184:187], v1, s[8:11], s20 offen offset:2048
  v_fmac_f32 v79, v35, v17
  v_mfma_f32_16x16x32_bf16 v[88:91], v[188:191], a[48:51], v[88:91]
  v_mul_f32 v40, v72, v20
  v_mul_f32 v41, v73, v20
  v_mfma_f32_16x16x32_bf16 v[92:95], v[188:191], a[52:55], v[92:95]
  v_mul_f32 v42, v74, v20
  v_mul_f32 v43, v75, v20
  v_mfma_f32_16x16x32_bf16 v[96:99], v[188:191], a[56:59], v[96:99]
  v_mul_f32 v44, v76, v21
  v_mul_f32 v45, v77, v21
  v_mfma_f32_16x16x32_bf16 v[100:103], v[188:191], a[60:63], v[100:103]
  buffer_load_dwordx4 v[188:191], v1, s[8:11], s20 offen offset:3072
  v_mul_f32 v46, v78, v21
  s_waitcnt vmcnt(20)
  v_mfma_f32_16x16x32_bf16 v[88:91], v[104:107], a[64:67], v[88:91]
  v_mul_f32 v47, v79, v21
  v_exp_f32 v40, v40
  v_mfma_f32_16x16x32_bf16 v[92:95], v[104:107], a[68:71], v[92:95]
  v_exp_f32 v41, v41
  v_mfma_f32_16x16x32_bf16 v[96:99], v[104:107], a[72:75], v[96:99]
  v_exp_f32 v42, v42
  v_mfma_f32_16x16x32_bf16 v[100:103], v[104:107], a[76:79], v[100:103]
  s_add_u32 s20, s20, 4096
  buffer_load_dwordx4 v[104:107], v1, s[8:11], s20 offen offset:0
  v_mfma_f32_16x16x32_bf16 v[88:91], v[108:111], a[80:83], v[88:91]
  v_exp_f32 v43, v43
  v_mfma_f32_16x16x32_bf16 v[92:95], v[108:111], a[84:87], v[92:95]
  v_exp_f32 v44, v44
  v_mfma_f32_16x16x32_bf16 v[96:99], v[108:111], a[88:91], v[96:99]
  v_exp_f32 v45, v45
  v_mfma_f32_16x16x32_bf16 v[100:103], v[108:111], a[92:95], v[100:103]
  buffer_load_dwordx4 v[108:111], v1, s[8:11], s20 offen offset:1024
  s_waitcnt vmcnt(20)
  v_mfma_f32_16x16x32_bf16 v[88:91], v[112:115], a[96:99], v[88:91]
  v_exp_f32 v46, v46
  v_mfma_f32_16x16x32_bf16 v[92:95], v[112:115], a[100:103], v[92:95]
  v_exp_f32 v47, v47
  v_mfma_f32_16x16x32_bf16 v[96:99], v[112:115], a[104:107], v[96:99]
  v_add_f32 v40, 1.0, v40
  v_add_f32 v41, 1.0, v41
  v_mfma_f32_16x16x32_bf16 v[100:103], v[112:115], a[108:111], v[100:103]
  buffer_load_dwordx4 v[112:115], v1, s[8:11], s20 offen offset:2048
  v_add_f32 v42, 1.0, v42
  v_mfma_f32_16x16x32_bf16 v[88:91], v[116:119], a[112:115], v[88:91]
  v_add_f32 v43, 1.0, v43
  v_add_f32 v44, 1.0, v44
  v_mfma_f32_16x16x32_bf16 v[92:95], v[116:119], a[116:119], v[92:95]
  v_add_f32 v45, 1.0, v45
  v_add_f32 v46, 1.0, v46
  v_mfma_f32_16x16x32_bf16 v[96:99], v[116:119], a[120:123], v[96:99]
  v_add_f32 v47, 1.0, v47
  v_rcp_f32 v40, v40
  v_mfma_f32_16x16x32_bf16 v[100:103], v[116:119], a[124:127], v[100:103]
  buffer_load_dwordx4 v[116:119], v1, s[8:11], s20 offen offset:3072
  s_waitcnt vmcnt(20)
  v_mfma_f32_16x16x32_bf16 v[88:91], v[120:123], a[128:131], v[88:91]
  v_rcp_f32 v41, v41
  v_mfma_f32_16x16x32_bf16 v[92:95], v[120:123], a[132:135], v[92:95]
  v_rcp_f32 v42, v42
  v_mfma_f32_16x16x32_bf16 v[96:99], v[120:123], a[136:139], v[96:99]
  v_rcp_f32 v43, v43
  v_mfma_f32_16x16x32_bf16 v[100:103], v[120:123], a[140:143], v[100:103]
  s_add_u32 s20, s20, 4096
  buffer_load_dwordx4 v[120:123], v1, s[8:11], s20 offen offset:0
  v_mfma_f32_16x16x32_bf16 v[88:91], v[124:127], a[144:147], v[88:91]
  v_rcp_f32 v44, v44
  v_mfma_f32_16x16x32_bf16 v[92:95], v[124:127], a[148:151], v[92:95]
  v_rcp_f32 v45, v45
  v_mfma_f32_16x16x32_bf16 v[96:99], v[124:127], a[152:155], v[96:99]
  v_rcp_f32 v46, v46
  v_mfma_f32_16x16x32_bf16 v[100:103], v[124:127], a[156:159], v[100:103]
  buffer_load_dwordx4 v[124:127], v1, s[8:11], s20 offen offset:1024
  v_rcp_f32 v47, v47
  s_waitcnt vmcnt(20)
  v_mfma_f32_16x16x32_bf16 v[88:91], v[128:131], a[160:163], v[88:91]
  v_mul_f32 v72, v72, v40
  v_mfma_f32_16x16x32_bf16 v[92:95], v[128:131], a[164:167], v[92:95]
  v_mul_f32 v73, v73, v41
  v_mul_f32 v74, v74, v42
  v_mfma_f32_16x16x32_bf16 v[96:99], v[128:131], a[168:171], v[96:99]
  v_mul_f32 v75, v75, v43
  v_mul_f32 v76, v76, v44
  v_mfma_f32_16x16x32_bf16 v[100:103], v[128:131], a[172:175], v[100:103]
  buffer_load_dwordx4 v[128:131], v1, s[8:11], s20 offen offset:2048
  v_mul_f32 v77, v77, v45
  v_mfma_f32_16x16x32_bf16 v[88:91], v[132:135], a[176:179], v[88:91]
  v_mul_f32 v78, v78, v46
  v_mul_f32 v79, v79, v47
  v_mfma_f32_16x16x32_bf16 v[92:95], v[132:135], a[180:183], v[92:95]
  v_cvt_pk_bf16_f32 v56, v72, v73
  v_cvt_pk_bf16_f32 v57, v74, v75
  v_mfma_f32_16x16x32_bf16 v[96:99], v[132:135], a[184:187], v[96:99]
  v_cvt_pk_bf16_f32 v58, v76, v77
  v_cvt_pk_bf16_f32 v59, v78, v79
  v_mfma_f32_16x16x32_bf16 v[100:103], v[132:135], a[188:191], v[100:103]
  buffer_load_dwordx4 v[132:135], v1, s[8:11], s20 offen offset:3072
  ds_write_b64 v12, v[56:57] offset:0
  s_waitcnt vmcnt(20)
  v_mfma_f32_16x16x32_bf16 v[88:91], v[136:139], a[192:195], v[88:91]
  ds_write_b64 v13, v[58:59] offset:0
  v_fmac_f32 v80, v32, v18
  v_mfma_f32_16x16x32_bf16 v[92:95], v[136:139], a[196:199], v[92:95]
  v_fmac_f32 v81, v33, v18
  v_fmac_f32 v82, v34, v18
  v_mfma_f32_16x16x32_bf16 v[96:99], v[136:139], a[200:203], v[96:99]
  v_fmac_f32 v83, v35, v18
  v_fmac_f32 v84, v32, v19
  v_mfma_f32_16x16x32_bf16 v[100:103], v[136:139], a[204:207], v[100:103]
  s_add_u32 s20, s20, 4096
  buffer_load_dwordx4 v[136:139], v1, s[8:11], s20 offen offset:0
  v_mfma_f32_16x16x32_bf16 v[88:91], v[140:143], a[208:211], v[88:91]
  v_fmac_f32 v85, v33, v19
  v_fmac_f32 v86, v34, v19
  v_mfma_f32_16x16x32_bf16 v[92:95], v[140:143], a[212:215], v[92:95]
  v_fmac_f32 v87, v35, v19
  v_mul_f32 v48, v80, v22
  v_mfma_f32_16x16x32_bf16 v[96:99], v[140:143], a[216:219], v[96:99]
  v_mul_f32 v49, v81, v22
  v_mul_f32 v50, v82, v22
  v_mfma_f32_16x16x32_bf16 v[100:103], v[140:143], a[220:223], v[100:103]
  buffer_load_dwordx4 v[140:143], v1, s[8:11], s20 offen offset:1024
  v_mul_f32 v51, v83, v22
  s_waitcnt vmcnt(20)
  v_mfma_f32_16x16x32_bf16 v[88:91], v[144:147], a[224:227], v[88:91]
  v_mul_f32 v52, v84, v23
  v_mul_f32 v53, v85, v23
  v_mfma_f32_16x16x32_bf16 v[92:95], v[144:147], a[228:231], v[92:95]
  v_mul_f32 v54, v86, v23
  v_mul_f32 v55, v87, v23
  v_mfma_f32_16x16x32_bf16 v[96:99], v[144:147], a[232:235], v[96:99]
  v_exp_f32 v48, v48
  v_mfma_f32_16x16x32_bf16 v[100:103], v[144:147], a[236:239], v[100:103]
  buffer_load_dwordx4 v[144:147], v1, s[8:11], s20 offen offset:2048
  v_exp_f32 v49, v49
  v_mfma_f32_16x16x32_bf16 v[88:91], v[148:151], a[240:243], v[88:91]
  v_exp_f32 v50, v50
  v_mfma_f32_16x16x32_bf16 v[92:95], v[148:151], a[244:247], v[92:95]
  v_exp_f32 v51, v51
  v_mfma_f32_16x16x32_bf16 v[96:99], v[148:151], a[248:251], v[96:99]
  v_exp_f32 v52, v52
  v_mfma_f32_16x16x32_bf16 v[100:103], v[148:151], a[252:255], v[100:103]
  buffer_load_dwordx4 v[148:151], v1, s[8:11], s20 offen offset:3072
  s_waitcnt vmcnt(20)
  v_mfma_f32_16x16x32_bf16 v[88:91], v[152:155], v[192:195], v[88:91]
  v_exp_f32 v53, v53
  v_mfma_f32_16x16x32_bf16 v[92:95], v[152:155], v[196:199], v[92:95]
  v_exp_f32 v54, v54
  v_mfma_f32_16x16x32_bf16 v[96:99], v[152:155], v[200:203], v[96:99]
  v_exp_f32 v55, v55
  v_mfma_f32_16x16x32_bf16 v[100:103], v[152:155], v[204:207], v[100:103]
  s_add_u32 s20, s20, 4096
  buffer_load_dwordx4 v[152:155], v1, s[8:11], s20 offen offset:0
  v_mfma_f32_16x16x32_bf16 v[88:91], v[156:159], v[208:211], v[88:91]
  v_add_f32 v48, 1.0, v48
  v_add_f32 v49, 1.0, v49
  v_mfma_f32_16x16x32_bf16 v[92:95], v[156:159], v[212:215], v[92:95]
  v_add_f32 v50, 1.0, v50
  v_add_f32 v51, 1.0, v51
  v_mfma_f32_16x16x32_bf16 v[96:99], v[156:159], v[216:219], v[96:99]
  v_add_f32 v52, 1.0, v52
  v_add_f32 v53, 1.0, v53
  v_mfma_f32_16x16x32_bf16 v[100:103], v[156:159], v[220:223], v[100:103]
  buffer_load_dwordx4 v[156:159], v1, s[8:11], s20 offen offset:1024
  v_add_f32 v54, 1.0, v54
  v_add_f32 v55, 1.0, v55
  v_rcp_f32 v48, v48
  v_rcp_f32 v49, v49
  v_rcp_f32 v50, v50
  v_rcp_f32 v51, v51
  v_rcp_f32 v52, v52
  v_rcp_f32 v53, v53
  v_rcp_f32 v54, v54
  v_rcp_f32 v55, v55
  v_mul_f32 v80, v80, v48
  v_mul_f32 v81, v81, v49
  v_mul_f32 v82, v82, v50
  v_mul_f32 v83, v83, v51
  v_mul_f32 v84, v84, v52
  v_mul_f32 v85, v85, v53
  v_mul_f32 v86, v86, v54
  v_mul_f32 v87, v87, v55
  v_cvt_pk_bf16_f32 v60, v80, v81
  v_cvt_pk_bf16_f32 v61, v82, v83
  v_cvt_pk_bf16_f32 v62, v84, v85
  v_cvt_pk_bf16_f32 v63, v86, v87
  ds_write_b64 v14, v[60:61] offset:0
  ds_write_b64 v15, v[62:63] offset:0
  s_waitcnt vmcnt(20)
  v_mfma_f32_16x16x32_bf16 v[72:75], v[160:163], a[0:3], 0
  v_mfma_f32_16x16x32_bf16 v[76:79], v[160:163], a[4:7], 0
  v_mfma_f32_16x16x32_bf16 v[80:83], v[160:163], a[8:11], 0
  v_mfma_f32_16x16x32_bf16 v[84:87], v[160:163], a[12:15], 0
  buffer_load_dwordx4 v[160:163], v1, s[8:11], s20 offen offset:2048
  v_mfma_f32_16x16x32_bf16 v[72:75], v[164:167], a[16:19], v[72:75]
  v_mfma_f32_16x16x32_bf16 v[76:79], v[164:167], a[20:23], v[76:79]
  v_mfma_f32_16x16x32_bf16 v[80:83], v[164:167], a[24:27], v[80:83]
  ds_read_b128 v[32:35], v28 offset:512
  s_waitcnt lgkmcnt(5)
  v_mfma_f32_16x16x32_bf16 v[84:87], v[164:167], a[28:31], v[84:87]
  buffer_load_dwordx4 v[164:167], v1, s[8:11], s20 offen offset:3072
  v_fmac_f32 v88, v36, v16
  s_waitcnt vmcnt(20)
  v_mfma_f32_16x16x32_bf16 v[72:75], v[168:171], a[32:35], v[72:75]
  v_fmac_f32 v89, v37, v16
  v_fmac_f32 v90, v38, v16
  v_mfma_f32_16x16x32_bf16 v[76:79], v[168:171], a[36:39], v[76:79]
  v_fmac_f32 v91, v39, v16
  v_fmac_f32 v92, v36, v17
  v_mfma_f32_16x16x32_bf16 v[80:83], v[168:171], a[40:43], v[80:83]
  v_fmac_f32 v93, v37, v17
  v_fmac_f32 v94, v38, v17
  v_mfma_f32_16x16x32_bf16 v[84:87], v[168:171], a[44:47], v[84:87]
  s_add_u32 s20, s20, 4096
  buffer_load_dwordx4 v[168:171], v1, s[8:11], s20 offen offset:0
  v_mfma_f32_16x16x32_bf16 v[72:75], v[172:175], a[48:51], v[72:75]
  v_fmac_f32 v95, v39, v17
  v_mul_f32 v40, v88, v20
  v_mfma_f32_16x16x32_bf16 v[76:79], v[172:175], a[52:55], v[76:79]
  v_mul_f32 v41, v89, v20
  v_mul_f32 v42, v90, v20
  v_mfma_f32_16x16x32_bf16 v[80:83], v[172:175], a[56:59], v[80:83]
  v_mul_f32 v43, v91, v20
  v_mul_f32 v44, v92, v21
  v_mfma_f32_16x16x32_bf16 v[84:87], v[172:175], a[60:63], v[84:87]
  buffer_load_dwordx4 v[172:175], v1, s[8:11], s20 offen offset:1024
  v_mul_f32 v45, v93, v21
  s_waitcnt vmcnt(20)
  v_mfma_f32_16x16x32_bf16 v[72:75], v[176:179], a[64:67], v[72:75]
  v_mul_f32 v46, v94, v21
  v_mul_f32 v47, v95, v21
  v_mfma_f32_16x16x32_bf16 v[76:79], v[176:179], a[68:71], v[76:79]
  v_exp_f32 v40, v40
  v_mfma_f32_16x16x32_bf16 v[80:83], v[176:179], a[72:75], v[80:83]
  v_exp_f32 v41, v41
  v_mfma_f32_16x16x32_bf16 v[84:87], v[176:179], a[76:79], v[84:87]
  buffer_load_dwordx4 v[176:179], v1, s[8:11], s20 offen offset:2048
  v_exp_f32 v42, v42
  v_mfma_f32_16x16x32_bf16 v[72:75], v[180:183], a[80:83], v[72:75]
  v_exp_f32 v43, v43
  v_mfma_f32_16x16x32_bf16 v[76:79], v[180:183], a[84:87], v[76:79]
  v_exp_f32 v44, v44
  v_mfma_f32_16x16x32_bf16 v[80:83], v[180:183], a[88:91], v[80:83]
  v_exp_f32 v45, v45
  v_mfma_f32_16x16x32_bf16 v[84:87], v[180:183], a[92:95], v[84:87]
  buffer_load_dwordx4 v[180:183], v1, s[8:11], s20 offen offset:3072
  s_waitcnt vmcnt(20)
  v_mfma_f32_16x16x32_bf16 v[72:75], v[184:187], a[96:99], v[72:75]
  v_exp_f32 v46, v46
  v_mfma_f32_16x16x32_bf16 v[76:79], v[184:187], a[100:103], v[76:79]
  v_exp_f32 v47, v47
  v_mfma_f32_16x16x32_bf16 v[80:83], v[184:187], a[104:107], v[80:83]
  v_add_f32 v40, 1.0, v40
  v_add_f32 v41, 1.0, v41
  v_mfma_f32_16x16x32_bf16 v[84:87], v[184:187], a[108:111], v[84:87]
  s_add_u32 s20, s20, 4096
  buffer_load_dwordx4 v[184:187], v1, s[8:11], s20 offen offset:0
  v_mfma_f32_16x16x32_bf16 v[72:75], v[188:191], a[112:115], v[72:75]
  v_add_f32 v42, 1.0, v42
  v_add_f32 v43, 1.0, v43
  v_mfma_f32_16x16x32_bf16 v[76:79], v[188:191], a[116:119], v[76:79]
  v_add_f32 v44, 1.0, v44
  v_add_f32 v45, 1.0, v45
  v_mfma_f32_16x16x32_bf16 v[80:83], v[188:191], a[120:123], v[80:83]
  v_add_f32 v46, 1.0, v46
  v_add_f32 v47, 1.0, v47
  v_mfma_f32_16x16x32_bf16 v[84:87], v[188:191], a[124:127], v[84:87]
  buffer_load_dwordx4 v[188:191], v1, s[8:11], s20 offen offset:1024
  v_rcp_f32 v40, v40
  s_waitcnt vmcnt(20)
  v_mfma_f32_16x16x32_bf16 v[72:75], v[104:107], a[128:131], v[72:75]
  v_rcp_f32 v41, v41
  v_mfma_f32_16x16x32_bf16 v[76:79], v[104:107], a[132:135], v[76:79]
  v_rcp_f32 v42, v42
  v_mfma_f32_16x16x32_bf16 v[80:83], v[104:107], a[136:139], v[80:83]
  v_rcp_f32 v43, v43
  v_mfma_f32_16x16x32_bf16 v[84:87], v[104:107], a[140:143], v[84:87]
  buffer_load_dwordx4 v[104:107], v1, s[8:11], s20 offen offset:2048
  v_mfma_f32_16x16x32_bf16 v[72:75], v[108:111], a[144:147], v[72:75]
  v_rcp_f32 v44, v44
  v_mfma_f32_16x16x32_bf16 v[76:79], v[108:111], a[148:151], v[76:79]
  v_rcp_f32 v45, v45
  v_mfma_f32_16x16x32_bf16 v[80:83], v[108:111], a[152:155], v[80:83]
  v_rcp_f32 v46, v46
  v_mfma_f32_16x16x32_bf16 v[84:87], v[108:111], a[156:159], v[84:87]
  buffer_load_dwordx4 v[108:111], v1, s[8:11], s20 offen offset:3072
  v_rcp_f32 v47, v47
  s_waitcnt vmcnt(20)
  v_mfma_f32_16x16x32_bf16 v[72:75], v[112:115], a[160:163], v[72:75]
  v_mul_f32 v88, v88, v40
  v_mfma_f32_16x16x32_bf16 v[76:79], v[112:115], a[164:167], v[76:79]
  v_mul_f32 v89, v89, v41
  v_mul_f32 v90, v90, v42
  v_mfma_f32_16x16x32_bf16 v[80:83], v[112:115], a[168:171], v[80:83]
  v_mul_f32 v91, v91, v43
  v_mul_f32 v92, v92, v44
  v_mfma_f32_16x16x32_bf16 v[84:87], v[112:115], a[172:175], v[84:87]
  s_add_u32 s20, s20, 4096
  buffer_load_dwordx4 v[112:115], v1, s[8:11], s20 offen offset:0
  v_mfma_f32_16x16x32_bf16 v[72:75], v[116:119], a[176:179], v[72:75]
  v_mul_f32 v93, v93, v45
  v_mul_f32 v94, v94, v46
  v_mfma_f32_16x16x32_bf16 v[76:79], v[116:119], a[180:183], v[76:79]
  v_mul_f32 v95, v95, v47
  v_cvt_pk_bf16_f32 v56, v88, v89
  v_mfma_f32_16x16x32_bf16 v[80:83], v[116:119], a[184:187], v[80:83]
  v_cvt_pk_bf16_f32 v57, v90, v91
  v_cvt_pk_bf16_f32 v58, v92, v93
  v_mfma_f32_16x16x32_bf16 v[84:87], v[116:119], a[188:191], v[84:87]
  buffer_load_dwordx4 v[116:119], v1, s[8:11], s20 offen offset:1024
  v_cvt_pk_bf16_f32 v59, v94, v95
  s_waitcnt vmcnt(20)
  v_mfma_f32_16x16x32_bf16 v[72:75], v[120:123], a[192:195], v[72:75]
  ds_write_b64 v12, v[56:57] offset:2048
  ds_write_b64 v13, v[58:59] offset:2048
  v_mfma_f32_16x16x32_bf16 v[76:79], v[120:123], a[196:199], v[76:79]
  v_fmac_f32 v96, v36, v18
  v_fmac_f32 v97, v37, v18
  v_mfma_f32_16x16x32_bf16 v[80:83], v[120:123], a[200:203], v[80:83]
  v_fmac_f32 v98, v38, v18
  v_fmac_f32 v99, v39, v18
  v_mfma_f32_16x16x32_bf16 v[84:87], v[120:123], a[204:207], v[84:87]
  buffer_load_dwordx4 v[120:123], v1, s[8:11], s20 offen offset:2048
  v_fmac_f32 v100, v36, v19
  v_mfma_f32_16x16x32_bf16 v[72:75], v[124:127], a[208:211], v[72:75]
  v_fmac_f32 v101, v37, v19
  v_fmac_f32 v102, v38, v19
  v_mfma_f32_16x16x32_bf16 v[76:79], v[124:127], a[212:215], v[76:79]
  v_fmac_f32 v103, v39, v19
  v_mul_f32 v48, v96, v22
  v_mfma_f32_16x16x32_bf16 v[80:83], v[124:127], a[216:219], v[80:83]
  v_mul_f32 v49, v97, v22
  v_mul_f32 v50, v98, v22
  v_mfma_f32_16x16x32_bf16 v[84:87], v[124:127], a[220:223], v[84:87]
  buffer_load_dwordx4 v[124:127], v1, s[8:11], s20 offen offset:3072
  v_mul_f32 v51, v99, v22
  s_waitcnt vmcnt(20)
  v_mfma_f32_16x16x32_bf16 v[72:75], v[128:131], a[224:227], v[72:75]
  v_mul_f32 v52, v100, v23
  v_mul_f32 v53, v101, v23
  v_mfma_f32_16x16x32_bf16 v[76:79], v[128:131], a[228:231], v[76:79]
  v_mul_f32 v54, v102, v23
  v_mul_f32 v55, v103, v23
  v_mfma_f32_16x16x32_bf16 v[80:83], v[128:131], a[232:235], v[80:83]
  v_exp_f32 v48, v48
  v_mfma_f32_16x16x32_bf16 v[84:87], v[128:131], a[236:239], v[84:87]
  s_add_u32 s20, s20, 4096
  buffer_load_dwordx4 v[128:131], v1, s[8:11], s20 offen offset:0
  v_mfma_f32_16x16x32_bf16 v[72:75], v[132:135], a[240:243], v[72:75]
  v_exp_f32 v49, v49
  v_mfma_f32_16x16x32_bf16 v[76:79], v[132:135], a[244:247], v[76:79]
  v_exp_f32 v50, v50
  v_mfma_f32_16x16x32_bf16 v[80:83], v[132:135], a[248:251], v[80:83]
  v_exp_f32 v51, v51
  v_mfma_f32_16x16x32_bf16 v[84:87], v[132:135], a[252:255], v[84:87]
  buffer_load_dwordx4 v[132:135], v1, s[8:11], s20 offen offset:1024
  v_exp_f32 v52, v52
  s_waitcnt vmcnt(20)
  v_mfma_f32_16x16x32_bf16 v[72:75], v[136:139], v[192:195], v[72:75]
  v_exp_f32 v53, v53
  v_mfma_f32_16x16x32_bf16 v[76:79], v[136:139], v[196:199], v[76:79]
  v_exp_f32 v54, v54
  v_mfma_f32_16x16x32_bf16 v[80:83], v[136:139], v[200:203], v[80:83]
  v_exp_f32 v55, v55
  v_mfma_f32_16x16x32_bf16 v[84:87], v[136:139], v[204:207], v[84:87]
  buffer_load_dwordx4 v[136:139], v1, s[8:11], s20 offen offset:2048
  v_mfma_f32_16x16x32_bf16 v[72:75], v[140:143], v[208:211], v[72:75]
  v_add_f32 v48, 1.0, v48
  v_add_f32 v49, 1.0, v49
  v_mfma_f32_16x16x32_bf16 v[76:79], v[140:143], v[212:215], v[76:79]
  v_add_f32 v50, 1.0, v50
  v_add_f32 v51, 1.0, v51
  v_mfma_f32_16x16x32_bf16 v[80:83], v[140:143], v[216:219], v[80:83]
  v_add_f32 v52, 1.0, v52
  v_add_f32 v53, 1.0, v53
  v_mfma_f32_16x16x32_bf16 v[84:87], v[140:143], v[220:223], v[84:87]
  buffer_load_dwordx4 v[140:143], v1, s[8:11], s20 offen offset:3072
  v_add_f32 v54, 1.0, v54
  v_add_f32 v55, 1.0, v55
  v_rcp_f32 v48, v48
  v_rcp_f32 v49, v49
  v_rcp_f32 v50, v50
  v_rcp_f32 v51, v51
  v_rcp_f32 v52, v52
  v_rcp_f32 v53, v53
  v_rcp_f32 v54, v54
  v_rcp_f32 v55, v55
  v_mul_f32 v96, v96, v48
  v_mul_f32 v97, v97, v49
  v_mul_f32 v98, v98, v50
  v_mul_f32 v99, v99, v51
  v_mul_f32 v100, v100, v52
  v_mul_f32 v101, v101, v53
  v_mul_f32 v102, v102, v54
  v_mul_f32 v103, v103, v55
  v_cvt_pk_bf16_f32 v60, v96, v97
  v_cvt_pk_bf16_f32 v61, v98, v99
  v_cvt_pk_bf16_f32 v62, v100, v101
  v_cvt_pk_bf16_f32 v63, v102, v103
  ds_write_b64 v14, v[60:61] offset:2048
  ds_write_b64 v15, v[62:63] offset:2048
  s_waitcnt vmcnt(20)
  v_mfma_f32_16x16x32_bf16 v[88:91], v[144:147], a[0:3], 0
  v_mfma_f32_16x16x32_bf16 v[92:95], v[144:147], a[4:7], 0
  v_mfma_f32_16x16x32_bf16 v[96:99], v[144:147], a[8:11], 0
  v_mfma_f32_16x16x32_bf16 v[100:103], v[144:147], a[12:15], 0
  s_add_u32 s20, s20, 4096
  buffer_load_dwordx4 v[144:147], v1, s[8:11], s20 offen offset:0
  v_mfma_f32_16x16x32_bf16 v[88:91], v[148:151], a[16:19], v[88:91]
  v_mfma_f32_16x16x32_bf16 v[92:95], v[148:151], a[20:23], v[92:95]
  v_mfma_f32_16x16x32_bf16 v[96:99], v[148:151], a[24:27], v[96:99]
  ds_read_b128 v[36:39], v28 offset:768
  s_waitcnt lgkmcnt(5)
  v_mfma_f32_16x16x32_bf16 v[100:103], v[148:151], a[28:31], v[100:103]
  buffer_load_dwordx4 v[148:151], v1, s[8:11], s20 offen offset:1024
  v_fmac_f32 v72, v32, v16
  s_waitcnt vmcnt(20)
  v_mfma_f32_16x16x32_bf16 v[88:91], v[152:155], a[32:35], v[88:91]
  v_fmac_f32 v73, v33, v16
  v_fmac_f32 v74, v34, v16
  v_mfma_f32_16x16x32_bf16 v[92:95], v[152:155], a[36:39], v[92:95]
  v_fmac_f32 v75, v35, v16
  v_fmac_f32 v76, v32, v17
  v_mfma_f32_16x16x32_bf16 v[96:99], v[152:155], a[40:43], v[96:99]
  v_fmac_f32 v77, v33, v17
  v_fmac_f32 v78, v34, v17
  v_mfma_f32_16x16x32_bf16 v[100:103], v[152:155], a[44:47], v[100:103]
  buffer_load_dwordx4 v[152:155], v1, s[8:11], s20 offen offset:2048
  v_fmac_f32 v79, v35, v17
  v_mfma_f32_16x16x32_bf16 v[88:91], v[156:159], a[48:51], v[88:91]
  v_mul_f32 v40, v72, v20
  v_mul_f32 v41, v73, v20
  v_mfma_f32_16x16x32_bf16 v[92:95], v[156:159], a[52:55], v[92:95]
  v_mul_f32 v42, v74, v20
  v_mul_f32 v43, v75, v20
  v_mfma_f32_16x16x32_bf16 v[96:99], v[156:159], a[56:59], v[96:99]
  v_mul_f32 v44, v76, v21
  v_mul_f32 v45, v77, v21
  v_mfma_f32_16x16x32_bf16 v[100:103], v[156:159], a[60:63], v[100:103]
  buffer_load_dwordx4 v[156:159], v1, s[8:11], s20 offen offset:3072
  v_mul_f32 v46, v78, v21
  s_waitcnt vmcnt(20)
  v_mfma_f32_16x16x32_bf16 v[88:91], v[160:163], a[64:67], v[88:91]
  v_mul_f32 v47, v79, v21
  v_exp_f32 v40, v40
  v_mfma_f32_16x16x32_bf16 v[92:95], v[160:163], a[68:71], v[92:95]
  v_exp_f32 v41, v41
  v_mfma_f32_16x16x32_bf16 v[96:99], v[160:163], a[72:75], v[96:99]
  v_exp_f32 v42, v42
  v_mfma_f32_16x16x32_bf16 v[100:103], v[160:163], a[76:79], v[100:103]
  s_add_u32 s20, s20, 4096
  buffer_load_dwordx4 v[160:163], v1, s[8:11], s20 offen offset:0
  v_mfma_f32_16x16x32_bf16 v[88:91], v[164:167], a[80:83], v[88:91]
  v_exp_f32 v43, v43
  v_mfma_f32_16x16x32_bf16 v[92:95], v[164:167], a[84:87], v[92:95]
  v_exp_f32 v44, v44
  v_mfma_f32_16x16x32_bf16 v[96:99], v[164:167], a[88:91], v[96:99]
  v_exp_f32 v45, v45
  v_mfma_f32_16x16x32_bf16 v[100:103], v[164:167], a[92:95], v[100:103]
  buffer_load_dwordx4 v[164:167], v1, s[8:11], s20 offen offset:1024
  s_waitcnt vmcnt(20)
  v_mfma_f32_16x16x32_bf16 v[88:91], v[168:171], a[96:99], v[88:91]
  v_exp_f32 v46, v46
  v_mfma_f32_16x16x32_bf16 v[92:95], v[168:171], a[100:103], v[92:95]
  v_exp_f32 v47, v47
  v_mfma_f32_16x16x32_bf16 v[96:99], v[168:171], a[104:107], v[96:99]
  v_add_f32 v40, 1.0, v40
  v_add_f32 v41, 1.0, v41
  v_mfma_f32_16x16x32_bf16 v[100:103], v[168:171], a[108:111], v[100:103]
  buffer_load_dwordx4 v[168:171], v1, s[8:11], s20 offen offset:2048
  v_add_f32 v42, 1.0, v42
  v_mfma_f32_16x16x32_bf16 v[88:91], v[172:175], a[112:115], v[88:91]
  v_add_f32 v43, 1.0, v43
  v_add_f32 v44, 1.0, v44
  v_mfma_f32_16x16x32_bf16 v[92:95], v[172:175], a[116:119], v[92:95]
  v_add_f32 v45, 1.0, v45
  v_add_f32 v46, 1.0, v46
  v_mfma_f32_16x16x32_bf16 v[96:99], v[172:175], a[120:123], v[96:99]
  v_add_f32 v47, 1.0, v47
  v_rcp_f32 v40, v40
  v_mfma_f32_16x16x32_bf16 v[100:103], v[172:175], a[124:127], v[100:103]
  buffer_load_dwordx4 v[172:175], v1, s[8:11], s20 offen offset:3072
  s_waitcnt vmcnt(20)
  v_mfma_f32_16x16x32_bf16 v[88:91], v[176:179], a[128:131], v[88:91]
  v_rcp_f32 v41, v41
  v_mfma_f32_16x16x32_bf16 v[92:95], v[176:179], a[132:135], v[92:95]
  v_rcp_f32 v42, v42
  v_mfma_f32_16x16x32_bf16 v[96:99], v[176:179], a[136:139], v[96:99]
  v_rcp_f32 v43, v43
  v_mfma_f32_16x16x32_bf16 v[100:103], v[176:179], a[140:143], v[100:103]
  s_add_u32 s20, s20, 4096
  buffer_load_dwordx4 v[176:179], v1, s[8:11], s20 offen offset:0
  v_mfma_f32_16x16x32_bf16 v[88:91], v[180:183], a[144:147], v[88:91]
  v_rcp_f32 v44, v44
  v_mfma_f32_16x16x32_bf16 v[92:95], v[180:183], a[148:151], v[92:95]
  v_rcp_f32 v45, v45
  v_mfma_f32_16x16x32_bf16 v[96:99], v[180:183], a[152:155], v[96:99]
  v_rcp_f32 v46, v46
  v_mfma_f32_16x16x32_bf16 v[100:103], v[180:183], a[156:159], v[100:103]
  buffer_load_dwordx4 v[180:183], v1, s[8:11], s20 offen offset:1024
  v_rcp_f32 v47, v47
  s_waitcnt vmcnt(20)
  v_mfma_f32_16x16x32_bf16 v[88:91], v[184:187], a[160:163], v[88:91]
  v_mul_f32 v72, v72, v40
  v_mfma_f32_16x16x32_bf16 v[92:95], v[184:187], a[164:167], v[92:95]
  v_mul_f32 v73, v73, v41
  v_mul_f32 v74, v74, v42
  v_mfma_f32_16x16x32_bf16 v[96:99], v[184:187], a[168:171], v[96:99]
  v_mul_f32 v75, v75, v43
  v_mul_f32 v76, v76, v44
  v_mfma_f32_16x16x32_bf16 v[100:103], v[184:187], a[172:175], v[100:103]
  buffer_load_dwordx4 v[184:187], v1, s[8:11], s20 offen offset:2048
  v_mul_f32 v77, v77, v45
  v_mfma_f32_16x16x32_bf16 v[88:91], v[188:191], a[176:179], v[88:91]
  v_mul_f32 v78, v78, v46
  v_mul_f32 v79, v79, v47
  v_mfma_f32_16x16x32_bf16 v[92:95], v[188:191], a[180:183], v[92:95]
  v_cvt_pk_bf16_f32 v56, v72, v73
  v_cvt_pk_bf16_f32 v57, v74, v75
  v_mfma_f32_16x16x32_bf16 v[96:99], v[188:191], a[184:187], v[96:99]
  v_cvt_pk_bf16_f32 v58, v76, v77
  v_cvt_pk_bf16_f32 v59, v78, v79
  v_mfma_f32_16x16x32_bf16 v[100:103], v[188:191], a[188:191], v[100:103]
  buffer_load_dwordx4 v[188:191], v1, s[8:11], s20 offen offset:3072
  ds_write_b64 v12, v[56:57] offset:4096
  s_waitcnt vmcnt(20)
  v_mfma_f32_16x16x32_bf16 v[88:91], v[104:107], a[192:195], v[88:91]
  ds_write_b64 v13, v[58:59] offset:4096
  v_fmac_f32 v80, v32, v18
  v_mfma_f32_16x16x32_bf16 v[92:95], v[104:107], a[196:199], v[92:95]
  v_fmac_f32 v81, v33, v18
  v_fmac_f32 v82, v34, v18
  v_mfma_f32_16x16x32_bf16 v[96:99], v[104:107], a[200:203], v[96:99]
  v_fmac_f32 v83, v35, v18
  v_fmac_f32 v84, v32, v19
  v_mfma_f32_16x16x32_bf16 v[100:103], v[104:107], a[204:207], v[100:103]
  s_add_u32 s20, s20, 4096
  buffer_load_dwordx4 v[104:107], v1, s[8:11], s20 offen offset:0
  v_mfma_f32_16x16x32_bf16 v[88:91], v[108:111], a[208:211], v[88:91]
  v_fmac_f32 v85, v33, v19
  v_fmac_f32 v86, v34, v19
  v_mfma_f32_16x16x32_bf16 v[92:95], v[108:111], a[212:215], v[92:95]
  v_fmac_f32 v87, v35, v19
  v_mul_f32 v48, v80, v22
  v_mfma_f32_16x16x32_bf16 v[96:99], v[108:111], a[216:219], v[96:99]
  v_mul_f32 v49, v81, v22
  v_mul_f32 v50, v82, v22
  v_mfma_f32_16x16x32_bf16 v[100:103], v[108:111], a[220:223], v[100:103]
  buffer_load_dwordx4 v[108:111], v1, s[8:11], s20 offen offset:1024
  v_mul_f32 v51, v83, v22
  s_waitcnt vmcnt(20)
  v_mfma_f32_16x16x32_bf16 v[88:91], v[112:115], a[224:227], v[88:91]
  v_mul_f32 v52, v84, v23
  v_mul_f32 v53, v85, v23
  v_mfma_f32_16x16x32_bf16 v[92:95], v[112:115], a[228:231], v[92:95]
  v_mul_f32 v54, v86, v23
  v_mul_f32 v55, v87, v23
  v_mfma_f32_16x16x32_bf16 v[96:99], v[112:115], a[232:235], v[96:99]
  v_exp_f32 v48, v48
  v_mfma_f32_16x16x32_bf16 v[100:103], v[112:115], a[236:239], v[100:103]
  buffer_load_dwordx4 v[112:115], v1, s[8:11], s20 offen offset:2048
  v_exp_f32 v49, v49
  v_mfma_f32_16x16x32_bf16 v[88:91], v[116:119], a[240:243], v[88:91]
  v_exp_f32 v50, v50
  v_mfma_f32_16x16x32_bf16 v[92:95], v[116:119], a[244:247], v[92:95]
  v_exp_f32 v51, v51
  v_mfma_f32_16x16x32_bf16 v[96:99], v[116:119], a[248:251], v[96:99]
  v_exp_f32 v52, v52
  v_mfma_f32_16x16x32_bf16 v[100:103], v[116:119], a[252:255], v[100:103]
  buffer_load_dwordx4 v[116:119], v1, s[8:11], s20 offen offset:3072
  s_waitcnt vmcnt(20)
  v_mfma_f32_16x16x32_bf16 v[88:91], v[120:123], v[192:195], v[88:91]
  v_exp_f32 v53, v53
  v_mfma_f32_16x16x32_bf16 v[92:95], v[120:123], v[196:199], v[92:95]
  v_exp_f32 v54, v54
  v_mfma_f32_16x16x32_bf16 v[96:99], v[120:123], v[200:203], v[96:99]
  v_exp_f32 v55, v55
  v_mfma_f32_16x16x32_bf16 v[100:103], v[120:123], v[204:207], v[100:103]
  s_add_u32 s20, s20, 4096
  buffer_load_dwordx4 v[120:123], v1, s[8:11], s20 offen offset:0
  v_mfma_f32_16x16x32_bf16 v[88:91], v[124:127], v[208:211], v[88:91]
  v_add_f32 v48, 1.0, v48
  v_add_f32 v49, 1.0, v49
  v_mfma_f32_16x16x32_bf16 v[92:95], v[124:127], v[212:215], v[92:95]
  v_add_f32 v50, 1.0, v50
  v_add_f32 v51, 1.0, v51
  v_mfma_f32_16x16x32_bf16 v[96:99], v[124:127], v[216:219], v[96:99]
  v_add_f32 v52, 1.0, v52
  v_add_f32 v53, 1.0, v53
  v_mfma_f32_16x16x32_bf16 v[100:103], v[124:127], v[220:223], v[100:103]
  buffer_load_dwordx4 v[124:127], v1, s[8:11], s20 offen offset:1024
  v_add_f32 v54, 1.0, v54
  v_add_f32 v55, 1.0, v55
  v_rcp_f32 v48, v48
  v_rcp_f32 v49, v49
  v_rcp_f32 v50, v50
  v_rcp_f32 v51, v51
  v_rcp_f32 v52, v52
  v_rcp_f32 v53, v53
  v_rcp_f32 v54, v54
  v_rcp_f32 v55, v55
  v_mul_f32 v80, v80, v48
  v_mul_f32 v81, v81, v49
  v_mul_f32 v82, v82, v50
  v_mul_f32 v83, v83, v51
  v_mul_f32 v84, v84, v52
  v_mul_f32 v85, v85, v53
  v_mul_f32 v86, v86, v54
  v_mul_f32 v87, v87, v55
  v_cvt_pk_bf16_f32 v60, v80, v81
  v_cvt_pk_bf16_f32 v61, v82, v83
  v_cvt_pk_bf16_f32 v62, v84, v85
  v_cvt_pk_bf16_f32 v63, v86, v87
  ds_write_b64 v14, v[60:61] offset:4096
  ds_write_b64 v15, v[62:63] offset:4096
  s_waitcnt vmcnt(20)
  v_mfma_f32_16x16x32_bf16 v[72:75], v[128:131], a[0:3], 0
  v_mfma_f32_16x16x32_bf16 v[76:79], v[128:131], a[4:7], 0
  v_mfma_f32_16x16x32_bf16 v[80:83], v[128:131], a[8:11], 0
  v_mfma_f32_16x16x32_bf16 v[84:87], v[128:131], a[12:15], 0
  buffer_load_dwordx4 v[128:131], v1, s[8:11], s20 offen offset:2048
  v_mfma_f32_16x16x32_bf16 v[72:75], v[132:135], a[16:19], v[72:75]
  v_mfma_f32_16x16x32_bf16 v[76:79], v[132:135], a[20:23], v[76:79]
  v_mfma_f32_16x16x32_bf16 v[80:83], v[132:135], a[24:27], v[80:83]
  ds_read_b128 v[32:35], v28 offset:1024
  s_waitcnt lgkmcnt(5)
  v_mfma_f32_16x16x32_bf16 v[84:87], v[132:135], a[28:31], v[84:87]
  buffer_load_dwordx4 v[132:135], v1, s[8:11], s20 offen offset:3072
  v_fmac_f32 v88, v36, v16
  s_waitcnt vmcnt(20)
  v_mfma_f32_16x16x32_bf16 v[72:75], v[136:139], a[32:35], v[72:75]
  v_fmac_f32 v89, v37, v16
  v_fmac_f32 v90, v38, v16
  v_mfma_f32_16x16x32_bf16 v[76:79], v[136:139], a[36:39], v[76:79]
  v_fmac_f32 v91, v39, v16
  v_fmac_f32 v92, v36, v17
  v_mfma_f32_16x16x32_bf16 v[80:83], v[136:139], a[40:43], v[80:83]
  v_fmac_f32 v93, v37, v17
  v_fmac_f32 v94, v38, v17
  v_mfma_f32_16x16x32_bf16 v[84:87], v[136:139], a[44:47], v[84:87]
  s_add_u32 s20, s20, 4096
  buffer_load_dwordx4 v[136:139], v1, s[8:11], s20 offen offset:0
  v_mfma_f32_16x16x32_bf16 v[72:75], v[140:143], a[48:51], v[72:75]
  v_fmac_f32 v95, v39, v17
  v_mul_f32 v40, v88, v20
  v_mfma_f32_16x16x32_bf16 v[76:79], v[140:143], a[52:55], v[76:79]
  v_mul_f32 v41, v89, v20
  v_mul_f32 v42, v90, v20
  v_mfma_f32_16x16x32_bf16 v[80:83], v[140:143], a[56:59], v[80:83]
  v_mul_f32 v43, v91, v20
  v_mul_f32 v44, v92, v21
  v_mfma_f32_16x16x32_bf16 v[84:87], v[140:143], a[60:63], v[84:87]
  buffer_load_dwordx4 v[140:143], v1, s[8:11], s20 offen offset:1024
  v_mul_f32 v45, v93, v21
  s_waitcnt vmcnt(20)
  v_mfma_f32_16x16x32_bf16 v[72:75], v[144:147], a[64:67], v[72:75]
  v_mul_f32 v46, v94, v21
  v_mul_f32 v47, v95, v21
  v_mfma_f32_16x16x32_bf16 v[76:79], v[144:147], a[68:71], v[76:79]
  v_exp_f32 v40, v40
  v_mfma_f32_16x16x32_bf16 v[80:83], v[144:147], a[72:75], v[80:83]
  v_exp_f32 v41, v41
  v_mfma_f32_16x16x32_bf16 v[84:87], v[144:147], a[76:79], v[84:87]
  buffer_load_dwordx4 v[144:147], v1, s[8:11], s20 offen offset:2048
  v_exp_f32 v42, v42
  v_mfma_f32_16x16x32_bf16 v[72:75], v[148:151], a[80:83], v[72:75]
  v_exp_f32 v43, v43
  v_mfma_f32_16x16x32_bf16 v[76:79], v[148:151], a[84:87], v[76:79]
  v_exp_f32 v44, v44
  v_mfma_f32_16x16x32_bf16 v[80:83], v[148:151], a[88:91], v[80:83]
  v_exp_f32 v45, v45
  v_mfma_f32_16x16x32_bf16 v[84:87], v[148:151], a[92:95], v[84:87]
  buffer_load_dwordx4 v[148:151], v1, s[8:11], s20 offen offset:3072
  s_waitcnt vmcnt(20)
  v_mfma_f32_16x16x32_bf16 v[72:75], v[152:155], a[96:99], v[72:75]
  v_exp_f32 v46, v46
  v_mfma_f32_16x16x32_bf16 v[76:79], v[152:155], a[100:103], v[76:79]
  v_exp_f32 v47, v47
  v_mfma_f32_16x16x32_bf16 v[80:83], v[152:155], a[104:107], v[80:83]
  v_add_f32 v40, 1.0, v40
  v_add_f32 v41, 1.0, v41
  v_mfma_f32_16x16x32_bf16 v[84:87], v[152:155], a[108:111], v[84:87]
  s_add_u32 s20, s20, 4096
  buffer_load_dwordx4 v[152:155], v1, s[8:11], s20 offen offset:0
  v_mfma_f32_16x16x32_bf16 v[72:75], v[156:159], a[112:115], v[72:75]
  v_add_f32 v42, 1.0, v42
  v_add_f32 v43, 1.0, v43
  v_mfma_f32_16x16x32_bf16 v[76:79], v[156:159], a[116:119], v[76:79]
  v_add_f32 v44, 1.0, v44
  v_add_f32 v45, 1.0, v45
  v_mfma_f32_16x16x32_bf16 v[80:83], v[156:159], a[120:123], v[80:83]
  v_add_f32 v46, 1.0, v46
  v_add_f32 v47, 1.0, v47
  v_mfma_f32_16x16x32_bf16 v[84:87], v[156:159], a[124:127], v[84:87]
  buffer_load_dwordx4 v[156:159], v1, s[8:11], s20 offen offset:1024
  v_rcp_f32 v40, v40
  s_waitcnt vmcnt(20)
  v_mfma_f32_16x16x32_bf16 v[72:75], v[160:163], a[128:131], v[72:75]
  v_rcp_f32 v41, v41
  v_mfma_f32_16x16x32_bf16 v[76:79], v[160:163], a[132:135], v[76:79]
  v_rcp_f32 v42, v42
  v_mfma_f32_16x16x32_bf16 v[80:83], v[160:163], a[136:139], v[80:83]
  v_rcp_f32 v43, v43
  v_mfma_f32_16x16x32_bf16 v[84:87], v[160:163], a[140:143], v[84:87]
  buffer_load_dwordx4 v[160:163], v1, s[8:11], s20 offen offset:2048
  v_mfma_f32_16x16x32_bf16 v[72:75], v[164:167], a[144:147], v[72:75]
  v_rcp_f32 v44, v44
  v_mfma_f32_16x16x32_bf16 v[76:79], v[164:167], a[148:151], v[76:79]
  v_rcp_f32 v45, v45
  v_mfma_f32_16x16x32_bf16 v[80:83], v[164:167], a[152:155], v[80:83]
  v_rcp_f32 v46, v46
  v_mfma_f32_16x16x32_bf16 v[84:87], v[164:167], a[156:159], v[84:87]
  buffer_load_dwordx4 v[164:167], v1, s[8:11], s20 offen offset:3072
  v_rcp_f32 v47, v47
  s_waitcnt vmcnt(20)
  v_mfma_f32_16x16x32_bf16 v[72:75], v[168:171], a[160:163], v[72:75]
  v_mul_f32 v88, v88, v40
  v_mfma_f32_16x16x32_bf16 v[76:79], v[168:171], a[164:167], v[76:79]
  v_mul_f32 v89, v89, v41
  v_mul_f32 v90, v90, v42
  v_mfma_f32_16x16x32_bf16 v[80:83], v[168:171], a[168:171], v[80:83]
  v_mul_f32 v91, v91, v43
  v_mul_f32 v92, v92, v44
  v_mfma_f32_16x16x32_bf16 v[84:87], v[168:171], a[172:175], v[84:87]
  s_add_u32 s20, s20, 4096
  buffer_load_dwordx4 v[168:171], v1, s[8:11], s20 offen offset:0
  v_mfma_f32_16x16x32_bf16 v[72:75], v[172:175], a[176:179], v[72:75]
  v_mul_f32 v93, v93, v45
  v_mul_f32 v94, v94, v46
  v_mfma_f32_16x16x32_bf16 v[76:79], v[172:175], a[180:183], v[76:79]
  v_mul_f32 v95, v95, v47
  v_cvt_pk_bf16_f32 v56, v88, v89
  v_mfma_f32_16x16x32_bf16 v[80:83], v[172:175], a[184:187], v[80:83]
  v_cvt_pk_bf16_f32 v57, v90, v91
  v_cvt_pk_bf16_f32 v58, v92, v93
  v_mfma_f32_16x16x32_bf16 v[84:87], v[172:175], a[188:191], v[84:87]
  buffer_load_dwordx4 v[172:175], v1, s[8:11], s20 offen offset:1024
  v_cvt_pk_bf16_f32 v59, v94, v95
  s_waitcnt vmcnt(20)
  v_mfma_f32_16x16x32_bf16 v[72:75], v[176:179], a[192:195], v[72:75]
  ds_write_b64 v12, v[56:57] offset:6144
  ds_write_b64 v13, v[58:59] offset:6144
  v_mfma_f32_16x16x32_bf16 v[76:79], v[176:179], a[196:199], v[76:79]
  v_fmac_f32 v96, v36, v18
  v_fmac_f32 v97, v37, v18
  v_mfma_f32_16x16x32_bf16 v[80:83], v[176:179], a[200:203], v[80:83]
  v_fmac_f32 v98, v38, v18
  v_fmac_f32 v99, v39, v18
  v_mfma_f32_16x16x32_bf16 v[84:87], v[176:179], a[204:207], v[84:87]
  buffer_load_dwordx4 v[176:179], v1, s[8:11], s20 offen offset:2048
  v_fmac_f32 v100, v36, v19
  v_mfma_f32_16x16x32_bf16 v[72:75], v[180:183], a[208:211], v[72:75]
  v_fmac_f32 v101, v37, v19
  v_fmac_f32 v102, v38, v19
  v_mfma_f32_16x16x32_bf16 v[76:79], v[180:183], a[212:215], v[76:79]
  v_fmac_f32 v103, v39, v19
  v_mul_f32 v48, v96, v22
  v_mfma_f32_16x16x32_bf16 v[80:83], v[180:183], a[216:219], v[80:83]
  v_mul_f32 v49, v97, v22
  v_mul_f32 v50, v98, v22
  v_mfma_f32_16x16x32_bf16 v[84:87], v[180:183], a[220:223], v[84:87]
  buffer_load_dwordx4 v[180:183], v1, s[8:11], s20 offen offset:3072
  v_mul_f32 v51, v99, v22
  s_waitcnt vmcnt(20)
  v_mfma_f32_16x16x32_bf16 v[72:75], v[184:187], a[224:227], v[72:75]
  v_mul_f32 v52, v100, v23
  v_mul_f32 v53, v101, v23
  v_mfma_f32_16x16x32_bf16 v[76:79], v[184:187], a[228:231], v[76:79]
  v_mul_f32 v54, v102, v23
  v_mul_f32 v55, v103, v23
  v_mfma_f32_16x16x32_bf16 v[80:83], v[184:187], a[232:235], v[80:83]
  v_exp_f32 v48, v48
  v_mfma_f32_16x16x32_bf16 v[84:87], v[184:187], a[236:239], v[84:87]
  s_add_u32 s20, s20, 4096
  buffer_load_dwordx4 v[184:187], v1, s[8:11], s20 offen offset:0
  v_mfma_f32_16x16x32_bf16 v[72:75], v[188:191], a[240:243], v[72:75]
  v_exp_f32 v49, v49
  v_mfma_f32_16x16x32_bf16 v[76:79], v[188:191], a[244:247], v[76:79]
  v_exp_f32 v50, v50
  v_mfma_f32_16x16x32_bf16 v[80:83], v[188:191], a[248:251], v[80:83]
  v_exp_f32 v51, v51
  v_mfma_f32_16x16x32_bf16 v[84:87], v[188:191], a[252:255], v[84:87]
  buffer_load_dwordx4 v[188:191], v1, s[8:11], s20 offen offset:1024
  v_exp_f32 v52, v52
  s_waitcnt vmcnt(20)
  v_mfma_f32_16x16x32_bf16 v[72:75], v[104:107], v[192:195], v[72:75]
  v_exp_f32 v53, v53
  v_mfma_f32_16x16x32_bf16 v[76:79], v[104:107], v[196:199], v[76:79]
  v_exp_f32 v54, v54
  v_mfma_f32_16x16x32_bf16 v[80:83], v[104:107], v[200:203], v[80:83]
  v_exp_f32 v55, v55
  v_mfma_f32_16x16x32_bf16 v[84:87], v[104:107], v[204:207], v[84:87]
  buffer_load_dwordx4 v[104:107], v1, s[8:11], s20 offen offset:2048
  v_mfma_f32_16x16x32_bf16 v[72:75], v[108:111], v[208:211], v[72:75]
  v_add_f32 v48, 1.0, v48
  v_add_f32 v49, 1.0, v49
  v_mfma_f32_16x16x32_bf16 v[76:79], v[108:111], v[212:215], v[76:79]
  v_add_f32 v50, 1.0, v50
  v_add_f32 v51, 1.0, v51
  v_mfma_f32_16x16x32_bf16 v[80:83], v[108:111], v[216:219], v[80:83]
  v_add_f32 v52, 1.0, v52
  v_add_f32 v53, 1.0, v53
  v_mfma_f32_16x16x32_bf16 v[84:87], v[108:111], v[220:223], v[84:87]
  buffer_load_dwordx4 v[108:111], v1, s[8:11], s20 offen offset:3072
  v_add_f32 v54, 1.0, v54
  v_add_f32 v55, 1.0, v55
  v_rcp_f32 v48, v48
  v_rcp_f32 v49, v49
  v_rcp_f32 v50, v50
  v_rcp_f32 v51, v51
  v_rcp_f32 v52, v52
  v_rcp_f32 v53, v53
  v_rcp_f32 v54, v54
  v_rcp_f32 v55, v55
  v_mul_f32 v96, v96, v48
  v_mul_f32 v97, v97, v49
  v_mul_f32 v98, v98, v50
  v_mul_f32 v99, v99, v51
  v_mul_f32 v100, v100, v52
  v_mul_f32 v101, v101, v53
  v_mul_f32 v102, v102, v54
  v_mul_f32 v103, v103, v55
  v_cvt_pk_bf16_f32 v60, v96, v97
  v_cvt_pk_bf16_f32 v61, v98, v99
  v_cvt_pk_bf16_f32 v62, v100, v101
  v_cvt_pk_bf16_f32 v63, v102, v103
  ds_write_b64 v14, v[60:61] offset:6144
  ds_write_b64 v15, v[62:63] offset:6144
  s_waitcnt vmcnt(20)
  v_mfma_f32_16x16x32_bf16 v[88:91], v[112:115], a[0:3], 0
  v_mfma_f32_16x16x32_bf16 v[92:95], v[112:115], a[4:7], 0
  v_mfma_f32_16x16x32_bf16 v[96:99], v[112:115], a[8:11], 0
  v_mfma_f32_16x16x32_bf16 v[100:103], v[112:115], a[12:15], 0
  s_add_u32 s20, s20, 4096
  buffer_load_dwordx4 v[112:115], v1, s[8:11], s20 offen offset:0
  v_mfma_f32_16x16x32_bf16 v[88:91], v[116:119], a[16:19], v[88:91]
  v_mfma_f32_16x16x32_bf16 v[92:95], v[116:119], a[20:23], v[92:95]
  v_mfma_f32_16x16x32_bf16 v[96:99], v[116:119], a[24:27], v[96:99]
  ds_read_b128 v[36:39], v28 offset:1280
  s_waitcnt lgkmcnt(5)
  v_mfma_f32_16x16x32_bf16 v[100:103], v[116:119], a[28:31], v[100:103]
  buffer_load_dwordx4 v[116:119], v1, s[8:11], s20 offen offset:1024
  v_fmac_f32 v72, v32, v16
  s_waitcnt vmcnt(20)
  v_mfma_f32_16x16x32_bf16 v[88:91], v[120:123], a[32:35], v[88:91]
  v_fmac_f32 v73, v33, v16
  v_fmac_f32 v74, v34, v16
  v_mfma_f32_16x16x32_bf16 v[92:95], v[120:123], a[36:39], v[92:95]
  v_fmac_f32 v75, v35, v16
  v_fmac_f32 v76, v32, v17
  v_mfma_f32_16x16x32_bf16 v[96:99], v[120:123], a[40:43], v[96:99]
  v_fmac_f32 v77, v33, v17
  v_fmac_f32 v78, v34, v17
  v_mfma_f32_16x16x32_bf16 v[100:103], v[120:123], a[44:47], v[100:103]
  buffer_load_dwordx4 v[120:123], v1, s[8:11], s20 offen offset:2048
  v_fmac_f32 v79, v35, v17
  v_mfma_f32_16x16x32_bf16 v[88:91], v[124:127], a[48:51], v[88:91]
  v_mul_f32 v40, v72, v20
  v_mul_f32 v41, v73, v20
  v_mfma_f32_16x16x32_bf16 v[92:95], v[124:127], a[52:55], v[92:95]
  v_mul_f32 v42, v74, v20
  v_mul_f32 v43, v75, v20
  v_mfma_f32_16x16x32_bf16 v[96:99], v[124:127], a[56:59], v[96:99]
  v_mul_f32 v44, v76, v21
  v_mul_f32 v45, v77, v21
  v_mfma_f32_16x16x32_bf16 v[100:103], v[124:127], a[60:63], v[100:103]
  buffer_load_dwordx4 v[124:127], v1, s[8:11], s20 offen offset:3072
  v_mul_f32 v46, v78, v21
  s_waitcnt vmcnt(20)
  v_mfma_f32_16x16x32_bf16 v[88:91], v[128:131], a[64:67], v[88:91]
  v_mul_f32 v47, v79, v21
  v_exp_f32 v40, v40
  v_mfma_f32_16x16x32_bf16 v[92:95], v[128:131], a[68:71], v[92:95]
  v_exp_f32 v41, v41
  v_mfma_f32_16x16x32_bf16 v[96:99], v[128:131], a[72:75], v[96:99]
  v_exp_f32 v42, v42
  v_mfma_f32_16x16x32_bf16 v[100:103], v[128:131], a[76:79], v[100:103]
  s_add_u32 s20, s20, 4096
  buffer_load_dwordx4 v[128:131], v1, s[8:11], s20 offen offset:0
  v_mfma_f32_16x16x32_bf16 v[88:91], v[132:135], a[80:83], v[88:91]
  v_exp_f32 v43, v43
  v_mfma_f32_16x16x32_bf16 v[92:95], v[132:135], a[84:87], v[92:95]
  v_exp_f32 v44, v44
  v_mfma_f32_16x16x32_bf16 v[96:99], v[132:135], a[88:91], v[96:99]
  v_exp_f32 v45, v45
  v_mfma_f32_16x16x32_bf16 v[100:103], v[132:135], a[92:95], v[100:103]
  buffer_load_dwordx4 v[132:135], v1, s[8:11], s20 offen offset:1024
  s_waitcnt vmcnt(20)
  v_mfma_f32_16x16x32_bf16 v[88:91], v[136:139], a[96:99], v[88:91]
  v_exp_f32 v46, v46
  v_mfma_f32_16x16x32_bf16 v[92:95], v[136:139], a[100:103], v[92:95]
  v_exp_f32 v47, v47
  v_mfma_f32_16x16x32_bf16 v[96:99], v[136:139], a[104:107], v[96:99]
  v_add_f32 v40, 1.0, v40
  v_add_f32 v41, 1.0, v41
  v_mfma_f32_16x16x32_bf16 v[100:103], v[136:139], a[108:111], v[100:103]
  buffer_load_dwordx4 v[136:139], v1, s[8:11], s20 offen offset:2048
  v_add_f32 v42, 1.0, v42
  v_mfma_f32_16x16x32_bf16 v[88:91], v[140:143], a[112:115], v[88:91]
  v_add_f32 v43, 1.0, v43
  v_add_f32 v44, 1.0, v44
  v_mfma_f32_16x16x32_bf16 v[92:95], v[140:143], a[116:119], v[92:95]
  v_add_f32 v45, 1.0, v45
  v_add_f32 v46, 1.0, v46
  v_mfma_f32_16x16x32_bf16 v[96:99], v[140:143], a[120:123], v[96:99]
  v_add_f32 v47, 1.0, v47
  v_rcp_f32 v40, v40
  v_mfma_f32_16x16x32_bf16 v[100:103], v[140:143], a[124:127], v[100:103]
  buffer_load_dwordx4 v[140:143], v1, s[8:11], s20 offen offset:3072
  s_waitcnt vmcnt(20)
  v_mfma_f32_16x16x32_bf16 v[88:91], v[144:147], a[128:131], v[88:91]
  v_rcp_f32 v41, v41
  v_mfma_f32_16x16x32_bf16 v[92:95], v[144:147], a[132:135], v[92:95]
  v_rcp_f32 v42, v42
  v_mfma_f32_16x16x32_bf16 v[96:99], v[144:147], a[136:139], v[96:99]
  v_rcp_f32 v43, v43
  v_mfma_f32_16x16x32_bf16 v[100:103], v[144:147], a[140:143], v[100:103]
  s_add_u32 s20, s20, 4096
  buffer_load_dwordx4 v[144:147], v1, s[8:11], s20 offen offset:0
  v_mfma_f32_16x16x32_bf16 v[88:91], v[148:151], a[144:147], v[88:91]
  v_rcp_f32 v44, v44
  v_mfma_f32_16x16x32_bf16 v[92:95], v[148:151], a[148:151], v[92:95]
  v_rcp_f32 v45, v45
  v_mfma_f32_16x16x32_bf16 v[96:99], v[148:151], a[152:155], v[96:99]
  v_rcp_f32 v46, v46
  v_mfma_f32_16x16x32_bf16 v[100:103], v[148:151], a[156:159], v[100:103]
  buffer_load_dwordx4 v[148:151], v1, s[8:11], s20 offen offset:1024
  v_rcp_f32 v47, v47
  s_waitcnt vmcnt(20)
  v_mfma_f32_16x16x32_bf16 v[88:91], v[152:155], a[160:163], v[88:91]
  v_mul_f32 v72, v72, v40
  v_mfma_f32_16x16x32_bf16 v[92:95], v[152:155], a[164:167], v[92:95]
  v_mul_f32 v73, v73, v41
  v_mul_f32 v74, v74, v42
  v_mfma_f32_16x16x32_bf16 v[96:99], v[152:155], a[168:171], v[96:99]
  v_mul_f32 v75, v75, v43
  v_mul_f32 v76, v76, v44
  v_mfma_f32_16x16x32_bf16 v[100:103], v[152:155], a[172:175], v[100:103]
  buffer_load_dwordx4 v[152:155], v1, s[8:11], s20 offen offset:2048
  v_mul_f32 v77, v77, v45
  v_mfma_f32_16x16x32_bf16 v[88:91], v[156:159], a[176:179], v[88:91]
  v_mul_f32 v78, v78, v46
  v_mul_f32 v79, v79, v47
  v_mfma_f32_16x16x32_bf16 v[92:95], v[156:159], a[180:183], v[92:95]
  v_cvt_pk_bf16_f32 v56, v72, v73
  v_cvt_pk_bf16_f32 v57, v74, v75
  v_mfma_f32_16x16x32_bf16 v[96:99], v[156:159], a[184:187], v[96:99]
  v_cvt_pk_bf16_f32 v58, v76, v77
  v_cvt_pk_bf16_f32 v59, v78, v79
  v_mfma_f32_16x16x32_bf16 v[100:103], v[156:159], a[188:191], v[100:103]
  buffer_load_dwordx4 v[156:159], v1, s[8:11], s20 offen offset:3072
  ds_write_b64 v12, v[56:57] offset:8192
  s_waitcnt vmcnt(20)
  v_mfma_f32_16x16x32_bf16 v[88:91], v[160:163], a[192:195], v[88:91]
  ds_write_b64 v13, v[58:59] offset:8192
  v_fmac_f32 v80, v32, v18
  v_mfma_f32_16x16x32_bf16 v[92:95], v[160:163], a[196:199], v[92:95]
  v_fmac_f32 v81, v33, v18
  v_fmac_f32 v82, v34, v18
  v_mfma_f32_16x16x32_bf16 v[96:99], v[160:163], a[200:203], v[96:99]
  v_fmac_f32 v83, v35, v18
  v_fmac_f32 v84, v32, v19
  v_mfma_f32_16x16x32_bf16 v[100:103], v[160:163], a[204:207], v[100:103]
  s_add_u32 s20, s20, 4096
  buffer_load_dwordx4 v[160:163], v1, s[8:11], s20 offen offset:0
  v_mfma_f32_16x16x32_bf16 v[88:91], v[164:167], a[208:211], v[88:91]
  v_fmac_f32 v85, v33, v19
  v_fmac_f32 v86, v34, v19
  v_mfma_f32_16x16x32_bf16 v[92:95], v[164:167], a[212:215], v[92:95]
  v_fmac_f32 v87, v35, v19
  v_mul_f32 v48, v80, v22
  v_mfma_f32_16x16x32_bf16 v[96:99], v[164:167], a[216:219], v[96:99]
  v_mul_f32 v49, v81, v22
  v_mul_f32 v50, v82, v22
  v_mfma_f32_16x16x32_bf16 v[100:103], v[164:167], a[220:223], v[100:103]
  buffer_load_dwordx4 v[164:167], v1, s[8:11], s20 offen offset:1024
  v_mul_f32 v51, v83, v22
  s_waitcnt vmcnt(20)
  v_mfma_f32_16x16x32_bf16 v[88:91], v[168:171], a[224:227], v[88:91]
  v_mul_f32 v52, v84, v23
  v_mul_f32 v53, v85, v23
  v_mfma_f32_16x16x32_bf16 v[92:95], v[168:171], a[228:231], v[92:95]
  v_mul_f32 v54, v86, v23
  v_mul_f32 v55, v87, v23
  v_mfma_f32_16x16x32_bf16 v[96:99], v[168:171], a[232:235], v[96:99]
  v_exp_f32 v48, v48
  v_mfma_f32_16x16x32_bf16 v[100:103], v[168:171], a[236:239], v[100:103]
  buffer_load_dwordx4 v[168:171], v1, s[8:11], s20 offen offset:2048
  v_exp_f32 v49, v49
  v_mfma_f32_16x16x32_bf16 v[88:91], v[172:175], a[240:243], v[88:91]
  v_exp_f32 v50, v50
  v_mfma_f32_16x16x32_bf16 v[92:95], v[172:175], a[244:247], v[92:95]
  v_exp_f32 v51, v51
  v_mfma_f32_16x16x32_bf16 v[96:99], v[172:175], a[248:251], v[96:99]
  v_exp_f32 v52, v52
  v_mfma_f32_16x16x32_bf16 v[100:103], v[172:175], a[252:255], v[100:103]
  buffer_load_dwordx4 v[172:175], v1, s[8:11], s20 offen offset:3072
  s_waitcnt vmcnt(20)
  v_mfma_f32_16x16x32_bf16 v[88:91], v[176:179], v[192:195], v[88:91]
  v_exp_f32 v53, v53
  v_mfma_f32_16x16x32_bf16 v[92:95], v[176:179], v[196:199], v[92:95]
  v_exp_f32 v54, v54
  v_mfma_f32_16x16x32_bf16 v[96:99], v[176:179], v[200:203], v[96:99]
  v_exp_f32 v55, v55
  v_mfma_f32_16x16x32_bf16 v[100:103], v[176:179], v[204:207], v[100:103]
  s_add_u32 s20, s20, 4096
  buffer_load_dwordx4 v[176:179], v1, s[8:11], s20 offen offset:0
  v_mfma_f32_16x16x32_bf16 v[88:91], v[180:183], v[208:211], v[88:91]
  v_add_f32 v48, 1.0, v48
  v_add_f32 v49, 1.0, v49
  v_mfma_f32_16x16x32_bf16 v[92:95], v[180:183], v[212:215], v[92:95]
  v_add_f32 v50, 1.0, v50
  v_add_f32 v51, 1.0, v51
  v_mfma_f32_16x16x32_bf16 v[96:99], v[180:183], v[216:219], v[96:99]
  v_add_f32 v52, 1.0, v52
  v_add_f32 v53, 1.0, v53
  v_mfma_f32_16x16x32_bf16 v[100:103], v[180:183], v[220:223], v[100:103]
  buffer_load_dwordx4 v[180:183], v1, s[8:11], s20 offen offset:1024
  v_add_f32 v54, 1.0, v54
  v_add_f32 v55, 1.0, v55
  v_rcp_f32 v48, v48
  v_rcp_f32 v49, v49
  v_rcp_f32 v50, v50
  v_rcp_f32 v51, v51
  v_rcp_f32 v52, v52
  v_rcp_f32 v53, v53
  v_rcp_f32 v54, v54
  v_rcp_f32 v55, v55
  v_mul_f32 v80, v80, v48
  v_mul_f32 v81, v81, v49
  v_mul_f32 v82, v82, v50
  v_mul_f32 v83, v83, v51
  v_mul_f32 v84, v84, v52
  v_mul_f32 v85, v85, v53
  v_mul_f32 v86, v86, v54
  v_mul_f32 v87, v87, v55
  v_cvt_pk_bf16_f32 v60, v80, v81
  v_cvt_pk_bf16_f32 v61, v82, v83
  v_cvt_pk_bf16_f32 v62, v84, v85
  v_cvt_pk_bf16_f32 v63, v86, v87
  ds_write_b64 v14, v[60:61] offset:8192
  ds_write_b64 v15, v[62:63] offset:8192
  s_waitcnt vmcnt(20)
  v_mfma_f32_16x16x32_bf16 v[72:75], v[184:187], a[0:3], 0
  v_mfma_f32_16x16x32_bf16 v[76:79], v[184:187], a[4:7], 0
  v_mfma_f32_16x16x32_bf16 v[80:83], v[184:187], a[8:11], 0
  v_mfma_f32_16x16x32_bf16 v[84:87], v[184:187], a[12:15], 0
  buffer_load_dwordx4 v[184:187], v1, s[8:11], s20 offen offset:2048
  v_mfma_f32_16x16x32_bf16 v[72:75], v[188:191], a[16:19], v[72:75]
  v_mfma_f32_16x16x32_bf16 v[76:79], v[188:191], a[20:23], v[76:79]
  v_mfma_f32_16x16x32_bf16 v[80:83], v[188:191], a[24:27], v[80:83]
  ds_read_b128 v[32:35], v28 offset:1536
  s_waitcnt lgkmcnt(5)
  v_mfma_f32_16x16x32_bf16 v[84:87], v[188:191], a[28:31], v[84:87]
  buffer_load_dwordx4 v[188:191], v1, s[8:11], s20 offen offset:3072
  v_fmac_f32 v88, v36, v16
  s_waitcnt vmcnt(20)
  v_mfma_f32_16x16x32_bf16 v[72:75], v[104:107], a[32:35], v[72:75]
  v_fmac_f32 v89, v37, v16
  v_fmac_f32 v90, v38, v16
  v_mfma_f32_16x16x32_bf16 v[76:79], v[104:107], a[36:39], v[76:79]
  v_fmac_f32 v91, v39, v16
  v_fmac_f32 v92, v36, v17
  v_mfma_f32_16x16x32_bf16 v[80:83], v[104:107], a[40:43], v[80:83]
  v_fmac_f32 v93, v37, v17
  v_fmac_f32 v94, v38, v17
  v_mfma_f32_16x16x32_bf16 v[84:87], v[104:107], a[44:47], v[84:87]
  s_add_u32 s20, s20, 4096
  buffer_load_dwordx4 v[104:107], v1, s[8:11], s20 offen offset:0
  v_mfma_f32_16x16x32_bf16 v[72:75], v[108:111], a[48:51], v[72:75]
  v_fmac_f32 v95, v39, v17
  v_mul_f32 v40, v88, v20
  v_mfma_f32_16x16x32_bf16 v[76:79], v[108:111], a[52:55], v[76:79]
  v_mul_f32 v41, v89, v20
  v_mul_f32 v42, v90, v20
  v_mfma_f32_16x16x32_bf16 v[80:83], v[108:111], a[56:59], v[80:83]
  v_mul_f32 v43, v91, v20
  v_mul_f32 v44, v92, v21
  v_mfma_f32_16x16x32_bf16 v[84:87], v[108:111], a[60:63], v[84:87]
  buffer_load_dwordx4 v[108:111], v1, s[8:11], s20 offen offset:1024
  v_mul_f32 v45, v93, v21
  s_waitcnt vmcnt(20)
  v_mfma_f32_16x16x32_bf16 v[72:75], v[112:115], a[64:67], v[72:75]
  v_mul_f32 v46, v94, v21
  v_mul_f32 v47, v95, v21
  v_mfma_f32_16x16x32_bf16 v[76:79], v[112:115], a[68:71], v[76:79]
  v_exp_f32 v40, v40
  v_mfma_f32_16x16x32_bf16 v[80:83], v[112:115], a[72:75], v[80:83]
  v_exp_f32 v41, v41
  v_mfma_f32_16x16x32_bf16 v[84:87], v[112:115], a[76:79], v[84:87]
  buffer_load_dwordx4 v[112:115], v1, s[8:11], s20 offen offset:2048
  v_exp_f32 v42, v42
  v_mfma_f32_16x16x32_bf16 v[72:75], v[116:119], a[80:83], v[72:75]
  v_exp_f32 v43, v43
  v_mfma_f32_16x16x32_bf16 v[76:79], v[116:119], a[84:87], v[76:79]
  v_exp_f32 v44, v44
  v_mfma_f32_16x16x32_bf16 v[80:83], v[116:119], a[88:91], v[80:83]
  v_exp_f32 v45, v45
  v_mfma_f32_16x16x32_bf16 v[84:87], v[116:119], a[92:95], v[84:87]
  buffer_load_dwordx4 v[116:119], v1, s[8:11], s20 offen offset:3072
  s_waitcnt vmcnt(20)
  v_mfma_f32_16x16x32_bf16 v[72:75], v[120:123], a[96:99], v[72:75]
  v_exp_f32 v46, v46
  v_mfma_f32_16x16x32_bf16 v[76:79], v[120:123], a[100:103], v[76:79]
  v_exp_f32 v47, v47
  v_mfma_f32_16x16x32_bf16 v[80:83], v[120:123], a[104:107], v[80:83]
  v_add_f32 v40, 1.0, v40
  v_add_f32 v41, 1.0, v41
  v_mfma_f32_16x16x32_bf16 v[84:87], v[120:123], a[108:111], v[84:87]
  s_add_u32 s20, s20, 4096
  buffer_load_dwordx4 v[120:123], v1, s[8:11], s20 offen offset:0
  v_mfma_f32_16x16x32_bf16 v[72:75], v[124:127], a[112:115], v[72:75]
  v_add_f32 v42, 1.0, v42
  v_add_f32 v43, 1.0, v43
  v_mfma_f32_16x16x32_bf16 v[76:79], v[124:127], a[116:119], v[76:79]
  v_add_f32 v44, 1.0, v44
  v_add_f32 v45, 1.0, v45
  v_mfma_f32_16x16x32_bf16 v[80:83], v[124:127], a[120:123], v[80:83]
  v_add_f32 v46, 1.0, v46
  v_add_f32 v47, 1.0, v47
  v_mfma_f32_16x16x32_bf16 v[84:87], v[124:127], a[124:127], v[84:87]
  buffer_load_dwordx4 v[124:127], v1, s[8:11], s20 offen offset:1024
  v_rcp_f32 v40, v40
  s_waitcnt vmcnt(20)
  v_mfma_f32_16x16x32_bf16 v[72:75], v[128:131], a[128:131], v[72:75]
  v_rcp_f32 v41, v41
  v_mfma_f32_16x16x32_bf16 v[76:79], v[128:131], a[132:135], v[76:79]
  v_rcp_f32 v42, v42
  v_mfma_f32_16x16x32_bf16 v[80:83], v[128:131], a[136:139], v[80:83]
  v_rcp_f32 v43, v43
  v_mfma_f32_16x16x32_bf16 v[84:87], v[128:131], a[140:143], v[84:87]
  buffer_load_dwordx4 v[128:131], v1, s[8:11], s20 offen offset:2048
  v_mfma_f32_16x16x32_bf16 v[72:75], v[132:135], a[144:147], v[72:75]
  v_rcp_f32 v44, v44
  v_mfma_f32_16x16x32_bf16 v[76:79], v[132:135], a[148:151], v[76:79]
  v_rcp_f32 v45, v45
  v_mfma_f32_16x16x32_bf16 v[80:83], v[132:135], a[152:155], v[80:83]
  v_rcp_f32 v46, v46
  v_mfma_f32_16x16x32_bf16 v[84:87], v[132:135], a[156:159], v[84:87]
  buffer_load_dwordx4 v[132:135], v1, s[8:11], s20 offen offset:3072
  v_rcp_f32 v47, v47
  s_waitcnt vmcnt(20)
  v_mfma_f32_16x16x32_bf16 v[72:75], v[136:139], a[160:163], v[72:75]
  v_mul_f32 v88, v88, v40
  v_mfma_f32_16x16x32_bf16 v[76:79], v[136:139], a[164:167], v[76:79]
  v_mul_f32 v89, v89, v41
  v_mul_f32 v90, v90, v42
  v_mfma_f32_16x16x32_bf16 v[80:83], v[136:139], a[168:171], v[80:83]
  v_mul_f32 v91, v91, v43
  v_mul_f32 v92, v92, v44
  v_mfma_f32_16x16x32_bf16 v[84:87], v[136:139], a[172:175], v[84:87]
  s_add_u32 s20, s20, 4096
  buffer_load_dwordx4 v[136:139], v1, s[8:11], s20 offen offset:0
  v_mfma_f32_16x16x32_bf16 v[72:75], v[140:143], a[176:179], v[72:75]
  v_mul_f32 v93, v93, v45
  v_mul_f32 v94, v94, v46
  v_mfma_f32_16x16x32_bf16 v[76:79], v[140:143], a[180:183], v[76:79]
  v_mul_f32 v95, v95, v47
  v_cvt_pk_bf16_f32 v56, v88, v89
  v_mfma_f32_16x16x32_bf16 v[80:83], v[140:143], a[184:187], v[80:83]
  v_cvt_pk_bf16_f32 v57, v90, v91
  v_cvt_pk_bf16_f32 v58, v92, v93
  v_mfma_f32_16x16x32_bf16 v[84:87], v[140:143], a[188:191], v[84:87]
  buffer_load_dwordx4 v[140:143], v1, s[8:11], s20 offen offset:1024
  v_cvt_pk_bf16_f32 v59, v94, v95
  s_waitcnt vmcnt(20)
  v_mfma_f32_16x16x32_bf16 v[72:75], v[144:147], a[192:195], v[72:75]
  ds_write_b64 v12, v[56:57] offset:10240
  ds_write_b64 v13, v[58:59] offset:10240
  v_mfma_f32_16x16x32_bf16 v[76:79], v[144:147], a[196:199], v[76:79]
  v_fmac_f32 v96, v36, v18
  v_fmac_f32 v97, v37, v18
  v_mfma_f32_16x16x32_bf16 v[80:83], v[144:147], a[200:203], v[80:83]
  v_fmac_f32 v98, v38, v18
  v_fmac_f32 v99, v39, v18
  v_mfma_f32_16x16x32_bf16 v[84:87], v[144:147], a[204:207], v[84:87]
  buffer_load_dwordx4 v[144:147], v1, s[8:11], s20 offen offset:2048
  v_fmac_f32 v100, v36, v19
  v_mfma_f32_16x16x32_bf16 v[72:75], v[148:151], a[208:211], v[72:75]
  v_fmac_f32 v101, v37, v19
  v_fmac_f32 v102, v38, v19
  v_mfma_f32_16x16x32_bf16 v[76:79], v[148:151], a[212:215], v[76:79]
  v_fmac_f32 v103, v39, v19
  v_mul_f32 v48, v96, v22
  v_mfma_f32_16x16x32_bf16 v[80:83], v[148:151], a[216:219], v[80:83]
  v_mul_f32 v49, v97, v22
  v_mul_f32 v50, v98, v22
  v_mfma_f32_16x16x32_bf16 v[84:87], v[148:151], a[220:223], v[84:87]
  buffer_load_dwordx4 v[148:151], v1, s[8:11], s20 offen offset:3072
  v_mul_f32 v51, v99, v22
  s_waitcnt vmcnt(20)
  v_mfma_f32_16x16x32_bf16 v[72:75], v[152:155], a[224:227], v[72:75]
  v_mul_f32 v52, v100, v23
  v_mul_f32 v53, v101, v23
  v_mfma_f32_16x16x32_bf16 v[76:79], v[152:155], a[228:231], v[76:79]
  v_mul_f32 v54, v102, v23
  v_mul_f32 v55, v103, v23
  v_mfma_f32_16x16x32_bf16 v[80:83], v[152:155], a[232:235], v[80:83]
  v_exp_f32 v48, v48
  v_mfma_f32_16x16x32_bf16 v[84:87], v[152:155], a[236:239], v[84:87]
  s_add_u32 s20, s20, 4096
  buffer_load_dwordx4 v[152:155], v1, s[8:11], s20 offen offset:0
  v_mfma_f32_16x16x32_bf16 v[72:75], v[156:159], a[240:243], v[72:75]
  v_exp_f32 v49, v49
  v_mfma_f32_16x16x32_bf16 v[76:79], v[156:159], a[244:247], v[76:79]
  v_exp_f32 v50, v50
  v_mfma_f32_16x16x32_bf16 v[80:83], v[156:159], a[248:251], v[80:83]
  v_exp_f32 v51, v51
  v_mfma_f32_16x16x32_bf16 v[84:87], v[156:159], a[252:255], v[84:87]
  buffer_load_dwordx4 v[156:159], v1, s[8:11], s20 offen offset:1024
  v_exp_f32 v52, v52
  s_waitcnt vmcnt(20)
  v_mfma_f32_16x16x32_bf16 v[72:75], v[160:163], v[192:195], v[72:75]
  v_exp_f32 v53, v53
  v_mfma_f32_16x16x32_bf16 v[76:79], v[160:163], v[196:199], v[76:79]
  v_exp_f32 v54, v54
  v_mfma_f32_16x16x32_bf16 v[80:83], v[160:163], v[200:203], v[80:83]
  v_exp_f32 v55, v55
  v_mfma_f32_16x16x32_bf16 v[84:87], v[160:163], v[204:207], v[84:87]
  buffer_load_dwordx4 v[160:163], v1, s[8:11], s20 offen offset:2048
  v_mfma_f32_16x16x32_bf16 v[72:75], v[164:167], v[208:211], v[72:75]
  v_add_f32 v48, 1.0, v48
  v_add_f32 v49, 1.0, v49
  v_mfma_f32_16x16x32_bf16 v[76:79], v[164:167], v[212:215], v[76:79]
  v_add_f32 v50, 1.0, v50
  v_add_f32 v51, 1.0, v51
  v_mfma_f32_16x16x32_bf16 v[80:83], v[164:167], v[216:219], v[80:83]
  v_add_f32 v52, 1.0, v52
  v_add_f32 v53, 1.0, v53
  v_mfma_f32_16x16x32_bf16 v[84:87], v[164:167], v[220:223], v[84:87]
  buffer_load_dwordx4 v[164:167], v1, s[8:11], s20 offen offset:3072
  v_add_f32 v54, 1.0, v54
  v_add_f32 v55, 1.0, v55
  v_rcp_f32 v48, v48
  v_rcp_f32 v49, v49
  v_rcp_f32 v50, v50
  v_rcp_f32 v51, v51
  v_rcp_f32 v52, v52
  v_rcp_f32 v53, v53
  v_rcp_f32 v54, v54
  v_rcp_f32 v55, v55
  v_mul_f32 v96, v96, v48
  v_mul_f32 v97, v97, v49
  v_mul_f32 v98, v98, v50
  v_mul_f32 v99, v99, v51
  v_mul_f32 v100, v100, v52
  v_mul_f32 v101, v101, v53
  v_mul_f32 v102, v102, v54
  v_mul_f32 v103, v103, v55
  v_cvt_pk_bf16_f32 v60, v96, v97
  v_cvt_pk_bf16_f32 v61, v98, v99
  v_cvt_pk_bf16_f32 v62, v100, v101
  v_cvt_pk_bf16_f32 v63, v102, v103
  ds_write_b64 v14, v[60:61] offset:10240
  ds_write_b64 v15, v[62:63] offset:10240
  s_waitcnt vmcnt(20)
  v_mfma_f32_16x16x32_bf16 v[88:91], v[168:171], a[0:3], 0
  v_mfma_f32_16x16x32_bf16 v[92:95], v[168:171], a[4:7], 0
  v_mfma_f32_16x16x32_bf16 v[96:99], v[168:171], a[8:11], 0
  v_mfma_f32_16x16x32_bf16 v[100:103], v[168:171], a[12:15], 0
  s_add_u32 s20, s20, 4096
  buffer_load_dwordx4 v[168:171], v1, s[8:11], s20 offen offset:0
  v_mfma_f32_16x16x32_bf16 v[88:91], v[172:175], a[16:19], v[88:91]
  v_mfma_f32_16x16x32_bf16 v[92:95], v[172:175], a[20:23], v[92:95]
  v_mfma_f32_16x16x32_bf16 v[96:99], v[172:175], a[24:27], v[96:99]
  ds_read_b128 v[36:39], v28 offset:1792
  s_waitcnt lgkmcnt(5)
  v_mfma_f32_16x16x32_bf16 v[100:103], v[172:175], a[28:31], v[100:103]
  buffer_load_dwordx4 v[172:175], v1, s[8:11], s20 offen offset:1024
  v_fmac_f32 v72, v32, v16
  s_waitcnt vmcnt(20)
  v_mfma_f32_16x16x32_bf16 v[88:91], v[176:179], a[32:35], v[88:91]
  v_fmac_f32 v73, v33, v16
  v_fmac_f32 v74, v34, v16
  v_mfma_f32_16x16x32_bf16 v[92:95], v[176:179], a[36:39], v[92:95]
  v_fmac_f32 v75, v35, v16
  v_fmac_f32 v76, v32, v17
  v_mfma_f32_16x16x32_bf16 v[96:99], v[176:179], a[40:43], v[96:99]
  v_fmac_f32 v77, v33, v17
  v_fmac_f32 v78, v34, v17
  v_mfma_f32_16x16x32_bf16 v[100:103], v[176:179], a[44:47], v[100:103]
  buffer_load_dwordx4 v[176:179], v1, s[8:11], s20 offen offset:2048
  v_fmac_f32 v79, v35, v17
  v_mfma_f32_16x16x32_bf16 v[88:91], v[180:183], a[48:51], v[88:91]
  v_mul_f32 v40, v72, v20
  v_mul_f32 v41, v73, v20
  v_mfma_f32_16x16x32_bf16 v[92:95], v[180:183], a[52:55], v[92:95]
  v_mul_f32 v42, v74, v20
  v_mul_f32 v43, v75, v20
  v_mfma_f32_16x16x32_bf16 v[96:99], v[180:183], a[56:59], v[96:99]
  v_mul_f32 v44, v76, v21
  v_mul_f32 v45, v77, v21
  v_mfma_f32_16x16x32_bf16 v[100:103], v[180:183], a[60:63], v[100:103]
  buffer_load_dwordx4 v[180:183], v1, s[8:11], s20 offen offset:3072
  v_mul_f32 v46, v78, v21
  s_waitcnt vmcnt(20)
  v_mfma_f32_16x16x32_bf16 v[88:91], v[184:187], a[64:67], v[88:91]
  v_mul_f32 v47, v79, v21
  v_exp_f32 v40, v40
  v_mfma_f32_16x16x32_bf16 v[92:95], v[184:187], a[68:71], v[92:95]
  v_exp_f32 v41, v41
  v_mfma_f32_16x16x32_bf16 v[96:99], v[184:187], a[72:75], v[96:99]
  v_exp_f32 v42, v42
  v_mfma_f32_16x16x32_bf16 v[100:103], v[184:187], a[76:79], v[100:103]
  s_add_u32 s20, s20, 4096
  buffer_load_dwordx4 v[184:187], v1, s[8:11], s20 offen offset:0
  v_mfma_f32_16x16x32_bf16 v[88:91], v[188:191], a[80:83], v[88:91]
  v_exp_f32 v43, v43
  v_mfma_f32_16x16x32_bf16 v[92:95], v[188:191], a[84:87], v[92:95]
  v_exp_f32 v44, v44
  v_mfma_f32_16x16x32_bf16 v[96:99], v[188:191], a[88:91], v[96:99]
  v_exp_f32 v45, v45
  v_mfma_f32_16x16x32_bf16 v[100:103], v[188:191], a[92:95], v[100:103]
  buffer_load_dwordx4 v[188:191], v1, s[8:11], s20 offen offset:1024
  s_waitcnt vmcnt(20)
  v_mfma_f32_16x16x32_bf16 v[88:91], v[104:107], a[96:99], v[88:91]
  v_exp_f32 v46, v46
  v_mfma_f32_16x16x32_bf16 v[92:95], v[104:107], a[100:103], v[92:95]
  v_exp_f32 v47, v47
  v_mfma_f32_16x16x32_bf16 v[96:99], v[104:107], a[104:107], v[96:99]
  v_add_f32 v40, 1.0, v40
  v_add_f32 v41, 1.0, v41
  v_mfma_f32_16x16x32_bf16 v[100:103], v[104:107], a[108:111], v[100:103]
  buffer_load_dwordx4 v[104:107], v1, s[8:11], s20 offen offset:2048
  v_add_f32 v42, 1.0, v42
  v_mfma_f32_16x16x32_bf16 v[88:91], v[108:111], a[112:115], v[88:91]
  v_add_f32 v43, 1.0, v43
  v_add_f32 v44, 1.0, v44
  v_mfma_f32_16x16x32_bf16 v[92:95], v[108:111], a[116:119], v[92:95]
  v_add_f32 v45, 1.0, v45
  v_add_f32 v46, 1.0, v46
  v_mfma_f32_16x16x32_bf16 v[96:99], v[108:111], a[120:123], v[96:99]
  v_add_f32 v47, 1.0, v47
  v_rcp_f32 v40, v40
  v_mfma_f32_16x16x32_bf16 v[100:103], v[108:111], a[124:127], v[100:103]
  buffer_load_dwordx4 v[108:111], v1, s[8:11], s20 offen offset:3072
  s_waitcnt vmcnt(20)
  v_mfma_f32_16x16x32_bf16 v[88:91], v[112:115], a[128:131], v[88:91]
  v_rcp_f32 v41, v41
  v_mfma_f32_16x16x32_bf16 v[92:95], v[112:115], a[132:135], v[92:95]
  v_rcp_f32 v42, v42
  v_mfma_f32_16x16x32_bf16 v[96:99], v[112:115], a[136:139], v[96:99]
  v_rcp_f32 v43, v43
  v_mfma_f32_16x16x32_bf16 v[100:103], v[112:115], a[140:143], v[100:103]
  s_add_u32 s20, s20, 4096
  buffer_load_dwordx4 v[112:115], v1, s[8:11], s20 offen offset:0
  v_mfma_f32_16x16x32_bf16 v[88:91], v[116:119], a[144:147], v[88:91]
  v_rcp_f32 v44, v44
  v_mfma_f32_16x16x32_bf16 v[92:95], v[116:119], a[148:151], v[92:95]
  v_rcp_f32 v45, v45
  v_mfma_f32_16x16x32_bf16 v[96:99], v[116:119], a[152:155], v[96:99]
  v_rcp_f32 v46, v46
  v_mfma_f32_16x16x32_bf16 v[100:103], v[116:119], a[156:159], v[100:103]
  buffer_load_dwordx4 v[116:119], v1, s[8:11], s20 offen offset:1024
  v_rcp_f32 v47, v47
  s_waitcnt vmcnt(20)
  v_mfma_f32_16x16x32_bf16 v[88:91], v[120:123], a[160:163], v[88:91]
  v_mul_f32 v72, v72, v40
  v_mfma_f32_16x16x32_bf16 v[92:95], v[120:123], a[164:167], v[92:95]
  v_mul_f32 v73, v73, v41
  v_mul_f32 v74, v74, v42
  v_mfma_f32_16x16x32_bf16 v[96:99], v[120:123], a[168:171], v[96:99]
  v_mul_f32 v75, v75, v43
  v_mul_f32 v76, v76, v44
  v_mfma_f32_16x16x32_bf16 v[100:103], v[120:123], a[172:175], v[100:103]
  buffer_load_dwordx4 v[120:123], v1, s[8:11], s20 offen offset:2048
  v_mul_f32 v77, v77, v45
  v_mfma_f32_16x16x32_bf16 v[88:91], v[124:127], a[176:179], v[88:91]
  v_mul_f32 v78, v78, v46
  v_mul_f32 v79, v79, v47
  v_mfma_f32_16x16x32_bf16 v[92:95], v[124:127], a[180:183], v[92:95]
  v_cvt_pk_bf16_f32 v56, v72, v73
  v_cvt_pk_bf16_f32 v57, v74, v75
  v_mfma_f32_16x16x32_bf16 v[96:99], v[124:127], a[184:187], v[96:99]
  v_cvt_pk_bf16_f32 v58, v76, v77
  v_cvt_pk_bf16_f32 v59, v78, v79
  v_mfma_f32_16x16x32_bf16 v[100:103], v[124:127], a[188:191], v[100:103]
  buffer_load_dwordx4 v[124:127], v1, s[8:11], s20 offen offset:3072
  ds_write_b64 v12, v[56:57] offset:12288
  s_waitcnt vmcnt(20)
  v_mfma_f32_16x16x32_bf16 v[88:91], v[128:131], a[192:195], v[88:91]
  ds_write_b64 v13, v[58:59] offset:12288
  v_fmac_f32 v80, v32, v18
  v_mfma_f32_16x16x32_bf16 v[92:95], v[128:131], a[196:199], v[92:95]
  v_fmac_f32 v81, v33, v18
  v_fmac_f32 v82, v34, v18
  v_mfma_f32_16x16x32_bf16 v[96:99], v[128:131], a[200:203], v[96:99]
  v_fmac_f32 v83, v35, v18
  v_fmac_f32 v84, v32, v19
  v_mfma_f32_16x16x32_bf16 v[100:103], v[128:131], a[204:207], v[100:103]
  s_add_u32 s20, s20, 4096
  buffer_load_dwordx4 v[128:131], v1, s[8:11], s20 offen offset:0
  v_mfma_f32_16x16x32_bf16 v[88:91], v[132:135], a[208:211], v[88:91]
  v_fmac_f32 v85, v33, v19
  v_fmac_f32 v86, v34, v19
  v_mfma_f32_16x16x32_bf16 v[92:95], v[132:135], a[212:215], v[92:95]
  v_fmac_f32 v87, v35, v19
  v_mul_f32 v48, v80, v22
  v_mfma_f32_16x16x32_bf16 v[96:99], v[132:135], a[216:219], v[96:99]
  v_mul_f32 v49, v81, v22
  v_mul_f32 v50, v82, v22
  v_mfma_f32_16x16x32_bf16 v[100:103], v[132:135], a[220:223], v[100:103]
  buffer_load_dwordx4 v[132:135], v1, s[8:11], s20 offen offset:1024
  v_mul_f32 v51, v83, v22
  s_waitcnt vmcnt(20)
  v_mfma_f32_16x16x32_bf16 v[88:91], v[136:139], a[224:227], v[88:91]
  v_mul_f32 v52, v84, v23
  v_mul_f32 v53, v85, v23
  v_mfma_f32_16x16x32_bf16 v[92:95], v[136:139], a[228:231], v[92:95]
  v_mul_f32 v54, v86, v23
  v_mul_f32 v55, v87, v23
  v_mfma_f32_16x16x32_bf16 v[96:99], v[136:139], a[232:235], v[96:99]
  v_exp_f32 v48, v48
  v_mfma_f32_16x16x32_bf16 v[100:103], v[136:139], a[236:239], v[100:103]
  buffer_load_dwordx4 v[136:139], v1, s[8:11], s20 offen offset:2048
  v_exp_f32 v49, v49
  v_mfma_f32_16x16x32_bf16 v[88:91], v[140:143], a[240:243], v[88:91]
  v_exp_f32 v50, v50
  v_mfma_f32_16x16x32_bf16 v[92:95], v[140:143], a[244:247], v[92:95]
  v_exp_f32 v51, v51
  v_mfma_f32_16x16x32_bf16 v[96:99], v[140:143], a[248:251], v[96:99]
  v_exp_f32 v52, v52
  v_mfma_f32_16x16x32_bf16 v[100:103], v[140:143], a[252:255], v[100:103]
  buffer_load_dwordx4 v[140:143], v1, s[8:11], s20 offen offset:3072
  s_waitcnt vmcnt(20)
  v_mfma_f32_16x16x32_bf16 v[88:91], v[144:147], v[192:195], v[88:91]
  v_exp_f32 v53, v53
  v_mfma_f32_16x16x32_bf16 v[92:95], v[144:147], v[196:199], v[92:95]
  v_exp_f32 v54, v54
  v_mfma_f32_16x16x32_bf16 v[96:99], v[144:147], v[200:203], v[96:99]
  v_exp_f32 v55, v55
  v_mfma_f32_16x16x32_bf16 v[100:103], v[144:147], v[204:207], v[100:103]
  s_add_u32 s20, s20, 4096
  buffer_load_dwordx4 v[144:147], v1, s[8:11], s20 offen offset:0
  v_mfma_f32_16x16x32_bf16 v[88:91], v[148:151], v[208:211], v[88:91]
  v_add_f32 v48, 1.0, v48
  v_add_f32 v49, 1.0, v49
  v_mfma_f32_16x16x32_bf16 v[92:95], v[148:151], v[212:215], v[92:95]
  v_add_f32 v50, 1.0, v50
  v_add_f32 v51, 1.0, v51
  v_mfma_f32_16x16x32_bf16 v[96:99], v[148:151], v[216:219], v[96:99]
  v_add_f32 v52, 1.0, v52
  v_add_f32 v53, 1.0, v53
  v_mfma_f32_16x16x32_bf16 v[100:103], v[148:151], v[220:223], v[100:103]
  buffer_load_dwordx4 v[148:151], v1, s[8:11], s20 offen offset:1024
  v_add_f32 v54, 1.0, v54
  v_add_f32 v55, 1.0, v55
  v_rcp_f32 v48, v48
  v_rcp_f32 v49, v49
  v_rcp_f32 v50, v50
  v_rcp_f32 v51, v51
  v_rcp_f32 v52, v52
  v_rcp_f32 v53, v53
  v_rcp_f32 v54, v54
  v_rcp_f32 v55, v55
  v_mul_f32 v80, v80, v48
  v_mul_f32 v81, v81, v49
  v_mul_f32 v82, v82, v50
  v_mul_f32 v83, v83, v51
  v_mul_f32 v84, v84, v52
  v_mul_f32 v85, v85, v53
  v_mul_f32 v86, v86, v54
  v_mul_f32 v87, v87, v55
  v_cvt_pk_bf16_f32 v60, v80, v81
  v_cvt_pk_bf16_f32 v61, v82, v83
  v_cvt_pk_bf16_f32 v62, v84, v85
  v_cvt_pk_bf16_f32 v63, v86, v87
  ds_write_b64 v14, v[60:61] offset:12288
  ds_write_b64 v15, v[62:63] offset:12288
  s_waitcnt vmcnt(20)
  v_mfma_f32_16x16x32_bf16 v[72:75], v[152:155], a[0:3], 0
  v_mfma_f32_16x16x32_bf16 v[76:79], v[152:155], a[4:7], 0
  v_mfma_f32_16x16x32_bf16 v[80:83], v[152:155], a[8:11], 0
  v_mfma_f32_16x16x32_bf16 v[84:87], v[152:155], a[12:15], 0
  buffer_load_dwordx4 v[152:155], v1, s[8:11], s20 offen offset:2048
  v_mfma_f32_16x16x32_bf16 v[72:75], v[156:159], a[16:19], v[72:75]
  v_mfma_f32_16x16x32_bf16 v[76:79], v[156:159], a[20:23], v[76:79]
  v_mfma_f32_16x16x32_bf16 v[80:83], v[156:159], a[24:27], v[80:83]
  ds_read_b128 v[32:35], v28 offset:2048
  s_waitcnt lgkmcnt(5)
  v_mfma_f32_16x16x32_bf16 v[84:87], v[156:159], a[28:31], v[84:87]
  buffer_load_dwordx4 v[156:159], v1, s[8:11], s20 offen offset:3072
  v_fmac_f32 v88, v36, v16
  s_waitcnt vmcnt(20)
  v_mfma_f32_16x16x32_bf16 v[72:75], v[160:163], a[32:35], v[72:75]
  v_fmac_f32 v89, v37, v16
  v_fmac_f32 v90, v38, v16
  v_mfma_f32_16x16x32_bf16 v[76:79], v[160:163], a[36:39], v[76:79]
  v_fmac_f32 v91, v39, v16
  v_fmac_f32 v92, v36, v17
  v_mfma_f32_16x16x32_bf16 v[80:83], v[160:163], a[40:43], v[80:83]
  v_fmac_f32 v93, v37, v17
  v_fmac_f32 v94, v38, v17
  v_mfma_f32_16x16x32_bf16 v[84:87], v[160:163], a[44:47], v[84:87]
  s_add_u32 s20, s20, 4096
  buffer_load_dwordx4 v[160:163], v1, s[8:11], s20 offen offset:0
  v_mfma_f32_16x16x32_bf16 v[72:75], v[164:167], a[48:51], v[72:75]
  v_fmac_f32 v95, v39, v17
  v_mul_f32 v40, v88, v20
  v_mfma_f32_16x16x32_bf16 v[76:79], v[164:167], a[52:55], v[76:79]
  v_mul_f32 v41, v89, v20
  v_mul_f32 v42, v90, v20
  v_mfma_f32_16x16x32_bf16 v[80:83], v[164:167], a[56:59], v[80:83]
  v_mul_f32 v43, v91, v20
  v_mul_f32 v44, v92, v21
  v_mfma_f32_16x16x32_bf16 v[84:87], v[164:167], a[60:63], v[84:87]
  buffer_load_dwordx4 v[164:167], v1, s[8:11], s20 offen offset:1024
  v_mul_f32 v45, v93, v21
  s_waitcnt vmcnt(20)
  v_mfma_f32_16x16x32_bf16 v[72:75], v[168:171], a[64:67], v[72:75]
  v_mul_f32 v46, v94, v21
  v_mul_f32 v47, v95, v21
  v_mfma_f32_16x16x32_bf16 v[76:79], v[168:171], a[68:71], v[76:79]
  v_exp_f32 v40, v40
  v_mfma_f32_16x16x32_bf16 v[80:83], v[168:171], a[72:75], v[80:83]
  v_exp_f32 v41, v41
  v_mfma_f32_16x16x32_bf16 v[84:87], v[168:171], a[76:79], v[84:87]
  buffer_load_dwordx4 v[168:171], v1, s[8:11], s20 offen offset:2048
  v_exp_f32 v42, v42
  v_mfma_f32_16x16x32_bf16 v[72:75], v[172:175], a[80:83], v[72:75]
  v_exp_f32 v43, v43
  v_mfma_f32_16x16x32_bf16 v[76:79], v[172:175], a[84:87], v[76:79]
  v_exp_f32 v44, v44
  v_mfma_f32_16x16x32_bf16 v[80:83], v[172:175], a[88:91], v[80:83]
  v_exp_f32 v45, v45
  v_mfma_f32_16x16x32_bf16 v[84:87], v[172:175], a[92:95], v[84:87]
  buffer_load_dwordx4 v[172:175], v1, s[8:11], s20 offen offset:3072
  s_waitcnt vmcnt(20)
  v_mfma_f32_16x16x32_bf16 v[72:75], v[176:179], a[96:99], v[72:75]
  v_exp_f32 v46, v46
  v_mfma_f32_16x16x32_bf16 v[76:79], v[176:179], a[100:103], v[76:79]
  v_exp_f32 v47, v47
  v_mfma_f32_16x16x32_bf16 v[80:83], v[176:179], a[104:107], v[80:83]
  v_add_f32 v40, 1.0, v40
  v_add_f32 v41, 1.0, v41
  v_mfma_f32_16x16x32_bf16 v[84:87], v[176:179], a[108:111], v[84:87]
  s_add_u32 s20, s20, 4096
  buffer_load_dwordx4 v[176:179], v1, s[8:11], s20 offen offset:0
  v_mfma_f32_16x16x32_bf16 v[72:75], v[180:183], a[112:115], v[72:75]
  v_add_f32 v42, 1.0, v42
  v_add_f32 v43, 1.0, v43
  v_mfma_f32_16x16x32_bf16 v[76:79], v[180:183], a[116:119], v[76:79]
  v_add_f32 v44, 1.0, v44
  v_add_f32 v45, 1.0, v45
  v_mfma_f32_16x16x32_bf16 v[80:83], v[180:183], a[120:123], v[80:83]
  v_add_f32 v46, 1.0, v46
  v_add_f32 v47, 1.0, v47
  v_mfma_f32_16x16x32_bf16 v[84:87], v[180:183], a[124:127], v[84:87]
  buffer_load_dwordx4 v[180:183], v1, s[8:11], s20 offen offset:1024
  v_rcp_f32 v40, v40
  s_waitcnt vmcnt(20)
  v_mfma_f32_16x16x32_bf16 v[72:75], v[184:187], a[128:131], v[72:75]
  v_rcp_f32 v41, v41
  v_mfma_f32_16x16x32_bf16 v[76:79], v[184:187], a[132:135], v[76:79]
  v_rcp_f32 v42, v42
  v_mfma_f32_16x16x32_bf16 v[80:83], v[184:187], a[136:139], v[80:83]
  v_rcp_f32 v43, v43
  v_mfma_f32_16x16x32_bf16 v[84:87], v[184:187], a[140:143], v[84:87]
  buffer_load_dwordx4 v[184:187], v1, s[8:11], s20 offen offset:2048
  v_mfma_f32_16x16x32_bf16 v[72:75], v[188:191], a[144:147], v[72:75]
  v_rcp_f32 v44, v44
  v_mfma_f32_16x16x32_bf16 v[76:79], v[188:191], a[148:151], v[76:79]
  v_rcp_f32 v45, v45
  v_mfma_f32_16x16x32_bf16 v[80:83], v[188:191], a[152:155], v[80:83]
  v_rcp_f32 v46, v46
  v_mfma_f32_16x16x32_bf16 v[84:87], v[188:191], a[156:159], v[84:87]
  buffer_load_dwordx4 v[188:191], v1, s[8:11], s20 offen offset:3072
  v_rcp_f32 v47, v47
  s_waitcnt vmcnt(20)
  v_mfma_f32_16x16x32_bf16 v[72:75], v[104:107], a[160:163], v[72:75]
  v_mul_f32 v88, v88, v40
  v_mfma_f32_16x16x32_bf16 v[76:79], v[104:107], a[164:167], v[76:79]
  v_mul_f32 v89, v89, v41
  v_mul_f32 v90, v90, v42
  v_mfma_f32_16x16x32_bf16 v[80:83], v[104:107], a[168:171], v[80:83]
  v_mul_f32 v91, v91, v43
  v_mul_f32 v92, v92, v44
  v_mfma_f32_16x16x32_bf16 v[84:87], v[104:107], a[172:175], v[84:87]
  s_add_u32 s20, s20, 4096
  buffer_load_dwordx4 v[104:107], v1, s[8:11], s20 offen offset:0
  v_mfma_f32_16x16x32_bf16 v[72:75], v[108:111], a[176:179], v[72:75]
  v_mul_f32 v93, v93, v45
  v_mul_f32 v94, v94, v46
  v_mfma_f32_16x16x32_bf16 v[76:79], v[108:111], a[180:183], v[76:79]
  v_mul_f32 v95, v95, v47
  v_cvt_pk_bf16_f32 v56, v88, v89
  v_mfma_f32_16x16x32_bf16 v[80:83], v[108:111], a[184:187], v[80:83]
  v_cvt_pk_bf16_f32 v57, v90, v91
  v_cvt_pk_bf16_f32 v58, v92, v93
  v_mfma_f32_16x16x32_bf16 v[84:87], v[108:111], a[188:191], v[84:87]
  buffer_load_dwordx4 v[108:111], v1, s[8:11], s20 offen offset:1024
  v_cvt_pk_bf16_f32 v59, v94, v95
  s_waitcnt vmcnt(20)
  v_mfma_f32_16x16x32_bf16 v[72:75], v[112:115], a[192:195], v[72:75]
  ds_write_b64 v12, v[56:57] offset:14336
  ds_write_b64 v13, v[58:59] offset:14336
  v_mfma_f32_16x16x32_bf16 v[76:79], v[112:115], a[196:199], v[76:79]
  v_fmac_f32 v96, v36, v18
  v_fmac_f32 v97, v37, v18
  v_mfma_f32_16x16x32_bf16 v[80:83], v[112:115], a[200:203], v[80:83]
  v_fmac_f32 v98, v38, v18
  v_fmac_f32 v99, v39, v18
  v_mfma_f32_16x16x32_bf16 v[84:87], v[112:115], a[204:207], v[84:87]
  buffer_load_dwordx4 v[112:115], v1, s[8:11], s20 offen offset:2048
  v_fmac_f32 v100, v36, v19
  v_mfma_f32_16x16x32_bf16 v[72:75], v[116:119], a[208:211], v[72:75]
  v_fmac_f32 v101, v37, v19
  v_fmac_f32 v102, v38, v19
  v_mfma_f32_16x16x32_bf16 v[76:79], v[116:119], a[212:215], v[76:79]
  v_fmac_f32 v103, v39, v19
  v_mul_f32 v48, v96, v22
  v_mfma_f32_16x16x32_bf16 v[80:83], v[116:119], a[216:219], v[80:83]
  v_mul_f32 v49, v97, v22
  v_mul_f32 v50, v98, v22
  v_mfma_f32_16x16x32_bf16 v[84:87], v[116:119], a[220:223], v[84:87]
  buffer_load_dwordx4 v[116:119], v1, s[8:11], s20 offen offset:3072
  v_mul_f32 v51, v99, v22
  s_waitcnt vmcnt(20)
  v_mfma_f32_16x16x32_bf16 v[72:75], v[120:123], a[224:227], v[72:75]
  v_mul_f32 v52, v100, v23
  v_mul_f32 v53, v101, v23
  v_mfma_f32_16x16x32_bf16 v[76:79], v[120:123], a[228:231], v[76:79]
  v_mul_f32 v54, v102, v23
  v_mul_f32 v55, v103, v23
  v_mfma_f32_16x16x32_bf16 v[80:83], v[120:123], a[232:235], v[80:83]
  v_exp_f32 v48, v48
  v_mfma_f32_16x16x32_bf16 v[84:87], v[120:123], a[236:239], v[84:87]
  s_add_u32 s20, s20, 4096
  buffer_load_dwordx4 v[120:123], v1, s[8:11], s20 offen offset:0
  v_mfma_f32_16x16x32_bf16 v[72:75], v[124:127], a[240:243], v[72:75]
  v_exp_f32 v49, v49
  v_mfma_f32_16x16x32_bf16 v[76:79], v[124:127], a[244:247], v[76:79]
  v_exp_f32 v50, v50
  v_mfma_f32_16x16x32_bf16 v[80:83], v[124:127], a[248:251], v[80:83]
  v_exp_f32 v51, v51
  v_mfma_f32_16x16x32_bf16 v[84:87], v[124:127], a[252:255], v[84:87]
  buffer_load_dwordx4 v[124:127], v1, s[8:11], s20 offen offset:1024
  v_exp_f32 v52, v52
  s_waitcnt vmcnt(20)
  v_mfma_f32_16x16x32_bf16 v[72:75], v[128:131], v[192:195], v[72:75]
  v_exp_f32 v53, v53
  v_mfma_f32_16x16x32_bf16 v[76:79], v[128:131], v[196:199], v[76:79]
  v_exp_f32 v54, v54
  v_mfma_f32_16x16x32_bf16 v[80:83], v[128:131], v[200:203], v[80:83]
  v_exp_f32 v55, v55
  v_mfma_f32_16x16x32_bf16 v[84:87], v[128:131], v[204:207], v[84:87]
  buffer_load_dwordx4 v[128:131], v1, s[8:11], s20 offen offset:2048
  v_mfma_f32_16x16x32_bf16 v[72:75], v[132:135], v[208:211], v[72:75]
  v_add_f32 v48, 1.0, v48
  v_add_f32 v49, 1.0, v49
  v_mfma_f32_16x16x32_bf16 v[76:79], v[132:135], v[212:215], v[76:79]
  v_add_f32 v50, 1.0, v50
  v_add_f32 v51, 1.0, v51
  v_mfma_f32_16x16x32_bf16 v[80:83], v[132:135], v[216:219], v[80:83]
  v_add_f32 v52, 1.0, v52
  v_add_f32 v53, 1.0, v53
  v_mfma_f32_16x16x32_bf16 v[84:87], v[132:135], v[220:223], v[84:87]
  buffer_load_dwordx4 v[132:135], v1, s[8:11], s20 offen offset:3072
  v_add_f32 v54, 1.0, v54
  v_add_f32 v55, 1.0, v55
  v_rcp_f32 v48, v48
  v_rcp_f32 v49, v49
  v_rcp_f32 v50, v50
  v_rcp_f32 v51, v51
  v_rcp_f32 v52, v52
  v_rcp_f32 v53, v53
  v_rcp_f32 v54, v54
  v_rcp_f32 v55, v55
  v_mul_f32 v96, v96, v48
  v_mul_f32 v97, v97, v49
  v_mul_f32 v98, v98, v50
  v_mul_f32 v99, v99, v51
  v_mul_f32 v100, v100, v52
  v_mul_f32 v101, v101, v53
  v_mul_f32 v102, v102, v54
  v_mul_f32 v103, v103, v55
  v_cvt_pk_bf16_f32 v60, v96, v97
  v_cvt_pk_bf16_f32 v61, v98, v99
  v_cvt_pk_bf16_f32 v62, v100, v101
  v_cvt_pk_bf16_f32 v63, v102, v103
  ds_write_b64 v14, v[60:61] offset:14336
  ds_write_b64 v15, v[62:63] offset:14336
  s_waitcnt lgkmcnt(0)
  s_barrier
  ds_read_b128 a[0:3], v8 offset:0
  ds_read_b128 a[4:7], v9 offset:0
  ds_read_b128 a[8:11], v10 offset:0
  ds_read_b128 a[12:15], v11 offset:0
  ds_read_b128 a[16:19], v8 offset:1024
  ds_read_b128 a[20:23], v9 offset:1024
  ds_read_b128 a[24:27], v10 offset:1024
  ds_read_b128 a[28:31], v11 offset:1024
  s_waitcnt vmcnt(20)
  s_waitcnt lgkmcnt(4)
  v_mfma_f32_16x16x32_bf16 v[88:91], v[136:139], a[0:3], 0
  v_mfma_f32_16x16x32_bf16 v[92:95], v[136:139], a[4:7], 0
  v_mfma_f32_16x16x32_bf16 v[96:99], v[136:139], a[8:11], 0
  v_mfma_f32_16x16x32_bf16 v[100:103], v[136:139], a[12:15], 0
  s_add_u32 s20, s20, 4096
  buffer_load_dwordx4 v[136:139], v1, s[8:11], s20 offen offset:0
  ds_read_b128 a[32:35], v8 offset:2048
  ds_read_b128 a[36:39], v9 offset:2048
  ds_read_b128 a[40:43], v10 offset:2048
  ds_read_b128 a[44:47], v11 offset:2048
  s_waitcnt lgkmcnt(4)
  v_mfma_f32_16x16x32_bf16 v[88:91], v[140:143], a[16:19], v[88:91]
  v_mfma_f32_16x16x32_bf16 v[92:95], v[140:143], a[20:23], v[92:95]
  v_mfma_f32_16x16x32_bf16 v[96:99], v[140:143], a[24:27], v[96:99]
  v_fmac_f32 v72, v32, v16
  v_mfma_f32_16x16x32_bf16 v[100:103], v[140:143], a[28:31], v[100:103]
  buffer_load_dwordx4 v[140:143], v1, s[8:11], s20 offen offset:1024
  ds_read_b128 a[48:51], v8 offset:3072
  ds_read_b128 a[52:55], v9 offset:3072
  ds_read_b128 a[56:59], v10 offset:3072
  ds_read_b128 a[60:63], v11 offset:3072
  s_waitcnt vmcnt(20)
  s_waitcnt lgkmcnt(4)
  v_mfma_f32_16x16x32_bf16 v[88:91], v[144:147], a[32:35], v[88:91]
  v_mfma_f32_16x16x32_bf16 v[92:95], v[144:147], a[36:39], v[92:95]
  v_fmac_f32 v73, v33, v16
  v_mfma_f32_16x16x32_bf16 v[96:99], v[144:147], a[40:43], v[96:99]
  v_fmac_f32 v74, v34, v16
  v_fmac_f32 v75, v35, v16
  v_mfma_f32_16x16x32_bf16 v[100:103], v[144:147], a[44:47], v[100:103]
  buffer_load_dwordx4 v[144:147], v1, s[8:11], s20 offen offset:2048
  ds_read_b128 a[64:67], v8 offset:4096
  ds_read_b128 a[68:71], v9 offset:4096
  ds_read_b128 a[72:75], v10 offset:4096
  ds_read_b128 a[76:79], v11 offset:4096
  s_waitcnt lgkmcnt(4)
  v_mfma_f32_16x16x32_bf16 v[88:91], v[148:151], a[48:51], v[88:91]
  v_mfma_f32_16x16x32_bf16 v[92:95], v[148:151], a[52:55], v[92:95]
  v_fmac_f32 v76, v32, v17
  v_mfma_f32_16x16x32_bf16 v[96:99], v[148:151], a[56:59], v[96:99]
  v_fmac_f32 v77, v33, v17
  v_fmac_f32 v78, v34, v17
  v_mfma_f32_16x16x32_bf16 v[100:103], v[148:151], a[60:63], v[100:103]
  buffer_load_dwordx4 v[148:151], v1, s[8:11], s20 offen offset:3072
  ds_read_b128 a[80:83], v8 offset:5120
  ds_read_b128 a[84:87], v9 offset:5120
  ds_read_b128 a[88:91], v10 offset:5120
  ds_read_b128 a[92:95], v11 offset:5120
  s_waitcnt vmcnt(20)
  s_waitcnt lgkmcnt(4)
  v_mfma_f32_16x16x32_bf16 v[88:91], v[152:155], a[64:67], v[88:91]
  v_mfma_f32_16x16x32_bf16 v[92:95], v[152:155], a[68:71], v[92:95]
  v_fmac_f32 v79, v35, v17
  v_mfma_f32_16x16x32_bf16 v[96:99], v[152:155], a[72:75], v[96:99]
  v_mul_f32 v40, v72, v20
  v_mul_f32 v41, v73, v20
  v_mfma_f32_16x16x32_bf16 v[100:103], v[152:155], a[76:79], v[100:103]
  s_add_u32 s20, s20, 4096
  buffer_load_dwordx4 v[152:155], v1, s[8:11], s20 offen offset:0
  ds_read_b128 a[96:99], v8 offset:6144
  ds_read_b128 a[100:103], v9 offset:6144
  ds_read_b128 a[104:107], v10 offset:6144
  ds_read_b128 a[108:111], v11 offset:6144
  s_waitcnt lgkmcnt(4)
  v_mfma_f32_16x16x32_bf16 v[88:91], v[156:159], a[80:83], v[88:91]
  v_mfma_f32_16x16x32_bf16 v[92:95], v[156:159], a[84:87], v[92:95]
  v_mfma_f32_16x16x32_bf16 v[96:99], v[156:159], a[88:91], v[96:99]
  v_mul_f32 v42, v74, v20
  v_mul_f32 v43, v75, v20
  v_mfma_f32_16x16x32_bf16 v[100:103], v[156:159], a[92:95], v[100:103]
  buffer_load_dwordx4 v[156:159], v1, s[8:11], s20 offen offset:1024
  ds_read_b128 a[112:115], v8 offset:7168
  ds_read_b128 a[116:119], v9 offset:7168
  ds_read_b128 a[120:123], v10 offset:7168
  ds_read_b128 a[124:127], v11 offset:7168
  s_waitcnt vmcnt(20)
  s_waitcnt lgkmcnt(4)
  v_mfma_f32_16x16x32_bf16 v[88:91], v[160:163], a[96:99], v[88:91]
  v_mfma_f32_16x16x32_bf16 v[92:95], v[160:163], a[100:103], v[92:95]
  v_mul_f32 v44, v76, v21
  v_mfma_f32_16x16x32_bf16 v[96:99], v[160:163], a[104:107], v[96:99]
  v_mul_f32 v45, v77, v21
  v_mul_f32 v46, v78, v21
  v_mfma_f32_16x16x32_bf16 v[100:103], v[160:163], a[108:111], v[100:103]
  buffer_load_dwordx4 v[160:163], v1, s[8:11], s20 offen offset:2048
  ds_read_b128 a[128:131], v8 offset:8192
  ds_read_b128 a[132:135], v9 offset:8192
  ds_read_b128 a[136:139], v10 offset:8192
  ds_read_b128 a[140:143], v11 offset:8192
  s_waitcnt lgkmcnt(4)
  v_mfma_f32_16x16x32_bf16 v[88:91], v[164:167], a[112:115], v[88:91]
  v_mfma_f32_16x16x32_bf16 v[92:95], v[164:167], a[116:119], v[92:95]
  v_mul_f32 v47, v79, v21
  v_mfma_f32_16x16x32_bf16 v[96:99], v[164:167], a[120:123], v[96:99]
  v_exp_f32 v40, v40
  v_mfma_f32_16x16x32_bf16 v[100:103], v[164:167], a[124:127], v[100:103]
  buffer_load_dwordx4 v[164:167], v1, s[8:11], s20 offen offset:3072
  ds_read_b128 a[144:147], v8 offset:9216
  ds_read_b128 a[148:151], v9 offset:9216
  ds_read_b128 a[152:155], v10 offset:9216
  ds_read_b128 a[156:159], v11 offset:9216
  s_waitcnt vmcnt(20)
  s_waitcnt lgkmcnt(4)
  v_mfma_f32_16x16x32_bf16 v[88:91], v[168:171], a[128:131], v[88:91]
  v_mfma_f32_16x16x32_bf16 v[92:95], v[168:171], a[132:135], v[92:95]
  v_exp_f32 v41, v41
  v_mfma_f32_16x16x32_bf16 v[96:99], v[168:171], a[136:139], v[96:99]
  v_exp_f32 v42, v42
  v_mfma_f32_16x16x32_bf16 v[100:103], v[168:171], a[140:143], v[100:103]
  s_add_u32 s20, s20, 4096
  buffer_load_dwordx4 v[168:171], v1, s[8:11], s20 offen offset:0
  ds_read_b128 a[160:163], v8 offset:10240
  ds_read_b128 a[164:167], v9 offset:10240
  ds_read_b128 a[168:171], v10 offset:10240
  ds_read_b128 a[172:175], v11 offset:10240
  s_waitcnt lgkmcnt(4)
  v_mfma_f32_16x16x32_bf16 v[88:91], v[172:175], a[144:147], v[88:91]
  v_mfma_f32_16x16x32_bf16 v[92:95], v[172:175], a[148:151], v[92:95]
  v_mfma_f32_16x16x32_bf16 v[96:99], v[172:175], a[152:155], v[96:99]
  v_exp_f32 v43, v43
  v_mfma_f32_16x16x32_bf16 v[100:103], v[172:175], a[156:159], v[100:103]
  buffer_load_dwordx4 v[172:175], v1, s[8:11], s20 offen offset:1024
  ds_read_b128 a[176:179], v8 offset:11264
  ds_read_b128 a[180:183], v9 offset:11264
  ds_read_b128 a[184:187], v10 offset:11264
  ds_read_b128 a[188:191], v11 offset:11264
  s_waitcnt vmcnt(20)
  s_waitcnt lgkmcnt(4)
  v_mfma_f32_16x16x32_bf16 v[88:91], v[176:179], a[160:163], v[88:91]
  v_mfma_f32_16x16x32_bf16 v[92:95], v[176:179], a[164:167], v[92:95]
  v_exp_f32 v44, v44
  v_mfma_f32_16x16x32_bf16 v[96:99], v[176:179], a[168:171], v[96:99]
  v_exp_f32 v45, v45
  v_mfma_f32_16x16x32_bf16 v[100:103], v[176:179], a[172:175], v[100:103]
  buffer_load_dwordx4 v[176:179], v1, s[8:11], s20 offen offset:2048
  ds_read_b128 a[192:195], v8 offset:12288
  ds_read_b128 a[196:199], v9 offset:12288
  ds_read_b128 a[200:203], v10 offset:12288
  ds_read_b128 a[204:207], v11 offset:12288
  s_waitcnt lgkmcnt(4)
  v_mfma_f32_16x16x32_bf16 v[88:91], v[180:183], a[176:179], v[88:91]
  v_mfma_f32_16x16x32_bf16 v[92:95], v[180:183], a[180:183], v[92:95]
  v_mfma_f32_16x16x32_bf16 v[96:99], v[180:183], a[184:187], v[96:99]
  v_exp_f32 v46, v46
  v_mfma_f32_16x16x32_bf16 v[100:103], v[180:183], a[188:191], v[100:103]
  buffer_load_dwordx4 v[180:183], v1, s[8:11], s20 offen offset:3072
  ds_read_b128 a[208:211], v8 offset:13312
  ds_read_b128 a[212:215], v9 offset:13312
  ds_read_b128 a[216:219], v10 offset:13312
  ds_read_b128 a[220:223], v11 offset:13312
  s_waitcnt vmcnt(20)
  s_waitcnt lgkmcnt(4)
  v_mfma_f32_16x16x32_bf16 v[88:91], v[184:187], a[192:195], v[88:91]
  v_mfma_f32_16x16x32_bf16 v[92:95], v[184:187], a[196:199], v[92:95]
  v_exp_f32 v47, v47
  v_mfma_f32_16x16x32_bf16 v[96:99], v[184:187], a[200:203], v[96:99]
  v_add_f32 v40, 1.0, v40
  v_mfma_f32_16x16x32_bf16 v[100:103], v[184:187], a[204:207], v[100:103]
  s_add_u32 s20, s20, 4096
  buffer_load_dwordx4 v[184:187], v1, s[8:11], s20 offen offset:0
  ds_read_b128 a[224:227], v8 offset:14336
  ds_read_b128 a[228:231], v9 offset:14336
  ds_read_b128 a[232:235], v10 offset:14336
  ds_read_b128 a[236:239], v11 offset:14336
  s_waitcnt lgkmcnt(4)
  v_mfma_f32_16x16x32_bf16 v[88:91], v[188:191], a[208:211], v[88:91]
  v_mfma_f32_16x16x32_bf16 v[92:95], v[188:191], a[212:215], v[92:95]
  v_mfma_f32_16x16x32_bf16 v[96:99], v[188:191], a[216:219], v[96:99]
  v_add_f32 v41, 1.0, v41
  v_add_f32 v42, 1.0, v42
  v_mfma_f32_16x16x32_bf16 v[100:103], v[188:191], a[220:223], v[100:103]
  buffer_load_dwordx4 v[188:191], v1, s[8:11], s20 offen offset:1024
  ds_read_b128 a[240:243], v8 offset:15360
  ds_read_b128 a[244:247], v9 offset:15360
  ds_read_b128 a[248:251], v10 offset:15360
  ds_read_b128 a[252:255], v11 offset:15360
  s_waitcnt vmcnt(20)
  s_waitcnt lgkmcnt(4)
  v_mfma_f32_16x16x32_bf16 v[88:91], v[104:107], a[224:227], v[88:91]
  v_mfma_f32_16x16x32_bf16 v[92:95], v[104:107], a[228:231], v[92:95]
  v_add_f32 v43, 1.0, v43
  v_mfma_f32_16x16x32_bf16 v[96:99], v[104:107], a[232:235], v[96:99]
  v_add_f32 v44, 1.0, v44
  v_add_f32 v45, 1.0, v45
  v_mfma_f32_16x16x32_bf16 v[100:103], v[104:107], a[236:239], v[100:103]
  buffer_load_dwordx4 v[104:107], v1, s[8:11], s20 offen offset:2048
  v_add_f32 v46, 1.0, v46
  v_add_f32 v47, 1.0, v47
  v_rcp_f32 v40, v40
  v_rcp_f32 v41, v41
  v_rcp_f32 v42, v42
  v_rcp_f32 v43, v43
  v_rcp_f32 v44, v44
  v_rcp_f32 v45, v45
  v_rcp_f32 v46, v46
  v_rcp_f32 v47, v47
  v_mul_f32 v72, v72, v40
  v_mul_f32 v73, v73, v41
  v_mul_f32 v74, v74, v42
  v_mul_f32 v75, v75, v43
  v_mul_f32 v76, v76, v44
  v_mul_f32 v77, v77, v45
  v_mul_f32 v78, v78, v46
  v_mul_f32 v79, v79, v47
  v_cvt_pk_bf16_f32 v56, v72, v73
  v_cvt_pk_bf16_f32 v57, v74, v75
  v_cvt_pk_bf16_f32 v58, v76, v77
  v_cvt_pk_bf16_f32 v59, v78, v79
  ds_write_b64 v12, v[56:57] offset:16384
  ds_write_b64 v13, v[58:59] offset:16384
  v_fmac_f32 v80, v32, v18
  v_fmac_f32 v81, v33, v18
  v_fmac_f32 v82, v34, v18
  v_fmac_f32 v83, v35, v18
  v_fmac_f32 v84, v32, v19
  v_fmac_f32 v85, v33, v19
  v_fmac_f32 v86, v34, v19
  v_fmac_f32 v87, v35, v19
  v_mul_f32 v48, v80, v22
  v_mul_f32 v49, v81, v22
  v_mul_f32 v50, v82, v22
  v_mul_f32 v51, v83, v22
  v_mul_f32 v52, v84, v23
  v_mul_f32 v53, v85, v23
  v_mul_f32 v54, v86, v23
  v_mul_f32 v55, v87, v23
  v_exp_f32 v48, v48
  v_exp_f32 v49, v49
  v_exp_f32 v50, v50
  v_exp_f32 v51, v51
  v_exp_f32 v52, v52
  v_exp_f32 v53, v53
  v_exp_f32 v54, v54
  v_exp_f32 v55, v55
  v_add_f32 v48, 1.0, v48
  v_add_f32 v49, 1.0, v49
  v_add_f32 v50, 1.0, v50
  v_add_f32 v51, 1.0, v51
  v_add_f32 v52, 1.0, v52
  v_add_f32 v53, 1.0, v53
  v_add_f32 v54, 1.0, v54
  v_add_f32 v55, 1.0, v55
  v_rcp_f32 v48, v48
  v_rcp_f32 v49, v49
  v_rcp_f32 v50, v50
  v_rcp_f32 v51, v51
  v_rcp_f32 v52, v52
  v_rcp_f32 v53, v53
  v_rcp_f32 v54, v54
  v_rcp_f32 v55, v55
  v_mul_f32 v80, v80, v48
  v_mul_f32 v81, v81, v49
  v_mul_f32 v82, v82, v50
  v_mul_f32 v83, v83, v51
  v_mul_f32 v84, v84, v52
  v_mul_f32 v85, v85, v53
  v_mul_f32 v86, v86, v54
  v_mul_f32 v87, v87, v55
  v_cvt_pk_bf16_f32 v60, v80, v81
  v_cvt_pk_bf16_f32 v61, v82, v83
  v_cvt_pk_bf16_f32 v62, v84, v85
  v_cvt_pk_bf16_f32 v63, v86, v87
  ds_write_b64 v14, v[60:61] offset:16384
  ds_write_b64 v15, v[62:63] offset:16384
  s_waitcnt lgkmcnt(0)
  s_barrier
  ds_read_b128 v[192:195], v8 offset:16384
  ds_read_b128 v[196:199], v9 offset:16384
  ds_read_b128 v[200:203], v10 offset:16384
  ds_read_b128 v[204:207], v11 offset:16384
  v_mfma_f32_16x16x32_bf16 v[88:91], v[108:111], a[240:243], v[88:91]
  v_mfma_f32_16x16x32_bf16 v[92:95], v[108:111], a[244:247], v[92:95]
  v_mfma_f32_16x16x32_bf16 v[96:99], v[108:111], a[248:251], v[96:99]
  v_mfma_f32_16x16x32_bf16 v[100:103], v[108:111], a[252:255], v[100:103]
  buffer_load_dwordx4 v[108:111], v1, s[8:11], s20 offen offset:3072
  ds_read_b128 v[208:211], v8 offset:17408
  ds_read_b128 v[212:215], v9 offset:17408
  ds_read_b128 v[216:219], v10 offset:17408
  ds_read_b128 v[220:223], v11 offset:17408
  s_waitcnt vmcnt(20)
  s_waitcnt lgkmcnt(4)
  v_mfma_f32_16x16x32_bf16 v[88:91], v[112:115], v[192:195], v[88:91]
  v_mfma_f32_16x16x32_bf16 v[92:95], v[112:115], v[196:199], v[92:95]
  v_mfma_f32_16x16x32_bf16 v[96:99], v[112:115], v[200:203], v[96:99]
  v_mfma_f32_16x16x32_bf16 v[100:103], v[112:115], v[204:207], v[100:103]
  s_add_u32 s20, s20, 4096
  buffer_load_dwordx4 v[112:115], v1, s[8:11], s20 offen offset:0
  s_waitcnt lgkmcnt(0)
  v_mfma_f32_16x16x32_bf16 v[88:91], v[116:119], v[208:211], v[88:91]
  v_mfma_f32_16x16x32_bf16 v[92:95], v[116:119], v[212:215], v[92:95]
  v_mfma_f32_16x16x32_bf16 v[96:99], v[116:119], v[216:219], v[96:99]
  v_mfma_f32_16x16x32_bf16 v[100:103], v[116:119], v[220:223], v[100:103]
  buffer_load_dwordx4 v[116:119], v1, s[8:11], s20 offen offset:1024
  s_waitcnt vmcnt(20)
  v_mfma_f32_16x16x32_bf16 v[72:75], v[120:123], a[0:3], 0
  v_mfma_f32_16x16x32_bf16 v[76:79], v[120:123], a[4:7], 0
  v_mfma_f32_16x16x32_bf16 v[80:83], v[120:123], a[8:11], 0
  v_mfma_f32_16x16x32_bf16 v[84:87], v[120:123], a[12:15], 0
  buffer_load_dwordx4 v[32:35], v1, s[8:11], s20 offen offset:2048
  buffer_load_dwordx4 v[36:39], v1, s[8:11], s20 offen offset:3072
  v_mfma_f32_16x16x32_bf16 v[72:75], v[124:127], a[16:19], v[72:75]
  v_mfma_f32_16x16x32_bf16 v[76:79], v[124:127], a[20:23], v[76:79]
  v_mfma_f32_16x16x32_bf16 v[80:83], v[124:127], a[24:27], v[80:83]
  v_mul_f32 v88, v88, v24
  v_mul_f32 v89, v89, v24
  v_mfma_f32_16x16x32_bf16 v[84:87], v[124:127], a[28:31], v[84:87]
  s_add_u32 s20, s20, 4096
  buffer_load_dwordx4 v[224:227], v1, s[8:11], s20 offen offset:0
  buffer_load_dwordx4 v[228:231], v1, s[8:11], s20 offen offset:1024
  s_waitcnt vmcnt(22)
  v_mfma_f32_16x16x32_bf16 v[72:75], v[128:131], a[32:35], v[72:75]
  v_mul_f32 v90, v90, v24
  v_mfma_f32_16x16x32_bf16 v[76:79], v[128:131], a[36:39], v[76:79]
  v_mul_f32 v91, v91, v24
  v_mul_f32 v92, v92, v25
  v_mfma_f32_16x16x32_bf16 v[80:83], v[128:131], a[40:43], v[80:83]
  v_mul_f32 v93, v93, v25
  v_mul_f32 v94, v94, v25
  v_mfma_f32_16x16x32_bf16 v[84:87], v[128:131], a[44:47], v[84:87]
  buffer_load_dwordx4 v[232:235], v1, s[8:11], s20 offen offset:2048
  buffer_load_dwordx4 v[236:239], v1, s[8:11], s20 offen offset:3072
  v_mfma_f32_16x16x32_bf16 v[72:75], v[132:135], a[48:51], v[72:75]
  v_mul_f32 v95, v95, v25
  v_mul_f32 v96, v96, v26
  v_mfma_f32_16x16x32_bf16 v[76:79], v[132:135], a[52:55], v[76:79]
  v_mul_f32 v97, v97, v26
  v_mul_f32 v98, v98, v26
  v_mfma_f32_16x16x32_bf16 v[80:83], v[132:135], a[56:59], v[80:83]
  v_mul_f32 v99, v99, v26
  v_mul_f32 v100, v100, v27
  v_mfma_f32_16x16x32_bf16 v[84:87], v[132:135], a[60:63], v[84:87]
  s_add_u32 s20, s20, 4096
  buffer_load_dwordx4 v[120:123], v1, s[8:11], s20 offen offset:0
  buffer_load_dwordx4 v[124:127], v1, s[8:11], s20 offen offset:1024
  s_waitcnt vmcnt(24)
  v_mfma_f32_16x16x32_bf16 v[72:75], v[136:139], a[64:67], v[72:75]
  v_mul_f32 v101, v101, v27
  v_mfma_f32_16x16x32_bf16 v[76:79], v[136:139], a[68:71], v[76:79]
  v_mul_f32 v102, v102, v27
  v_mul_f32 v103, v103, v27
  v_mfma_f32_16x16x32_bf16 v[80:83], v[136:139], a[72:75], v[80:83]
  v_cvt_pk_bf16_f32 v56, v88, v89
  v_cvt_pk_bf16_f32 v57, v90, v91
  v_mfma_f32_16x16x32_bf16 v[84:87], v[136:139], a[76:79], v[84:87]
  buffer_load_dwordx4 v[128:131], v1, s[8:11], s20 offen offset:2048
  buffer_load_dwordx4 v[132:135], v1, s[8:11], s20 offen offset:3072
  v_mfma_f32_16x16x32_bf16 v[72:75], v[140:143], a[80:83], v[72:75]
  v_cvt_pk_bf16_f32 v60, v92, v93
  v_cvt_pk_bf16_f32 v61, v94, v95
  v_mfma_f32_16x16x32_bf16 v[76:79], v[140:143], a[84:87], v[76:79]
  v_cvt_pk_bf16_f32 v64, v96, v97
  v_cvt_pk_bf16_f32 v65, v98, v99
  v_mfma_f32_16x16x32_bf16 v[80:83], v[140:143], a[88:91], v[80:83]
  v_cvt_pk_bf16_f32 v68, v100, v101
  v_cvt_pk_bf16_f32 v69, v102, v103
  v_mfma_f32_16x16x32_bf16 v[84:87], v[140:143], a[92:95], v[84:87]
  s_add_u32 s20, s20, 4096
  buffer_load_dwordx4 v[136:139], v1, s[8:11], s20 offen offset:0
  buffer_load_dwordx4 v[140:143], v1, s[8:11], s20 offen offset:1024
  s_waitcnt vmcnt(26)
  v_mfma_f32_16x16x32_bf16 v[72:75], v[144:147], a[96:99], v[72:75]
  v_mfma_f32_16x16x32_bf16 v[76:79], v[144:147], a[100:103], v[76:79]
  v_mfma_f32_16x16x32_bf16 v[80:83], v[144:147], a[104:107], v[80:83]
  v_mfma_f32_16x16x32_bf16 v[84:87], v[144:147], a[108:111], v[84:87]
  buffer_load_dwordx4 v[144:147], v1, s[8:11], s20 offen offset:2048
  v_mfma_f32_16x16x32_bf16 v[72:75], v[148:151], a[112:115], v[72:75]
  v_mfma_f32_16x16x32_bf16 v[76:79], v[148:151], a[116:119], v[76:79]
  v_mfma_f32_16x16x32_bf16 v[80:83], v[148:151], a[120:123], v[80:83]
  v_mfma_f32_16x16x32_bf16 v[84:87], v[148:151], a[124:127], v[84:87]
  buffer_load_dwordx4 v[148:151], v1, s[8:11], s20 offen offset:3072
  s_waitcnt vmcnt(26)
  v_mfma_f32_16x16x32_bf16 v[72:75], v[152:155], a[128:131], v[72:75]
  v_mfma_f32_16x16x32_bf16 v[76:79], v[152:155], a[132:135], v[76:79]
  v_mfma_f32_16x16x32_bf16 v[80:83], v[152:155], a[136:139], v[80:83]
  v_mfma_f32_16x16x32_bf16 v[84:87], v[152:155], a[140:143], v[84:87]
  s_add_u32 s20, s20, 4096
  buffer_load_dwordx4 v[152:155], v1, s[8:11], s20 offen offset:0
  v_mfma_f32_16x16x32_bf16 v[72:75], v[156:159], a[144:147], v[72:75]
  v_mfma_f32_16x16x32_bf16 v[76:79], v[156:159], a[148:151], v[76:79]
  v_mfma_f32_16x16x32_bf16 v[80:83], v[156:159], a[152:155], v[80:83]
  v_mfma_f32_16x16x32_bf16 v[84:87], v[156:159], a[156:159], v[84:87]
  buffer_load_dwordx4 v[156:159], v1, s[8:11], s20 offen offset:1024
  s_waitcnt vmcnt(26)
  v_mfma_f32_16x16x32_bf16 v[72:75], v[160:163], a[160:163], v[72:75]
  v_mfma_f32_16x16x32_bf16 v[76:79], v[160:163], a[164:167], v[76:79]
  v_mfma_f32_16x16x32_bf16 v[80:83], v[160:163], a[168:171], v[80:83]
  v_mfma_f32_16x16x32_bf16 v[84:87], v[160:163], a[172:175], v[84:87]
  buffer_load_dwordx4 v[160:163], v1, s[8:11], s20 offen offset:2048
  v_mfma_f32_16x16x32_bf16 v[72:75], v[164:167], a[176:179], v[72:75]
  v_mfma_f32_16x16x32_bf16 v[76:79], v[164:167], a[180:183], v[76:79]
  v_mfma_f32_16x16x32_bf16 v[80:83], v[164:167], a[184:187], v[80:83]
  v_mfma_f32_16x16x32_bf16 v[84:87], v[164:167], a[188:191], v[84:87]
  buffer_load_dwordx4 v[164:167], v1, s[8:11], s20 offen offset:3072
  s_waitcnt vmcnt(26)
  v_mfma_f32_16x16x32_bf16 v[72:75], v[168:171], a[192:195], v[72:75]
  v_mfma_f32_16x16x32_bf16 v[76:79], v[168:171], a[196:199], v[76:79]
  v_mfma_f32_16x16x32_bf16 v[80:83], v[168:171], a[200:203], v[80:83]
  v_mfma_f32_16x16x32_bf16 v[84:87], v[168:171], a[204:207], v[84:87]
  s_add_u32 s20, s20, 4096
  buffer_load_dwordx4 v[168:171], v1, s[8:11], s20 offen offset:0
  v_mfma_f32_16x16x32_bf16 v[72:75], v[172:175], a[208:211], v[72:75]
  v_mfma_f32_16x16x32_bf16 v[76:79], v[172:175], a[212:215], v[76:79]
  v_mfma_f32_16x16x32_bf16 v[80:83], v[172:175], a[216:219], v[80:83]
  v_mfma_f32_16x16x32_bf16 v[84:87], v[172:175], a[220:223], v[84:87]
  buffer_load_dwordx4 v[172:175], v1, s[8:11], s20 offen offset:1024
  s_waitcnt vmcnt(26)
  v_mfma_f32_16x16x32_bf16 v[72:75], v[176:179], a[224:227], v[72:75]
  v_mfma_f32_16x16x32_bf16 v[76:79], v[176:179], a[228:231], v[76:79]
  v_mfma_f32_16x16x32_bf16 v[80:83], v[176:179], a[232:235], v[80:83]
  v_mfma_f32_16x16x32_bf16 v[84:87], v[176:179], a[236:239], v[84:87]
  buffer_load_dwordx4 v[176:179], v1, s[8:11], s20 offen offset:2048
  v_mfma_f32_16x16x32_bf16 v[72:75], v[180:183], a[240:243], v[72:75]
  v_mfma_f32_16x16x32_bf16 v[76:79], v[180:183], a[244:247], v[76:79]
  v_mfma_f32_16x16x32_bf16 v[80:83], v[180:183], a[248:251], v[80:83]
  v_mfma_f32_16x16x32_bf16 v[84:87], v[180:183], a[252:255], v[84:87]
  buffer_load_dwordx4 v[180:183], v1, s[8:11], s20 offen offset:3072
  s_waitcnt vmcnt(26)
  v_mfma_f32_16x16x32_bf16 v[72:75], v[184:187], v[192:195], v[72:75]
  v_mfma_f32_16x16x32_bf16 v[76:79], v[184:187], v[196:199], v[76:79]
  v_mfma_f32_16x16x32_bf16 v[80:83], v[184:187], v[200:203], v[80:83]
  v_mfma_f32_16x16x32_bf16 v[84:87], v[184:187], v[204:207], v[84:87]
  s_add_u32 s20, s20, 4096
  buffer_load_dwordx4 v[184:187], v1, s[8:11], s20 offen offset:0
  v_mfma_f32_16x16x32_bf16 v[72:75], v[188:191], v[208:211], v[72:75]
  v_mfma_f32_16x16x32_bf16 v[76:79], v[188:191], v[212:215], v[76:79]
  v_mfma_f32_16x16x32_bf16 v[80:83], v[188:191], v[216:219], v[80:83]
  v_mfma_f32_16x16x32_bf16 v[84:87], v[188:191], v[220:223], v[84:87]
  buffer_load_dwordx4 v[188:191], v1, s[8:11], s20 offen offset:1024
  s_waitcnt vmcnt(26)
  v_mfma_f32_16x16x32_bf16 v[88:91], v[104:107], a[0:3], 0
  v_mfma_f32_16x16x32_bf16 v[92:95], v[104:107], a[4:7], 0
  v_mfma_f32_16x16x32_bf16 v[96:99], v[104:107], a[8:11], 0
  v_mfma_f32_16x16x32_bf16 v[100:103], v[104:107], a[12:15], 0
  buffer_load_dwordx4 v[104:107], v1, s[8:11], s20 offen offset:2048
  v_mfma_f32_16x16x32_bf16 v[88:91], v[108:111], a[16:19], v[88:91]
  v_mfma_f32_16x16x32_bf16 v[92:95], v[108:111], a[20:23], v[92:95]
  v_mfma_f32_16x16x32_bf16 v[96:99], v[108:111], a[24:27], v[96:99]
  v_mul_f32 v72, v72, v24
  v_mul_f32 v73, v73, v24
  v_mfma_f32_16x16x32_bf16 v[100:103], v[108:111], a[28:31], v[100:103]
  buffer_load_dwordx4 v[108:111], v1, s[8:11], s20 offen offset:3072
  v_mul_f32 v74, v74, v24
  s_waitcnt vmcnt(26)
  v_mfma_f32_16x16x32_bf16 v[88:91], v[112:115], a[32:35], v[88:91]
  v_mul_f32 v75, v75, v24
  v_mul_f32 v76, v76, v25
  v_mfma_f32_16x16x32_bf16 v[92:95], v[112:115], a[36:39], v[92:95]
  v_mul_f32 v77, v77, v25
  v_mul_f32 v78, v78, v25
  v_mfma_f32_16x16x32_bf16 v[96:99], v[112:115], a[40:43], v[96:99]
  v_mul_f32 v79, v79, v25
  v_mul_f32 v80, v80, v26
  v_mfma_f32_16x16x32_bf16 v[100:103], v[112:115], a[44:47], v[100:103]
  s_add_u32 s20, s20, 4096
  buffer_load_dwordx4 v[112:115], v1, s[8:11], s20 offen offset:0
  v_mfma_f32_16x16x32_bf16 v[88:91], v[116:119], a[48:51], v[88:91]
  v_mul_f32 v81, v81, v26
  v_mul_f32 v82, v82, v26
  v_mfma_f32_16x16x32_bf16 v[92:95], v[116:119], a[52:55], v[92:95]
  v_mul_f32 v83, v83, v26
  v_mul_f32 v84, v84, v27
  v_mfma_f32_16x16x32_bf16 v[96:99], v[116:119], a[56:59], v[96:99]
  v_mul_f32 v85, v85, v27
  v_mul_f32 v86, v86, v27
  v_mfma_f32_16x16x32_bf16 v[100:103], v[116:119], a[60:63], v[100:103]
  buffer_load_dwordx4 v[116:119], v1, s[8:11], s20 offen offset:1024
  v_mul_f32 v87, v87, v27
  s_waitcnt vmcnt(26)
  v_mfma_f32_16x16x32_bf16 v[88:91], v[32:35], a[64:67], v[88:91]
  v_cvt_pk_bf16_f32 v58, v72, v73
  v_cvt_pk_bf16_f32 v59, v74, v75
  v_mfma_f32_16x16x32_bf16 v[92:95], v[32:35], a[68:71], v[92:95]
  v_cvt_pk_bf16_f32 v62, v76, v77
  v_cvt_pk_bf16_f32 v63, v78, v79
  v_mfma_f32_16x16x32_bf16 v[96:99], v[32:35], a[72:75], v[96:99]
  v_cvt_pk_bf16_f32 v66, v80, v81
  v_cvt_pk_bf16_f32 v67, v82, v83
  v_mfma_f32_16x16x32_bf16 v[100:103], v[32:35], a[76:79], v[100:103]
  buffer_load_dwordx4 v[32:35], v1, s[8:11], s20 offen offset:2048
  v_cvt_pk_bf16_f32 v70, v84, v85
  v_mfma_f32_16x16x32_bf16 v[88:91], v[36:39], a[80:83], v[88:91]
  v_cvt_pk_bf16_f32 v71, v86, v87
  v_mfma_f32_16x16x32_bf16 v[92:95], v[36:39], a[84:87], v[92:95]
  v_mfma_f32_16x16x32_bf16 v[96:99], v[36:39], a[88:91], v[96:99]
  v_mfma_f32_16x16x32_bf16 v[100:103], v[36:39], a[92:95], v[100:103]
  buffer_load_dwordx4 v[36:39], v1, s[8:11], s20 offen offset:3072
  s_waitcnt vmcnt(26)
  v_mfma_f32_16x16x32_bf16 v[88:91], v[224:227], a[96:99], v[88:91]
  v_mfma_f32_16x16x32_bf16 v[92:95], v[224:227], a[100:103], v[92:95]
  v_mfma_f32_16x16x32_bf16 v[96:99], v[224:227], a[104:107], v[96:99]
  v_mfma_f32_16x16x32_bf16 v[100:103], v[224:227], a[108:111], v[100:103]
  s_add_u32 s20, s20, 4096
  buffer_load_dwordx4 v[224:227], v1, s[8:11], s20 offen offset:0
  v_mfma_f32_16x16x32_bf16 v[88:91], v[228:231], a[112:115], v[88:91]
  v_mfma_f32_16x16x32_bf16 v[92:95], v[228:231], a[116:119], v[92:95]
  v_mfma_f32_16x16x32_bf16 v[96:99], v[228:231], a[120:123], v[96:99]
  v_mfma_f32_16x16x32_bf16 v[100:103], v[228:231], a[124:127], v[100:103]
  buffer_load_dwordx4 v[228:231], v1, s[8:11], s20 offen offset:1024
  s_waitcnt vmcnt(26)
  v_mfma_f32_16x16x32_bf16 v[88:91], v[232:235], a[128:131], v[88:91]
  v_mfma_f32_16x16x32_bf16 v[92:95], v[232:235], a[132:135], v[92:95]
  v_mfma_f32_16x16x32_bf16 v[96:99], v[232:235], a[136:139], v[96:99]
  v_mfma_f32_16x16x32_bf16 v[100:103], v[232:235], a[140:143], v[100:103]
  buffer_load_dwordx4 v[232:235], v1, s[8:11], s20 offen offset:2048
  s_add_u32 s31, s28, 0
  buffer_store_dwordx4 v[56:59], v1, s[44:47], s31 offen sc1
  v_mfma_f32_16x16x32_bf16 v[88:91], v[236:239], a[144:147], v[88:91]
  v_mfma_f32_16x16x32_bf16 v[92:95], v[236:239], a[148:151], v[92:95]
  v_mfma_f32_16x16x32_bf16 v[96:99], v[236:239], a[152:155], v[96:99]
  v_mfma_f32_16x16x32_bf16 v[100:103], v[236:239], a[156:159], v[100:103]
  buffer_load_dwordx4 v[236:239], v1, s[8:11], s20 offen offset:3072
  s_waitcnt vmcnt(27)
  v_mfma_f32_16x16x32_bf16 v[88:91], v[120:123], a[160:163], v[88:91]
  v_mfma_f32_16x16x32_bf16 v[92:95], v[120:123], a[164:167], v[92:95]
  v_mfma_f32_16x16x32_bf16 v[96:99], v[120:123], a[168:171], v[96:99]
  v_mfma_f32_16x16x32_bf16 v[100:103], v[120:123], a[172:175], v[100:103]
  s_add_u32 s20, s20, 4096
  buffer_load_dwordx4 v[120:123], v1, s[8:11], s20 offen offset:0
  v_mfma_f32_16x16x32_bf16 v[88:91], v[124:127], a[176:179], v[88:91]
  v_mfma_f32_16x16x32_bf16 v[92:95], v[124:127], a[180:183], v[92:95]
  v_mfma_f32_16x16x32_bf16 v[96:99], v[124:127], a[184:187], v[96:99]
  v_mfma_f32_16x16x32_bf16 v[100:103], v[124:127], a[188:191], v[100:103]
  buffer_load_dwordx4 v[124:127], v1, s[8:11], s20 offen offset:1024
  s_waitcnt vmcnt(27)
  v_mfma_f32_16x16x32_bf16 v[88:91], v[128:131], a[192:195], v[88:91]
  v_mfma_f32_16x16x32_bf16 v[92:95], v[128:131], a[196:199], v[92:95]
  v_mfma_f32_16x16x32_bf16 v[96:99], v[128:131], a[200:203], v[96:99]
  v_mfma_f32_16x16x32_bf16 v[100:103], v[128:131], a[204:207], v[100:103]
  buffer_load_dwordx4 v[128:131], v1, s[8:11], s20 offen offset:2048
  v_mfma_f32_16x16x32_bf16 v[88:91], v[132:135], a[208:211], v[88:91]
  v_mfma_f32_16x16x32_bf16 v[92:95], v[132:135], a[212:215], v[92:95]
  v_mfma_f32_16x16x32_bf16 v[96:99], v[132:135], a[216:219], v[96:99]
  v_mfma_f32_16x16x32_bf16 v[100:103], v[132:135], a[220:223], v[100:103]
  buffer_load_dwordx4 v[132:135], v1, s[8:11], s20 offen offset:3072
  s_waitcnt vmcnt(27)
  v_mfma_f32_16x16x32_bf16 v[88:91], v[136:139], a[224:227], v[88:91]
  v_mfma_f32_16x16x32_bf16 v[92:95], v[136:139], a[228:231], v[92:95]
  v_mfma_f32_16x16x32_bf16 v[96:99], v[136:139], a[232:235], v[96:99]
  v_mfma_f32_16x16x32_bf16 v[100:103], v[136:139], a[236:239], v[100:103]
  s_add_u32 s20, s20, 4096
  buffer_load_dwordx4 v[136:139], v1, s[8:11], s20 offen offset:0
  s_add_u32 s31, s28, 18432
  buffer_store_dwordx4 v[60:63], v1, s[44:47], s31 offen sc1
  v_mfma_f32_16x16x32_bf16 v[88:91], v[140:143], a[240:243], v[88:91]
  v_mfma_f32_16x16x32_bf16 v[92:95], v[140:143], a[244:247], v[92:95]
  v_mfma_f32_16x16x32_bf16 v[96:99], v[140:143], a[248:251], v[96:99]
  v_mfma_f32_16x16x32_bf16 v[100:103], v[140:143], a[252:255], v[100:103]
  buffer_load_dwordx4 v[140:143], v1, s[8:11], s20 offen offset:1024
  s_waitcnt vmcnt(28)
  v_mfma_f32_16x16x32_bf16 v[88:91], v[144:147], v[192:195], v[88:91]
  v_mfma_f32_16x16x32_bf16 v[92:95], v[144:147], v[196:199], v[92:95]
  v_mfma_f32_16x16x32_bf16 v[96:99], v[144:147], v[200:203], v[96:99]
  v_mfma_f32_16x16x32_bf16 v[100:103], v[144:147], v[204:207], v[100:103]
  buffer_load_dwordx4 v[144:147], v1, s[8:11], s20 offen offset:2048
  v_mfma_f32_16x16x32_bf16 v[88:91], v[148:151], v[208:211], v[88:91]
  v_mfma_f32_16x16x32_bf16 v[92:95], v[148:151], v[212:215], v[92:95]
  v_mfma_f32_16x16x32_bf16 v[96:99], v[148:151], v[216:219], v[96:99]
  v_mfma_f32_16x16x32_bf16 v[100:103], v[148:151], v[220:223], v[100:103]
  buffer_load_dwordx4 v[148:151], v1, s[8:11], s20 offen offset:3072
  s_waitcnt vmcnt(28)
  v_mfma_f32_16x16x32_bf16 v[72:75], v[152:155], a[0:3], 0
  v_mfma_f32_16x16x32_bf16 v[76:79], v[152:155], a[4:7], 0
  v_mfma_f32_16x16x32_bf16 v[80:83], v[152:155], a[8:11], 0
  v_mfma_f32_16x16x32_bf16 v[84:87], v[152:155], a[12:15], 0
  s_add_u32 s20, s20, 4096
  buffer_load_dwordx4 v[152:155], v1, s[8:11], s20 offen offset:0
  v_mfma_f32_16x16x32_bf16 v[72:75], v[156:159], a[16:19], v[72:75]
  v_mfma_f32_16x16x32_bf16 v[76:79], v[156:159], a[20:23], v[76:79]
  v_mfma_f32_16x16x32_bf16 v[80:83], v[156:159], a[24:27], v[80:83]
  v_mul_f32 v88, v88, v24
  v_mul_f32 v89, v89, v24
  v_mfma_f32_16x16x32_bf16 v[84:87], v[156:159], a[28:31], v[84:87]
  buffer_load_dwordx4 v[156:159], v1, s[8:11], s20 offen offset:1024
  v_mul_f32 v90, v90, v24
  s_waitcnt vmcnt(28)
  v_mfma_f32_16x16x32_bf16 v[72:75], v[160:163], a[32:35], v[72:75]
  v_mul_f32 v91, v91, v24
  v_mul_f32 v92, v92, v25
  v_mfma_f32_16x16x32_bf16 v[76:79], v[160:163], a[36:39], v[76:79]
  v_mul_f32 v93, v93, v25
  v_mul_f32 v94, v94, v25
  v_mfma_f32_16x16x32_bf16 v[80:83], v[160:163], a[40:43], v[80:83]
  v_mul_f32 v95, v95, v25
  v_mul_f32 v96, v96, v26
  v_mfma_f32_16x16x32_bf16 v[84:87], v[160:163], a[44:47], v[84:87]
  buffer_load_dwordx4 v[160:163], v1, s[8:11], s20 offen offset:2048
  v_mul_f32 v97, v97, v26
  v_mfma_f32_16x16x32_bf16 v[72:75], v[164:167], a[48:51], v[72:75]
  v_mul_f32 v98, v98, v26
  v_mul_f32 v99, v99, v26
  v_mfma_f32_16x16x32_bf16 v[76:79], v[164:167], a[52:55], v[76:79]
  v_mul_f32 v100, v100, v27
  v_mul_f32 v101, v101, v27
  v_mfma_f32_16x16x32_bf16 v[80:83], v[164:167], a[56:59], v[80:83]
  v_mul_f32 v102, v102, v27
  v_mul_f32 v103, v103, v27
  v_mfma_f32_16x16x32_bf16 v[84:87], v[164:167], a[60:63], v[84:87]
  buffer_load_dwordx4 v[164:167], v1, s[8:11], s20 offen offset:3072
  s_add_u32 s31, s28, 36864
  buffer_store_dwordx4 v[64:67], v1, s[44:47], s31 offen sc1
  s_waitcnt vmcnt(29)
  v_mfma_f32_16x16x32_bf16 v[72:75], v[168:171], a[64:67], v[72:75]
  v_cvt_pk_bf16_f32 v40, v88, v89
  v_mfma_f32_16x16x32_bf16 v[76:79], v[168:171], a[68:71], v[76:79]
  v_cvt_pk_bf16_f32 v41, v90, v91
  v_cvt_pk_bf16_f32 v44, v92, v93
  v_mfma_f32_16x16x32_bf16 v[80:83], v[168:171], a[72:75], v[80:83]
  v_cvt_pk_bf16_f32 v45, v94, v95
  v_cvt_pk_bf16_f32 v48, v96, v97
  v_mfma_f32_16x16x32_bf16 v[84:87], v[168:171], a[76:79], v[84:87]
  s_add_u32 s20, s20, 4096
  buffer_load_dwordx4 v[168:171], v1, s[8:11], s20 offen offset:0
  v_mfma_f32_16x16x32_bf16 v[72:75], v[172:175], a[80:83], v[72:75]
  v_cvt_pk_bf16_f32 v49, v98, v99
  v_cvt_pk_bf16_f32 v52, v100, v101
  v_mfma_f32_16x16x32_bf16 v[76:79], v[172:175], a[84:87], v[76:79]
  v_cvt_pk_bf16_f32 v53, v102, v103
  v_mfma_f32_16x16x32_bf16 v[80:83], v[172:175], a[88:91], v[80:83]
  v_mfma_f32_16x16x32_bf16 v[84:87], v[172:175], a[92:95], v[84:87]
  buffer_load_dwordx4 v[172:175], v1, s[8:11], s20 offen offset:1024
  s_waitcnt vmcnt(29)
  v_mfma_f32_16x16x32_bf16 v[72:75], v[176:179], a[96:99], v[72:75]
  v_mfma_f32_16x16x32_bf16 v[76:79], v[176:179], a[100:103], v[76:79]
  v_mfma_f32_16x16x32_bf16 v[80:83], v[176:179], a[104:107], v[80:83]
  v_mfma_f32_16x16x32_bf16 v[84:87], v[176:179], a[108:111], v[84:87]
  buffer_load_dwordx4 v[176:179], v1, s[8:11], s20 offen offset:2048
  v_mfma_f32_16x16x32_bf16 v[72:75], v[180:183], a[112:115], v[72:75]
  v_mfma_f32_16x16x32_bf16 v[76:79], v[180:183], a[116:119], v[76:79]
  v_mfma_f32_16x16x32_bf16 v[80:83], v[180:183], a[120:123], v[80:83]
  v_mfma_f32_16x16x32_bf16 v[84:87], v[180:183], a[124:127], v[84:87]
  buffer_load_dwordx4 v[180:183], v1, s[8:11], s20 offen offset:3072
  s_waitcnt vmcnt(29)
  v_mfma_f32_16x16x32_bf16 v[72:75], v[184:187], a[128:131], v[72:75]
  v_mfma_f32_16x16x32_bf16 v[76:79], v[184:187], a[132:135], v[76:79]
  v_mfma_f32_16x16x32_bf16 v[80:83], v[184:187], a[136:139], v[80:83]
  v_mfma_f32_16x16x32_bf16 v[84:87], v[184:187], a[140:143], v[84:87]
  s_add_u32 s20, s20, 4096
  buffer_load_dwordx4 v[184:187], v1, s[8:11], s20 offen offset:0
  v_mfma_f32_16x16x32_bf16 v[72:75], v[188:191], a[144:147], v[72:75]
  v_mfma_f32_16x16x32_bf16 v[76:79], v[188:191], a[148:151], v[76:79]
  v_mfma_f32_16x16x32_bf16 v[80:83], v[188:191], a[152:155], v[80:83]
  v_mfma_f32_16x16x32_bf16 v[84:87], v[188:191], a[156:159], v[84:87]
  buffer_load_dwordx4 v[188:191], v1, s[8:11], s20 offen offset:1024
  s_waitcnt vmcnt(29)
  v_mfma_f32_16x16x32_bf16 v[72:75], v[104:107], a[160:163], v[72:75]
  v_mfma_f32_16x16x32_bf16 v[76:79], v[104:107], a[164:167], v[76:79]
  v_mfma_f32_16x16x32_bf16 v[80:83], v[104:107], a[168:171], v[80:83]
  v_mfma_f32_16x16x32_bf16 v[84:87], v[104:107], a[172:175], v[84:87]
  buffer_load_dwordx4 v[104:107], v1, s[8:11], s20 offen offset:2048
  s_add_u32 s31, s28, 55296
  buffer_store_dwordx4 v[68:71], v1, s[44:47], s31 offen sc1
  v_mfma_f32_16x16x32_bf16 v[72:75], v[108:111], a[176:179], v[72:75]
  v_mfma_f32_16x16x32_bf16 v[76:79], v[108:111], a[180:183], v[76:79]
  v_mfma_f32_16x16x32_bf16 v[80:83], v[108:111], a[184:187], v[80:83]
  v_mfma_f32_16x16x32_bf16 v[84:87], v[108:111], a[188:191], v[84:87]
  buffer_load_dwordx4 v[108:111], v1, s[8:11], s20 offen offset:3072
  s_waitcnt vmcnt(30)
  v_mfma_f32_16x16x32_bf16 v[72:75], v[112:115], a[192:195], v[72:75]
  v_mfma_f32_16x16x32_bf16 v[76:79], v[112:115], a[196:199], v[76:79]
  v_mfma_f32_16x16x32_bf16 v[80:83], v[112:115], a[200:203], v[80:83]
  v_mfma_f32_16x16x32_bf16 v[84:87], v[112:115], a[204:207], v[84:87]
  s_add_u32 s20, s20, 4096
  buffer_load_dwordx4 v[112:115], v1, s[8:11], s20 offen offset:0
  v_mfma_f32_16x16x32_bf16 v[72:75], v[116:119], a[208:211], v[72:75]
  v_mfma_f32_16x16x32_bf16 v[76:79], v[116:119], a[212:215], v[76:79]
  v_mfma_f32_16x16x32_bf16 v[80:83], v[116:119], a[216:219], v[80:83]
  v_mfma_f32_16x16x32_bf16 v[84:87], v[116:119], a[220:223], v[84:87]
  buffer_load_dwordx4 v[116:119], v1, s[8:11], s20 offen offset:1024
  s_waitcnt vmcnt(30)
  v_mfma_f32_16x16x32_bf16 v[72:75], v[32:35], a[224:227], v[72:75]
  v_mfma_f32_16x16x32_bf16 v[76:79], v[32:35], a[228:231], v[76:79]
  v_mfma_f32_16x16x32_bf16 v[80:83], v[32:35], a[232:235], v[80:83]
  v_mfma_f32_16x16x32_bf16 v[84:87], v[32:35], a[236:239], v[84:87]
  buffer_load_dwordx4 v[32:35], v1, s[8:11], s20 offen offset:2048
  v_mfma_f32_16x16x32_bf16 v[72:75], v[36:39], a[240:243], v[72:75]
  v_mfma_f32_16x16x32_bf16 v[76:79], v[36:39], a[244:247], v[76:79]
  v_mfma_f32_16x16x32_bf16 v[80:83], v[36:39], a[248:251], v[80:83]
  v_mfma_f32_16x16x32_bf16 v[84:87], v[36:39], a[252:255], v[84:87]
  buffer_load_dwordx4 v[36:39], v1, s[8:11], s20 offen offset:3072
  s_waitcnt vmcnt(30)
  v_mfma_f32_16x16x32_bf16 v[72:75], v[224:227], v[192:195], v[72:75]
  v_mfma_f32_16x16x32_bf16 v[76:79], v[224:227], v[196:199], v[76:79]
  v_mfma_f32_16x16x32_bf16 v[80:83], v[224:227], v[200:203], v[80:83]
  v_mfma_f32_16x16x32_bf16 v[84:87], v[224:227], v[204:207], v[84:87]
  s_add_u32 s20, s20, 4096
  buffer_load_dwordx4 v[224:227], v1, s[8:11], s20 offen offset:0
  v_mfma_f32_16x16x32_bf16 v[72:75], v[228:231], v[208:211], v[72:75]
  v_mfma_f32_16x16x32_bf16 v[76:79], v[228:231], v[212:215], v[76:79]
  v_mfma_f32_16x16x32_bf16 v[80:83], v[228:231], v[216:219], v[80:83]
  v_mfma_f32_16x16x32_bf16 v[84:87], v[228:231], v[220:223], v[84:87]
  buffer_load_dwordx4 v[228:231], v1, s[8:11], s20 offen offset:1024
  s_waitcnt vmcnt(29)
  v_mfma_f32_16x16x32_bf16 v[88:91], v[232:235], a[0:3], 0
  v_mfma_f32_16x16x32_bf16 v[92:95], v[232:235], a[4:7], 0
  v_mfma_f32_16x16x32_bf16 v[96:99], v[232:235], a[8:11], 0
  v_mfma_f32_16x16x32_bf16 v[100:103], v[232:235], a[12:15], 0
  buffer_load_dwordx4 v[232:235], v1, s[8:11], s20 offen offset:2048
  v_mfma_f32_16x16x32_bf16 v[88:91], v[236:239], a[16:19], v[88:91]
  v_mfma_f32_16x16x32_bf16 v[92:95], v[236:239], a[20:23], v[92:95]
  v_mfma_f32_16x16x32_bf16 v[96:99], v[236:239], a[24:27], v[96:99]
  v_mul_f32 v72, v72, v24
  v_mul_f32 v73, v73, v24
  v_mfma_f32_16x16x32_bf16 v[100:103], v[236:239], a[28:31], v[100:103]
  buffer_load_dwordx4 v[236:239], v1, s[8:11], s20 offen offset:3072
  v_mul_f32 v74, v74, v24
  s_waitcnt vmcnt(29)
  v_mfma_f32_16x16x32_bf16 v[88:91], v[120:123], a[32:35], v[88:91]
  v_mul_f32 v75, v75, v24
  v_mul_f32 v76, v76, v25
  v_mfma_f32_16x16x32_bf16 v[92:95], v[120:123], a[36:39], v[92:95]
  v_mul_f32 v77, v77, v25
  v_mul_f32 v78, v78, v25
  v_mfma_f32_16x16x32_bf16 v[96:99], v[120:123], a[40:43], v[96:99]
  v_mul_f32 v79, v79, v25
  v_mul_f32 v80, v80, v26
  v_mfma_f32_16x16x32_bf16 v[100:103], v[120:123], a[44:47], v[100:103]
  s_add_u32 s20, s20, 4096
  buffer_load_dwordx4 v[120:123], v1, s[8:11], s20 offen offset:0
  v_mfma_f32_16x16x32_bf16 v[88:91], v[124:127], a[48:51], v[88:91]
  v_mul_f32 v81, v81, v26
  v_mul_f32 v82, v82, v26
  v_mfma_f32_16x16x32_bf16 v[92:95], v[124:127], a[52:55], v[92:95]
  v_mul_f32 v83, v83, v26
  v_mul_f32 v84, v84, v27
  v_mfma_f32_16x16x32_bf16 v[96:99], v[124:127], a[56:59], v[96:99]
  v_mul_f32 v85, v85, v27
  v_mul_f32 v86, v86, v27
  v_mfma_f32_16x16x32_bf16 v[100:103], v[124:127], a[60:63], v[100:103]
  buffer_load_dwordx4 v[124:127], v1, s[8:11], s20 offen offset:1024
  v_mul_f32 v87, v87, v27
  s_waitcnt vmcnt(29)
  v_mfma_f32_16x16x32_bf16 v[88:91], v[128:131], a[64:67], v[88:91]
  v_cvt_pk_bf16_f32 v42, v72, v73
  v_cvt_pk_bf16_f32 v43, v74, v75
  v_mfma_f32_16x16x32_bf16 v[92:95], v[128:131], a[68:71], v[92:95]
  v_cvt_pk_bf16_f32 v46, v76, v77
  v_cvt_pk_bf16_f32 v47, v78, v79
  v_mfma_f32_16x16x32_bf16 v[96:99], v[128:131], a[72:75], v[96:99]
  v_cvt_pk_bf16_f32 v50, v80, v81
  v_cvt_pk_bf16_f32 v51, v82, v83
  v_mfma_f32_16x16x32_bf16 v[100:103], v[128:131], a[76:79], v[100:103]
  buffer_load_dwordx4 v[128:131], v1, s[8:11], s20 offen offset:2048
  v_cvt_pk_bf16_f32 v54, v84, v85
  v_mfma_f32_16x16x32_bf16 v[88:91], v[132:135], a[80:83], v[88:91]
  v_cvt_pk_bf16_f32 v55, v86, v87
  v_mfma_f32_16x16x32_bf16 v[92:95], v[132:135], a[84:87], v[92:95]
  v_mfma_f32_16x16x32_bf16 v[96:99], v[132:135], a[88:91], v[96:99]
  v_mfma_f32_16x16x32_bf16 v[100:103], v[132:135], a[92:95], v[100:103]
  buffer_load_dwordx4 v[132:135], v1, s[8:11], s20 offen offset:3072
  s_waitcnt vmcnt(28)
  v_mfma_f32_16x16x32_bf16 v[88:91], v[136:139], a[96:99], v[88:91]
  v_mfma_f32_16x16x32_bf16 v[92:95], v[136:139], a[100:103], v[92:95]
  v_mfma_f32_16x16x32_bf16 v[96:99], v[136:139], a[104:107], v[96:99]
  v_mfma_f32_16x16x32_bf16 v[100:103], v[136:139], a[108:111], v[100:103]
  s_add_u32 s20, s20, 4096
  buffer_load_dwordx4 v[136:139], v1, s[8:11], s20 offen offset:0
  v_mfma_f32_16x16x32_bf16 v[88:91], v[140:143], a[112:115], v[88:91]
  v_mfma_f32_16x16x32_bf16 v[92:95], v[140:143], a[116:119], v[92:95]
  v_mfma_f32_16x16x32_bf16 v[96:99], v[140:143], a[120:123], v[96:99]
  v_mfma_f32_16x16x32_bf16 v[100:103], v[140:143], a[124:127], v[100:103]
  buffer_load_dwordx4 v[140:143], v1, s[8:11], s20 offen offset:1024
  s_waitcnt vmcnt(28)
  v_mfma_f32_16x16x32_bf16 v[88:91], v[144:147], a[128:131], v[88:91]
  v_mfma_f32_16x16x32_bf16 v[92:95], v[144:147], a[132:135], v[92:95]
  v_mfma_f32_16x16x32_bf16 v[96:99], v[144:147], a[136:139], v[96:99]
  v_mfma_f32_16x16x32_bf16 v[100:103], v[144:147], a[140:143], v[100:103]
  buffer_load_dwordx4 v[144:147], v1, s[8:11], s20 offen offset:2048
  s_add_u32 s31, s28, 4096
  buffer_store_dwordx4 v[40:43], v1, s[44:47], s31 offen sc1
  v_mfma_f32_16x16x32_bf16 v[88:91], v[148:151], a[144:147], v[88:91]
  v_mfma_f32_16x16x32_bf16 v[92:95], v[148:151], a[148:151], v[92:95]
  v_mfma_f32_16x16x32_bf16 v[96:99], v[148:151], a[152:155], v[96:99]
  v_mfma_f32_16x16x32_bf16 v[100:103], v[148:151], a[156:159], v[100:103]
  buffer_load_dwordx4 v[148:151], v1, s[8:11], s20 offen offset:3072
  s_waitcnt vmcnt(29)
  v_mfma_f32_16x16x32_bf16 v[88:91], v[152:155], a[160:163], v[88:91]
  v_mfma_f32_16x16x32_bf16 v[92:95], v[152:155], a[164:167], v[92:95]
  v_mfma_f32_16x16x32_bf16 v[96:99], v[152:155], a[168:171], v[96:99]
  v_mfma_f32_16x16x32_bf16 v[100:103], v[152:155], a[172:175], v[100:103]
  s_add_u32 s20, s20, 4096
  buffer_load_dwordx4 v[152:155], v1, s[8:11], s20 offen offset:0
  v_mfma_f32_16x16x32_bf16 v[88:91], v[156:159], a[176:179], v[88:91]
  v_mfma_f32_16x16x32_bf16 v[92:95], v[156:159], a[180:183], v[92:95]
  v_mfma_f32_16x16x32_bf16 v[96:99], v[156:159], a[184:187], v[96:99]
  v_mfma_f32_16x16x32_bf16 v[100:103], v[156:159], a[188:191], v[100:103]
  buffer_load_dwordx4 v[156:159], v1, s[8:11], s20 offen offset:1024
  s_waitcnt vmcnt(29)
  v_mfma_f32_16x16x32_bf16 v[88:91], v[160:163], a[192:195], v[88:91]
  v_mfma_f32_16x16x32_bf16 v[92:95], v[160:163], a[196:199], v[92:95]
  v_mfma_f32_16x16x32_bf16 v[96:99], v[160:163], a[200:203], v[96:99]
  v_mfma_f32_16x16x32_bf16 v[100:103], v[160:163], a[204:207], v[100:103]
  buffer_load_dwordx4 v[160:163], v1, s[8:11], s20 offen offset:2048
  v_mfma_f32_16x16x32_bf16 v[88:91], v[164:167], a[208:211], v[88:91]
  v_mfma_f32_16x16x32_bf16 v[92:95], v[164:167], a[212:215], v[92:95]
  v_mfma_f32_16x16x32_bf16 v[96:99], v[164:167], a[216:219], v[96:99]
  v_mfma_f32_16x16x32_bf16 v[100:103], v[164:167], a[220:223], v[100:103]
  buffer_load_dwordx4 v[164:167], v1, s[8:11], s20 offen offset:3072
  s_waitcnt vmcnt(28)
  v_mfma_f32_16x16x32_bf16 v[88:91], v[168:171], a[224:227], v[88:91]
  v_mfma_f32_16x16x32_bf16 v[92:95], v[168:171], a[228:231], v[92:95]
  v_mfma_f32_16x16x32_bf16 v[96:99], v[168:171], a[232:235], v[96:99]
  v_mfma_f32_16x16x32_bf16 v[100:103], v[168:171], a[236:239], v[100:103]
  s_add_u32 s20, s20, 4096
  buffer_load_dwordx4 v[168:171], v1, s[8:11], s20 offen offset:0
  s_add_u32 s31, s28, 22528
  buffer_store_dwordx4 v[44:47], v1, s[44:47], s31 offen sc1
  v_mfma_f32_16x16x32_bf16 v[88:91], v[172:175], a[240:243], v[88:91]
  v_mfma_f32_16x16x32_bf16 v[92:95], v[172:175], a[244:247], v[92:95]
  v_mfma_f32_16x16x32_bf16 v[96:99], v[172:175], a[248:251], v[96:99]
  v_mfma_f32_16x16x32_bf16 v[100:103], v[172:175], a[252:255], v[100:103]
  buffer_load_dwordx4 v[172:175], v1, s[8:11], s20 offen offset:1024
  s_waitcnt vmcnt(29)
  v_mfma_f32_16x16x32_bf16 v[88:91], v[176:179], v[192:195], v[88:91]
  v_mfma_f32_16x16x32_bf16 v[92:95], v[176:179], v[196:199], v[92:95]
  v_mfma_f32_16x16x32_bf16 v[96:99], v[176:179], v[200:203], v[96:99]
  v_mfma_f32_16x16x32_bf16 v[100:103], v[176:179], v[204:207], v[100:103]
  buffer_load_dwordx4 v[176:179], v1, s[8:11], s20 offen offset:2048
  v_mfma_f32_16x16x32_bf16 v[88:91], v[180:183], v[208:211], v[88:91]
  v_mfma_f32_16x16x32_bf16 v[92:95], v[180:183], v[212:215], v[92:95]
  v_mfma_f32_16x16x32_bf16 v[96:99], v[180:183], v[216:219], v[96:99]
  v_mfma_f32_16x16x32_bf16 v[100:103], v[180:183], v[220:223], v[100:103]
  buffer_load_dwordx4 v[180:183], v1, s[8:11], s20 offen offset:3072
  s_waitcnt vmcnt(29)
  v_mfma_f32_16x16x32_bf16 v[72:75], v[184:187], a[0:3], 0
  v_mfma_f32_16x16x32_bf16 v[76:79], v[184:187], a[4:7], 0
  v_mfma_f32_16x16x32_bf16 v[80:83], v[184:187], a[8:11], 0
  v_mfma_f32_16x16x32_bf16 v[84:87], v[184:187], a[12:15], 0
  s_add_u32 s20, s20, 4096
  buffer_load_dwordx4 v[184:187], v1, s[8:11], s20 offen offset:0
  v_mfma_f32_16x16x32_bf16 v[72:75], v[188:191], a[16:19], v[72:75]
  v_mfma_f32_16x16x32_bf16 v[76:79], v[188:191], a[20:23], v[76:79]
  v_mfma_f32_16x16x32_bf16 v[80:83], v[188:191], a[24:27], v[80:83]
  v_mul_f32 v88, v88, v24
  v_mul_f32 v89, v89, v24
  v_mfma_f32_16x16x32_bf16 v[84:87], v[188:191], a[28:31], v[84:87]
  buffer_load_dwordx4 v[188:191], v1, s[8:11], s20 offen offset:1024
  v_mul_f32 v90, v90, v24
  s_waitcnt vmcnt(28)
  v_mfma_f32_16x16x32_bf16 v[72:75], v[104:107], a[32:35], v[72:75]
  v_mul_f32 v91, v91, v24
  v_mul_f32 v92, v92, v25
  v_mfma_f32_16x16x32_bf16 v[76:79], v[104:107], a[36:39], v[76:79]
  v_mul_f32 v93, v93, v25
  v_mul_f32 v94, v94, v25
  v_mfma_f32_16x16x32_bf16 v[80:83], v[104:107], a[40:43], v[80:83]
  v_mul_f32 v95, v95, v25
  v_mul_f32 v96, v96, v26
  v_mfma_f32_16x16x32_bf16 v[84:87], v[104:107], a[44:47], v[84:87]
  buffer_load_dwordx4 v[104:107], v1, s[8:11], s20 offen offset:2048
  v_mul_f32 v97, v97, v26
  v_mfma_f32_16x16x32_bf16 v[72:75], v[108:111], a[48:51], v[72:75]
  v_mul_f32 v98, v98, v26
  v_mul_f32 v99, v99, v26
  v_mfma_f32_16x16x32_bf16 v[76:79], v[108:111], a[52:55], v[76:79]
  v_mul_f32 v100, v100, v27
  v_mul_f32 v101, v101, v27
  v_mfma_f32_16x16x32_bf16 v[80:83], v[108:111], a[56:59], v[80:83]
  v_mul_f32 v102, v102, v27
  v_mul_f32 v103, v103, v27
  v_mfma_f32_16x16x32_bf16 v[84:87], v[108:111], a[60:63], v[84:87]
  buffer_load_dwordx4 v[108:111], v1, s[8:11], s20 offen offset:3072
  s_add_u32 s31, s28, 40960
  buffer_store_dwordx4 v[48:51], v1, s[44:47], s31 offen sc1
  s_waitcnt vmcnt(29)
  v_mfma_f32_16x16x32_bf16 v[72:75], v[112:115], a[64:67], v[72:75]
  v_cvt_pk_bf16_f32 v56, v88, v89
  v_mfma_f32_16x16x32_bf16 v[76:79], v[112:115], a[68:71], v[76:79]
  v_cvt_pk_bf16_f32 v57, v90, v91
  v_cvt_pk_bf16_f32 v60, v92, v93
  v_mfma_f32_16x16x32_bf16 v[80:83], v[112:115], a[72:75], v[80:83]
  v_cvt_pk_bf16_f32 v61, v94, v95
  v_cvt_pk_bf16_f32 v64, v96, v97
  v_mfma_f32_16x16x32_bf16 v[84:87], v[112:115], a[76:79], v[84:87]
  s_add_u32 s20, s20, 4096
  buffer_load_dwordx4 v[112:115], v1, s[8:11], s20 offen offset:0
  v_mfma_f32_16x16x32_bf16 v[72:75], v[116:119], a[80:83], v[72:75]
  v_cvt_pk_bf16_f32 v65, v98, v99
  v_cvt_pk_bf16_f32 v68, v100, v101
  v_mfma_f32_16x16x32_bf16 v[76:79], v[116:119], a[84:87], v[76:79]
  v_cvt_pk_bf16_f32 v69, v102, v103
  v_mfma_f32_16x16x32_bf16 v[80:83], v[116:119], a[88:91], v[80:83]
  v_mfma_f32_16x16x32_bf16 v[84:87], v[116:119], a[92:95], v[84:87]
  buffer_load_dwordx4 v[116:119], v1, s[8:11], s20 offen offset:1024
  s_waitcnt vmcnt(29)
  v_mfma_f32_16x16x32_bf16 v[72:75], v[32:35], a[96:99], v[72:75]
  v_mfma_f32_16x16x32_bf16 v[76:79], v[32:35], a[100:103], v[76:79]
  v_mfma_f32_16x16x32_bf16 v[80:83], v[32:35], a[104:107], v[80:83]
  v_mfma_f32_16x16x32_bf16 v[84:87], v[32:35], a[108:111], v[84:87]
  buffer_load_dwordx4 v[32:35], v1, s[8:11], s20 offen offset:2048
  v_mfma_f32_16x16x32_bf16 v[72:75], v[36:39], a[112:115], v[72:75]
  v_mfma_f32_16x16x32_bf16 v[76:79], v[36:39], a[116:119], v[76:79]
  v_mfma_f32_16x16x32_bf16 v[80:83], v[36:39], a[120:123], v[80:83]
  v_mfma_f32_16x16x32_bf16 v[84:87], v[36:39], a[124:127], v[84:87]
  buffer_load_dwordx4 v[36:39], v1, s[8:11], s20 offen offset:3072
  s_waitcnt vmcnt(29)
  v_mfma_f32_16x16x32_bf16 v[72:75], v[224:227], a[128:131], v[72:75]
  v_mfma_f32_16x16x32_bf16 v[76:79], v[224:227], a[132:135], v[76:79]
  v_mfma_f32_16x16x32_bf16 v[80:83], v[224:227], a[136:139], v[80:83]
  v_mfma_f32_16x16x32_bf16 v[84:87], v[224:227], a[140:143], v[84:87]
  s_add_u32 s20, s20, 4096
  buffer_load_dwordx4 v[224:227], v1, s[8:11], s20 offen offset:0
  v_mfma_f32_16x16x32_bf16 v[72:75], v[228:231], a[144:147], v[72:75]
  v_mfma_f32_16x16x32_bf16 v[76:79], v[228:231], a[148:151], v[76:79]
  v_mfma_f32_16x16x32_bf16 v[80:83], v[228:231], a[152:155], v[80:83]
  v_mfma_f32_16x16x32_bf16 v[84:87], v[228:231], a[156:159], v[84:87]
  buffer_load_dwordx4 v[228:231], v1, s[8:11], s20 offen offset:1024
  s_waitcnt vmcnt(29)
  v_mfma_f32_16x16x32_bf16 v[72:75], v[232:235], a[160:163], v[72:75]
  v_mfma_f32_16x16x32_bf16 v[76:79], v[232:235], a[164:167], v[76:79]
  v_mfma_f32_16x16x32_bf16 v[80:83], v[232:235], a[168:171], v[80:83]
  v_mfma_f32_16x16x32_bf16 v[84:87], v[232:235], a[172:175], v[84:87]
  buffer_load_dwordx4 v[232:235], v1, s[8:11], s20 offen offset:2048
  s_add_u32 s31, s28, 59392
  buffer_store_dwordx4 v[52:55], v1, s[44:47], s31 offen sc1
  v_mfma_f32_16x16x32_bf16 v[72:75], v[236:239], a[176:179], v[72:75]
  v_mfma_f32_16x16x32_bf16 v[76:79], v[236:239], a[180:183], v[76:79]
  v_mfma_f32_16x16x32_bf16 v[80:83], v[236:239], a[184:187], v[80:83]
  v_mfma_f32_16x16x32_bf16 v[84:87], v[236:239], a[188:191], v[84:87]
  buffer_load_dwordx4 v[236:239], v1, s[8:11], s20 offen offset:3072
  s_waitcnt vmcnt(30)
  v_mfma_f32_16x16x32_bf16 v[72:75], v[120:123], a[192:195], v[72:75]
  v_mfma_f32_16x16x32_bf16 v[76:79], v[120:123], a[196:199], v[76:79]
  v_mfma_f32_16x16x32_bf16 v[80:83], v[120:123], a[200:203], v[80:83]
  v_mfma_f32_16x16x32_bf16 v[84:87], v[120:123], a[204:207], v[84:87]
  s_add_u32 s20, s20, 4096
  buffer_load_dwordx4 v[120:123], v1, s[8:11], s20 offen offset:0
  v_mfma_f32_16x16x32_bf16 v[72:75], v[124:127], a[208:211], v[72:75]
  v_mfma_f32_16x16x32_bf16 v[76:79], v[124:127], a[212:215], v[76:79]
  v_mfma_f32_16x16x32_bf16 v[80:83], v[124:127], a[216:219], v[80:83]
  v_mfma_f32_16x16x32_bf16 v[84:87], v[124:127], a[220:223], v[84:87]
  buffer_load_dwordx4 v[124:127], v1, s[8:11], s20 offen offset:1024
  s_waitcnt vmcnt(30)
  v_mfma_f32_16x16x32_bf16 v[72:75], v[128:131], a[224:227], v[72:75]
  v_mfma_f32_16x16x32_bf16 v[76:79], v[128:131], a[228:231], v[76:79]
  v_mfma_f32_16x16x32_bf16 v[80:83], v[128:131], a[232:235], v[80:83]
  v_mfma_f32_16x16x32_bf16 v[84:87], v[128:131], a[236:239], v[84:87]
  buffer_load_dwordx4 v[128:131], v1, s[8:11], s20 offen offset:2048
  v_mfma_f32_16x16x32_bf16 v[72:75], v[132:135], a[240:243], v[72:75]
  v_mfma_f32_16x16x32_bf16 v[76:79], v[132:135], a[244:247], v[76:79]
  v_mfma_f32_16x16x32_bf16 v[80:83], v[132:135], a[248:251], v[80:83]
  v_mfma_f32_16x16x32_bf16 v[84:87], v[132:135], a[252:255], v[84:87]
  buffer_load_dwordx4 v[132:135], v1, s[8:11], s20 offen offset:3072
  s_waitcnt vmcnt(30)
  v_mfma_f32_16x16x32_bf16 v[72:75], v[136:139], v[192:195], v[72:75]
  v_mfma_f32_16x16x32_bf16 v[76:79], v[136:139], v[196:199], v[76:79]
  v_mfma_f32_16x16x32_bf16 v[80:83], v[136:139], v[200:203], v[80:83]
  v_mfma_f32_16x16x32_bf16 v[84:87], v[136:139], v[204:207], v[84:87]
  s_add_u32 s20, s20, 4096
  buffer_load_dwordx4 v[136:139], v1, s[8:11], s20 offen offset:0
  v_mfma_f32_16x16x32_bf16 v[72:75], v[140:143], v[208:211], v[72:75]
  v_mfma_f32_16x16x32_bf16 v[76:79], v[140:143], v[212:215], v[76:79]
  v_mfma_f32_16x16x32_bf16 v[80:83], v[140:143], v[216:219], v[80:83]
  v_mfma_f32_16x16x32_bf16 v[84:87], v[140:143], v[220:223], v[84:87]
  buffer_load_dwordx4 v[140:143], v1, s[8:11], s20 offen offset:1024
  s_waitcnt vmcnt(29)
  v_mfma_f32_16x16x32_bf16 v[88:91], v[144:147], a[0:3], 0
  v_mfma_f32_16x16x32_bf16 v[92:95], v[144:147], a[4:7], 0
  v_mfma_f32_16x16x32_bf16 v[96:99], v[144:147], a[8:11], 0
  v_mfma_f32_16x16x32_bf16 v[100:103], v[144:147], a[12:15], 0
  buffer_load_dwordx4 v[144:147], v1, s[8:11], s20 offen offset:2048
  v_mfma_f32_16x16x32_bf16 v[88:91], v[148:151], a[16:19], v[88:91]
  v_mfma_f32_16x16x32_bf16 v[92:95], v[148:151], a[20:23], v[92:95]
  v_mfma_f32_16x16x32_bf16 v[96:99], v[148:151], a[24:27], v[96:99]
  v_mul_f32 v72, v72, v24
  v_mul_f32 v73, v73, v24
  v_mfma_f32_16x16x32_bf16 v[100:103], v[148:151], a[28:31], v[100:103]
  buffer_load_dwordx4 v[148:151], v1, s[8:11], s20 offen offset:3072
  v_mul_f32 v74, v74, v24
  s_waitcnt vmcnt(29)
  v_mfma_f32_16x16x32_bf16 v[88:91], v[152:155], a[32:35], v[88:91]
  v_mul_f32 v75, v75, v24
  v_mul_f32 v76, v76, v25
  v_mfma_f32_16x16x32_bf16 v[92:95], v[152:155], a[36:39], v[92:95]
  v_mul_f32 v77, v77, v25
  v_mul_f32 v78, v78, v25
  v_mfma_f32_16x16x32_bf16 v[96:99], v[152:155], a[40:43], v[96:99]
  v_mul_f32 v79, v79, v25
  v_mul_f32 v80, v80, v26
  v_mfma_f32_16x16x32_bf16 v[100:103], v[152:155], a[44:47], v[100:103]
  s_add_u32 s20, s20, 4096
  buffer_load_dwordx4 v[152:155], v1, s[8:11], s20 offen offset:0
  v_mfma_f32_16x16x32_bf16 v[88:91], v[156:159], a[48:51], v[88:91]
  v_mul_f32 v81, v81, v26
  v_mul_f32 v82, v82, v26
  v_mfma_f32_16x16x32_bf16 v[92:95], v[156:159], a[52:55], v[92:95]
  v_mul_f32 v83, v83, v26
  v_mul_f32 v84, v84, v27
  v_mfma_f32_16x16x32_bf16 v[96:99], v[156:159], a[56:59], v[96:99]
  v_mul_f32 v85, v85, v27
  v_mul_f32 v86, v86, v27
  v_mfma_f32_16x16x32_bf16 v[100:103], v[156:159], a[60:63], v[100:103]
  buffer_load_dwordx4 v[156:159], v1, s[8:11], s20 offen offset:1024
  v_mul_f32 v87, v87, v27
  s_waitcnt vmcnt(29)
  v_mfma_f32_16x16x32_bf16 v[88:91], v[160:163], a[64:67], v[88:91]
  v_cvt_pk_bf16_f32 v58, v72, v73
  v_cvt_pk_bf16_f32 v59, v74, v75
  v_mfma_f32_16x16x32_bf16 v[92:95], v[160:163], a[68:71], v[92:95]
  v_cvt_pk_bf16_f32 v62, v76, v77
  v_cvt_pk_bf16_f32 v63, v78, v79
  v_mfma_f32_16x16x32_bf16 v[96:99], v[160:163], a[72:75], v[96:99]
  v_cvt_pk_bf16_f32 v66, v80, v81
  v_cvt_pk_bf16_f32 v67, v82, v83
  v_mfma_f32_16x16x32_bf16 v[100:103], v[160:163], a[76:79], v[100:103]
  buffer_load_dwordx4 v[160:163], v1, s[8:11], s20 offen offset:2048
  v_cvt_pk_bf16_f32 v70, v84, v85
  v_mfma_f32_16x16x32_bf16 v[88:91], v[164:167], a[80:83], v[88:91]
  v_cvt_pk_bf16_f32 v71, v86, v87
  s_getpc_b64 s[50:51]
k45_mlp_pc_1:
  s_add_u32 s50, s50, k1_qkv0_kernel-k45_mlp_pc_1
  s_addc_u32 s51, s51, (k1_qkv0_kernel-k45_mlp_pc_1)>>32
  s_lshr_b32 s52, s2, 3
  s_and_b32 s52, s52, 31
  s_mul_i32 s52, s52, 4
  s_add_u32 s52, s52, s3
  s_lshl_b32 s52, s52, 10
  s_min_u32 s52, s52, k2_attn_codeend-k1_qkv0_kernel-1024
  v_lshlrev_b32 v240, 4, v0
  v_add_u32 v240, s52, v240
  global_load_dwordx4 v[242:245], v240, s[50:51]
  s_getpc_b64 s[50:51]
k45_mlp_pc_2:
  s_add_u32 s50, s50, k6_red0_kernel-k45_mlp_pc_2
  s_addc_u32 s51, s51, (k6_red0_kernel-k45_mlp_pc_2)>>32
  s_lshr_b32 s52, s2, 3
  s_and_b32 s52, s52, 31
  s_mul_i32 s52, s52, 4
  s_add_u32 s52, s52, s3
  s_lshl_b32 s52, s52, 10
  s_min_u32 s52, s52, k6_red_codeend-k6_red0_kernel-1024
  v_lshlrev_b32 v246, 4, v0
  v_add_u32 v246, s52, v246
  global_load_dwordx4 v[248:251], v246, s[50:51]
  v_mfma_f32_16x16x32_bf16 v[92:95], v[164:167], a[84:87], v[92:95]
  v_mfma_f32_16x16x32_bf16 v[96:99], v[164:167], a[88:91], v[96:99]
  v_mfma_f32_16x16x32_bf16 v[100:103], v[164:167], a[92:95], v[100:103]
  buffer_load_dwordx4 v[164:167], v1, s[8:11], s20 offen offset:3072
  s_waitcnt vmcnt(30)
  v_mfma_f32_16x16x32_bf16 v[88:91], v[168:171], a[96:99], v[88:91]
  v_mfma_f32_16x16x32_bf16 v[92:95], v[168:171], a[100:103], v[92:95]
  v_mfma_f32_16x16x32_bf16 v[96:99], v[168:171], a[104:107], v[96:99]
  v_mfma_f32_16x16x32_bf16 v[100:103], v[168:171], a[108:111], v[100:103]
  s_add_u32 s20, s20, 4096
  buffer_load_dwordx4 v[168:171], v1, s[8:11], s20 offen offset:0
  v_mfma_f32_16x16x32_bf16 v[88:91], v[172:175], a[112:115], v[88:91]
  v_mfma_f32_16x16x32_bf16 v[92:95], v[172:175], a[116:119], v[92:95]
  v_mfma_f32_16x16x32_bf16 v[96:99], v[172:175], a[120:123], v[96:99]
  v_mfma_f32_16x16x32_bf16 v[100:103], v[172:175], a[124:127], v[100:103]
  buffer_load_dwordx4 v[172:175], v1, s[8:11], s20 offen offset:1024
  s_waitcnt vmcnt(30)
  v_mfma_f32_16x16x32_bf16 v[88:91], v[176:179], a[128:131], v[88:91]
  v_mfma_f32_16x16x32_bf16 v[92:95], v[176:179], a[132:135], v[92:95]
  v_mfma_f32_16x16x32_bf16 v[96:99], v[176:179], a[136:139], v[96:99]
  v_mfma_f32_16x16x32_bf16 v[100:103], v[176:179], a[140:143], v[100:103]
  buffer_load_dwordx4 v[176:179], v1, s[8:11], s20 offen offset:2048
  s_add_u32 s31, s28, 8192
  buffer_store_dwordx4 v[56:59], v1, s[44:47], s31 offen sc1
  v_mfma_f32_16x16x32_bf16 v[88:91], v[180:183], a[144:147], v[88:91]
  v_mfma_f32_16x16x32_bf16 v[92:95], v[180:183], a[148:151], v[92:95]
  v_mfma_f32_16x16x32_bf16 v[96:99], v[180:183], a[152:155], v[96:99]
  v_mfma_f32_16x16x32_bf16 v[100:103], v[180:183], a[156:159], v[100:103]
  buffer_load_dwordx4 v[180:183], v1, s[8:11], s20 offen offset:3072
  s_waitcnt vmcnt(31)
  v_mfma_f32_16x16x32_bf16 v[88:91], v[184:187], a[160:163], v[88:91]
  v_mfma_f32_16x16x32_bf16 v[92:95], v[184:187], a[164:167], v[92:95]
  v_mfma_f32_16x16x32_bf16 v[96:99], v[184:187], a[168:171], v[96:99]
  v_mfma_f32_16x16x32_bf16 v[100:103], v[184:187], a[172:175], v[100:103]
  s_add_u32 s20, s20, 4096
  buffer_load_dwordx4 v[184:187], v1, s[8:11], s20 offen offset:0
  v_mfma_f32_16x16x32_bf16 v[88:91], v[188:191], a[176:179], v[88:91]
  v_mfma_f32_16x16x32_bf16 v[92:95], v[188:191], a[180:183], v[92:95]
  v_mfma_f32_16x16x32_bf16 v[96:99], v[188:191], a[184:187], v[96:99]
  v_mfma_f32_16x16x32_bf16 v[100:103], v[188:191], a[188:191], v[100:103]
  buffer_load_dwordx4 v[188:191], v1, s[8:11], s20 offen offset:1024
  s_waitcnt vmcnt(31)
  v_mfma_f32_16x16x32_bf16 v[88:91], v[104:107], a[192:195], v[88:91]
  v_mfma_f32_16x16x32_bf16 v[92:95], v[104:107], a[196:199], v[92:95]
  v_mfma_f32_16x16x32_bf16 v[96:99], v[104:107], a[200:203], v[96:99]
  v_mfma_f32_16x16x32_bf16 v[100:103], v[104:107], a[204:207], v[100:103]
  buffer_load_dwordx4 v[104:107], v1, s[8:11], s20 offen offset:2048
  v_mfma_f32_16x16x32_bf16 v[88:91], v[108:111], a[208:211], v[88:91]
  v_mfma_f32_16x16x32_bf16 v[92:95], v[108:111], a[212:215], v[92:95]
  v_mfma_f32_16x16x32_bf16 v[96:99], v[108:111], a[216:219], v[96:99]
  v_mfma_f32_16x16x32_bf16 v[100:103], v[108:111], a[220:223], v[100:103]
  buffer_load_dwordx4 v[108:111], v1, s[8:11], s20 offen offset:3072
  s_waitcnt vmcnt(30)
  v_mfma_f32_16x16x32_bf16 v[88:91], v[112:115], a[224:227], v[88:91]
  v_mfma_f32_16x16x32_bf16 v[92:95], v[112:115], a[228:231], v[92:95]
  v_mfma_f32_16x16x32_bf16 v[96:99], v[112:115], a[232:235], v[96:99]
  v_mfma_f32_16x16x32_bf16 v[100:103], v[112:115], a[236:239], v[100:103]
  s_add_u32 s20, s20, 4096
  buffer_load_dwordx4 v[112:115], v1, s[8:11], s20 offen offset:0
  s_add_u32 s31, s28, 26624
  buffer_store_dwordx4 v[60:63], v1, s[44:47], s31 offen sc1
  v_mfma_f32_16x16x32_bf16 v[88:91], v[116:119], a[240:243], v[88:91]
  v_mfma_f32_16x16x32_bf16 v[92:95], v[116:119], a[244:247], v[92:95]
  v_mfma_f32_16x16x32_bf16 v[96:99], v[116:119], a[248:251], v[96:99]
  v_mfma_f32_16x16x32_bf16 v[100:103], v[116:119], a[252:255], v[100:103]
  buffer_load_dwordx4 v[116:119], v1, s[8:11], s20 offen offset:1024
  s_waitcnt vmcnt(31)
  v_mfma_f32_16x16x32_bf16 v[88:91], v[32:35], v[192:195], v[88:91]
  v_mfma_f32_16x16x32_bf16 v[92:95], v[32:35], v[196:199], v[92:95]
  v_mfma_f32_16x16x32_bf16 v[96:99], v[32:35], v[200:203], v[96:99]
  v_mfma_f32_16x16x32_bf16 v[100:103], v[32:35], v[204:207], v[100:103]
  buffer_load_dwordx4 v[32:35], v1, s[8:11], s20 offen offset:2048
  v_mfma_f32_16x16x32_bf16 v[88:91], v[36:39], v[208:211], v[88:91]
  v_mfma_f32_16x16x32_bf16 v[92:95], v[36:39], v[212:215], v[92:95]
  v_mfma_f32_16x16x32_bf16 v[96:99], v[36:39], v[216:219], v[96:99]
  v_mfma_f32_16x16x32_bf16 v[100:103], v[36:39], v[220:223], v[100:103]
  buffer_load_dwordx4 v[36:39], v1, s[8:11], s20 offen offset:3072
  s_waitcnt vmcnt(31)
  v_mfma_f32_16x16x32_bf16 v[72:75], v[224:227], a[0:3], 0
  v_mfma_f32_16x16x32_bf16 v[76:79], v[224:227], a[4:7], 0
  v_mfma_f32_16x16x32_bf16 v[80:83], v[224:227], a[8:11], 0
  v_mfma_f32_16x16x32_bf16 v[84:87], v[224:227], a[12:15], 0
  s_add_u32 s20, s20, 4096
  buffer_load_dwordx4 v[224:227], v1, s[8:11], s20 offen offset:0
  v_mfma_f32_16x16x32_bf16 v[72:75], v[228:231], a[16:19], v[72:75]
  v_mfma_f32_16x16x32_bf16 v[76:79], v[228:231], a[20:23], v[76:79]
  v_mfma_f32_16x16x32_bf16 v[80:83], v[228:231], a[24:27], v[80:83]
  v_mul_f32 v88, v88, v24
  v_mul_f32 v89, v89, v24
  v_mfma_f32_16x16x32_bf16 v[84:87], v[228:231], a[28:31], v[84:87]
  buffer_load_dwordx4 v[228:231], v1, s[8:11], s20 offen offset:1024
  v_mul_f32 v90, v90, v24
  s_waitcnt vmcnt(30)
  v_mfma_f32_16x16x32_bf16 v[72:75], v[232:235], a[32:35], v[72:75]
  v_mul_f32 v91, v91, v24
  v_mul_f32 v92, v92, v25
  v_mfma_f32_16x16x32_bf16 v[76:79], v[232:235], a[36:39], v[76:79]
  v_mul_f32 v93, v93, v25
  v_mul_f32 v94, v94, v25
  v_mfma_f32_16x16x32_bf16 v[80:83], v[232:235], a[40:43], v[80:83]
  v_mul_f32 v95, v95, v25
  v_mul_f32 v96, v96, v26
  v_mfma_f32_16x16x32_bf16 v[84:87], v[232:235], a[44:47], v[84:87]
  buffer_load_dwordx4 v[232:235], v1, s[8:11], s20 offen offset:2048
  v_mul_f32 v97, v97, v26
  v_mfma_f32_16x16x32_bf16 v[72:75], v[236:239], a[48:51], v[72:75]
  v_mul_f32 v98, v98, v26
  v_mul_f32 v99, v99, v26
  v_mfma_f32_16x16x32_bf16 v[76:79], v[236:239], a[52:55], v[76:79]
  v_mul_f32 v100, v100, v27
  v_mul_f32 v101, v101, v27
  v_mfma_f32_16x16x32_bf16 v[80:83], v[236:239], a[56:59], v[80:83]
  v_mul_f32 v102, v102, v27
  v_mul_f32 v103, v103, v27
  v_mfma_f32_16x16x32_bf16 v[84:87], v[236:239], a[60:63], v[84:87]
  buffer_load_dwordx4 v[236:239], v1, s[8:11], s20 offen offset:3072
  s_add_u32 s31, s28, 45056
  buffer_store_dwordx4 v[64:67], v1, s[44:47], s31 offen sc1
  s_waitcnt vmcnt(31)
  v_mfma_f32_16x16x32_bf16 v[72:75], v[120:123], a[64:67], v[72:75]
  v_cvt_pk_bf16_f32 v40, v88, v89
  v_mfma_f32_16x16x32_bf16 v[76:79], v[120:123], a[68:71], v[76:79]
  v_cvt_pk_bf16_f32 v41, v90, v91
  v_cvt_pk_bf16_f32 v44, v92, v93
  v_mfma_f32_16x16x32_bf16 v[80:83], v[120:123], a[72:75], v[80:83]
  v_cvt_pk_bf16_f32 v45, v94, v95
  v_cvt_pk_bf16_f32 v48, v96, v97
  v_mfma_f32_16x16x32_bf16 v[84:87], v[120:123], a[76:79], v[84:87]
  s_add_u32 s20, s20, 4096
  buffer_load_dwordx4 v[120:123], v1, s[8:11], s20 offen offset:0
  v_mfma_f32_16x16x32_bf16 v[72:75], v[124:127], a[80:83], v[72:75]
  v_cvt_pk_bf16_f32 v49, v98, v99
  v_cvt_pk_bf16_f32 v52, v100, v101
  v_mfma_f32_16x16x32_bf16 v[76:79], v[124:127], a[84:87], v[76:79]
  v_cvt_pk_bf16_f32 v53, v102, v103
  v_mfma_f32_16x16x32_bf16 v[80:83], v[124:127], a[88:91], v[80:83]
  v_mfma_f32_16x16x32_bf16 v[84:87], v[124:127], a[92:95], v[84:87]
  buffer_load_dwordx4 v[124:127], v1, s[8:11], s20 offen offset:1024
  s_waitcnt vmcnt(31)
  v_mfma_f32_16x16x32_bf16 v[72:75], v[128:131], a[96:99], v[72:75]
  v_mfma_f32_16x16x32_bf16 v[76:79], v[128:131], a[100:103], v[76:79]
  v_mfma_f32_16x16x32_bf16 v[80:83], v[128:131], a[104:107], v[80:83]
  v_mfma_f32_16x16x32_bf16 v[84:87], v[128:131], a[108:111], v[84:87]
  buffer_load_dwordx4 v[128:131], v1, s[8:11], s20 offen offset:2048
  v_mfma_f32_16x16x32_bf16 v[72:75], v[132:135], a[112:115], v[72:75]
  v_mfma_f32_16x16x32_bf16 v[76:79], v[132:135], a[116:119], v[76:79]
  v_mfma_f32_16x16x32_bf16 v[80:83], v[132:135], a[120:123], v[80:83]
  v_mfma_f32_16x16x32_bf16 v[84:87], v[132:135], a[124:127], v[84:87]
  buffer_load_dwordx4 v[132:135], v1, s[8:11], s20 offen offset:3072
  s_waitcnt vmcnt(31)
  v_mfma_f32_16x16x32_bf16 v[72:75], v[136:139], a[128:131], v[72:75]
  v_mfma_f32_16x16x32_bf16 v[76:79], v[136:139], a[132:135], v[76:79]
  v_mfma_f32_16x16x32_bf16 v[80:83], v[136:139], a[136:139], v[80:83]
  v_mfma_f32_16x16x32_bf16 v[84:87], v[136:139], a[140:143], v[84:87]
  v_mfma_f32_16x16x32_bf16 v[72:75], v[140:143], a[144:147], v[72:75]
  v_mfma_f32_16x16x32_bf16 v[76:79], v[140:143], a[148:151], v[76:79]
  v_mfma_f32_16x16x32_bf16 v[80:83], v[140:143], a[152:155], v[80:83]
  v_mfma_f32_16x16x32_bf16 v[84:87], v[140:143], a[156:159], v[84:87]
  s_waitcnt vmcnt(29)
  v_mfma_f32_16x16x32_bf16 v[72:75], v[144:147], a[160:163], v[72:75]
  v_mfma_f32_16x16x32_bf16 v[76:79], v[144:147], a[164:167], v[76:79]
  v_mfma_f32_16x16x32_bf16 v[80:83], v[144:147], a[168:171], v[80:83]
  v_mfma_f32_16x16x32_bf16 v[84:87], v[144:147], a[172:175], v[84:87]
  s_add_u32 s31, s28, 63488
  buffer_store_dwordx4 v[68:71], v1, s[44:47], s31 offen sc1
  v_mfma_f32_16x16x32_bf16 v[72:75], v[148:151], a[176:179], v[72:75]
  v_mfma_f32_16x16x32_bf16 v[76:79], v[148:151], a[180:183], v[76:79]
  v_mfma_f32_16x16x32_bf16 v[80:83], v[148:151], a[184:187], v[80:83]
  v_mfma_f32_16x16x32_bf16 v[84:87], v[148:151], a[188:191], v[84:87]
  s_waitcnt vmcnt(28)
  v_mfma_f32_16x16x32_bf16 v[72:75], v[152:155], a[192:195], v[72:75]
  v_mfma_f32_16x16x32_bf16 v[76:79], v[152:155], a[196:199], v[76:79]
  v_mfma_f32_16x16x32_bf16 v[80:83], v[152:155], a[200:203], v[80:83]
  v_mfma_f32_16x16x32_bf16 v[84:87], v[152:155], a[204:207], v[84:87]
  v_mfma_f32_16x16x32_bf16 v[72:75], v[156:159], a[208:211], v[72:75]
  v_mfma_f32_16x16x32_bf16 v[76:79], v[156:159], a[212:215], v[76:79]
  v_mfma_f32_16x16x32_bf16 v[80:83], v[156:159], a[216:219], v[80:83]
  v_mfma_f32_16x16x32_bf16 v[84:87], v[156:159], a[220:223], v[84:87]
  s_waitcnt vmcnt(24)
  v_mfma_f32_16x16x32_bf16 v[72:75], v[160:163], a[224:227], v[72:75]
  v_mfma_f32_16x16x32_bf16 v[76:79], v[160:163], a[228:231], v[76:79]
  v_mfma_f32_16x16x32_bf16 v[80:83], v[160:163], a[232:235], v[80:83]
  v_mfma_f32_16x16x32_bf16 v[84:87], v[160:163], a[236:239], v[84:87]
  v_mfma_f32_16x16x32_bf16 v[72:75], v[164:167], a[240:243], v[72:75]
  v_mfma_f32_16x16x32_bf16 v[76:79], v[164:167], a[244:247], v[76:79]
  v_mfma_f32_16x16x32_bf16 v[80:83], v[164:167], a[248:251], v[80:83]
  v_mfma_f32_16x16x32_bf16 v[84:87], v[164:167], a[252:255], v[84:87]
  s_waitcnt vmcnt(22)
  v_mfma_f32_16x16x32_bf16 v[72:75], v[168:171], v[192:195], v[72:75]
  v_mfma_f32_16x16x32_bf16 v[76:79], v[168:171], v[196:199], v[76:79]
  v_mfma_f32_16x16x32_bf16 v[80:83], v[168:171], v[200:203], v[80:83]
  v_mfma_f32_16x16x32_bf16 v[84:87], v[168:171], v[204:207], v[84:87]
  v_mfma_f32_16x16x32_bf16 v[72:75], v[172:175], v[208:211], v[72:75]
  v_mfma_f32_16x16x32_bf16 v[76:79], v[172:175], v[212:215], v[76:79]
  v_mfma_f32_16x16x32_bf16 v[80:83], v[172:175], v[216:219], v[80:83]
  v_mfma_f32_16x16x32_bf16 v[84:87], v[172:175], v[220:223], v[84:87]
  s_waitcnt vmcnt(19)
  v_mfma_f32_16x16x32_bf16 v[88:91], v[176:179], a[0:3], 0
  v_mfma_f32_16x16x32_bf16 v[92:95], v[176:179], a[4:7], 0
  v_mfma_f32_16x16x32_bf16 v[96:99], v[176:179], a[8:11], 0
  v_mfma_f32_16x16x32_bf16 v[100:103], v[176:179], a[12:15], 0
  v_mfma_f32_16x16x32_bf16 v[88:91], v[180:183], a[16:19], v[88:91]
  v_mfma_f32_16x16x32_bf16 v[92:95], v[180:183], a[20:23], v[92:95]
  v_mfma_f32_16x16x32_bf16 v[96:99], v[180:183], a[24:27], v[96:99]
  v_mul_f32 v72, v72, v24
  v_mul_f32 v73, v73, v24
  v_mfma_f32_16x16x32_bf16 v[100:103], v[180:183], a[28:31], v[100:103]
  v_mul_f32 v74, v74, v24
  v_mul_f32 v75, v75, v24
  s_waitcnt vmcnt(17)
  v_mfma_f32_16x16x32_bf16 v[88:91], v[184:187], a[32:35], v[88:91]
  v_mul_f32 v76, v76, v25
  v_mul_f32 v77, v77, v25
  v_mfma_f32_16x16x32_bf16 v[92:95], v[184:187], a[36:39], v[92:95]
  v_mul_f32 v78, v78, v25
  v_mul_f32 v79, v79, v25
  v_mfma_f32_16x16x32_bf16 v[96:99], v[184:187], a[40:43], v[96:99]
  v_mul_f32 v80, v80, v26
  v_mul_f32 v81, v81, v26
  v_mfma_f32_16x16x32_bf16 v[100:103], v[184:187], a[44:47], v[100:103]
  v_mul_f32 v82, v82, v26
  v_mul_f32 v83, v83, v26
  v_mfma_f32_16x16x32_bf16 v[88:91], v[188:191], a[48:51], v[88:91]
  v_mul_f32 v84, v84, v27
  v_mul_f32 v85, v85, v27
  v_mfma_f32_16x16x32_bf16 v[92:95], v[188:191], a[52:55], v[92:95]
  v_mul_f32 v86, v86, v27
  v_mul_f32 v87, v87, v27
  v_mfma_f32_16x16x32_bf16 v[96:99], v[188:191], a[56:59], v[96:99]
  v_cvt_pk_bf16_f32 v42, v72, v73
  v_cvt_pk_bf16_f32 v43, v74, v75
  v_mfma_f32_16x16x32_bf16 v[100:103], v[188:191], a[60:63], v[100:103]
  v_cvt_pk_bf16_f32 v46, v76, v77
  v_cvt_pk_bf16_f32 v47, v78, v79
  s_waitcnt vmcnt(15)
  v_mfma_f32_16x16x32_bf16 v[88:91], v[104:107], a[64:67], v[88:91]
  v_cvt_pk_bf16_f32 v50, v80, v81
  v_cvt_pk_bf16_f32 v51, v82, v83
  v_mfma_f32_16x16x32_bf16 v[92:95], v[104:107], a[68:71], v[92:95]
  v_cvt_pk_bf16_f32 v54, v84, v85
  v_cvt_pk_bf16_f32 v55, v86, v87
  v_mfma_f32_16x16x32_bf16 v[96:99], v[104:107], a[72:75], v[96:99]
  v_mfma_f32_16x16x32_bf16 v[100:103], v[104:107], a[76:79], v[100:103]
  v_mfma_f32_16x16x32_bf16 v[88:91], v[108:111], a[80:83], v[88:91]
  v_mfma_f32_16x16x32_bf16 v[92:95], v[108:111], a[84:87], v[92:95]
  v_mfma_f32_16x16x32_bf16 v[96:99], v[108:111], a[88:91], v[96:99]
  v_mfma_f32_16x16x32_bf16 v[100:103], v[108:111], a[92:95], v[100:103]
  s_waitcnt vmcnt(12)
  v_mfma_f32_16x16x32_bf16 v[88:91], v[112:115], a[96:99], v[88:91]
  v_mfma_f32_16x16x32_bf16 v[92:95], v[112:115], a[100:103], v[92:95]
  v_mfma_f32_16x16x32_bf16 v[96:99], v[112:115], a[104:107], v[96:99]
  v_mfma_f32_16x16x32_bf16 v[100:103], v[112:115], a[108:111], v[100:103]
  s_add_u32 s31, s28, 12288
  buffer_store_dwordx4 v[40:43], v1, s[44:47], s31 offen sc1
  v_mfma_f32_16x16x32_bf16 v[88:91], v[116:119], a[112:115], v[88:91]
  v_mfma_f32_16x16x32_bf16 v[92:95], v[116:119], a[116:119], v[92:95]
  v_mfma_f32_16x16x32_bf16 v[96:99], v[116:119], a[120:123], v[96:99]
  v_mfma_f32_16x16x32_bf16 v[100:103], v[116:119], a[124:127], v[100:103]
  s_waitcnt vmcnt(12)
  v_mfma_f32_16x16x32_bf16 v[88:91], v[32:35], a[128:131], v[88:91]
  v_mfma_f32_16x16x32_bf16 v[92:95], v[32:35], a[132:135], v[92:95]
  v_mfma_f32_16x16x32_bf16 v[96:99], v[32:35], a[136:139], v[96:99]
  v_mfma_f32_16x16x32_bf16 v[100:103], v[32:35], a[140:143], v[100:103]
  s_waitcnt vmcnt(11)
  v_mfma_f32_16x16x32_bf16 v[88:91], v[36:39], a[144:147], v[88:91]
  v_mfma_f32_16x16x32_bf16 v[92:95], v[36:39], a[148:151], v[92:95]
  v_mfma_f32_16x16x32_bf16 v[96:99], v[36:39], a[152:155], v[96:99]
  v_mfma_f32_16x16x32_bf16 v[100:103], v[36:39], a[156:159], v[100:103]
  s_add_u32 s31, s28, 30720
  buffer_store_dwordx4 v[44:47], v1, s[44:47], s31 offen sc1
  s_waitcnt vmcnt(11)
  v_mfma_f32_16x16x32_bf16 v[88:91], v[224:227], a[160:163], v[88:91]
  v_mfma_f32_16x16x32_bf16 v[92:95], v[224:227], a[164:167], v[92:95]
  v_mfma_f32_16x16x32_bf16 v[96:99], v[224:227], a[168:171], v[96:99]
  v_mfma_f32_16x16x32_bf16 v[100:103], v[224:227], a[172:175], v[100:103]
  s_waitcnt vmcnt(10)
  v_mfma_f32_16x16x32_bf16 v[88:91], v[228:231], a[176:179], v[88:91]
  v_mfma_f32_16x16x32_bf16 v[92:95], v[228:231], a[180:183], v[92:95]
  v_mfma_f32_16x16x32_bf16 v[96:99], v[228:231], a[184:187], v[96:99]
  v_mfma_f32_16x16x32_bf16 v[100:103], v[228:231], a[188:191], v[100:103]
  s_waitcnt vmcnt(9)
  v_mfma_f32_16x16x32_bf16 v[88:91], v[232:235], a[192:195], v[88:91]
  v_mfma_f32_16x16x32_bf16 v[92:95], v[232:235], a[196:199], v[92:95]
  v_mfma_f32_16x16x32_bf16 v[96:99], v[232:235], a[200:203], v[96:99]
  v_mfma_f32_16x16x32_bf16 v[100:103], v[232:235], a[204:207], v[100:103]
  s_add_u32 s31, s28, 49152
  buffer_store_dwordx4 v[48:51], v1, s[44:47], s31 offen sc1
  s_waitcnt vmcnt(9)
  v_mfma_f32_16x16x32_bf16 v[88:91], v[236:239], a[208:211], v[88:91]
  v_mfma_f32_16x16x32_bf16 v[92:95], v[236:239], a[212:215], v[92:95]
  v_mfma_f32_16x16x32_bf16 v[96:99], v[236:239], a[216:219], v[96:99]
  v_mfma_f32_16x16x32_bf16 v[100:103], v[236:239], a[220:223], v[100:103]
  s_waitcnt vmcnt(7)
  v_mfma_f32_16x16x32_bf16 v[88:91], v[120:123], a[224:227], v[88:91]
  v_mfma_f32_16x16x32_bf16 v[92:95], v[120:123], a[228:231], v[92:95]
  v_mfma_f32_16x16x32_bf16 v[96:99], v[120:123], a[232:235], v[96:99]
  v_mfma_f32_16x16x32_bf16 v[100:103], v[120:123], a[236:239], v[100:103]
  s_waitcnt vmcnt(6)
  v_mfma_f32_16x16x32_bf16 v[88:91], v[124:127], a[240:243], v[88:91]
  v_mfma_f32_16x16x32_bf16 v[92:95], v[124:127], a[244:247], v[92:95]
  v_mfma_f32_16x16x32_bf16 v[96:99], v[124:127], a[248:251], v[96:99]
  v_mfma_f32_16x16x32_bf16 v[100:103], v[124:127], a[252:255], v[100:103]
  s_add_u32 s31, s28, 67584
  buffer_store_dwordx4 v[52:55], v1, s[44:47], s31 offen sc1
  s_waitcnt vmcnt(6)
  v_mfma_f32_16x16x32_bf16 v[88:91], v[128:131], v[192:195], v[88:91]
  v_mfma_f32_16x16x32_bf16 v[92:95], v[128:131], v[196:199], v[92:95]
  v_mfma_f32_16x16x32_bf16 v[96:99], v[128:131], v[200:203], v[96:99]
  v_mfma_f32_16x16x32_bf16 v[100:103], v[128:131], v[204:207], v[100:103]
  s_waitcnt vmcnt(5)
  v_mfma_f32_16x16x32_bf16 v[88:91], v[132:135], v[208:211], v[88:91]
  v_mfma_f32_16x16x32_bf16 v[92:95], v[132:135], v[212:215], v[92:95]
  v_mfma_f32_16x16x32_bf16 v[96:99], v[132:135], v[216:219], v[96:99]
  v_mfma_f32_16x16x32_bf16 v[100:103], v[132:135], v[220:223], v[100:103]
  s_nop 6
  v_mul_f32 v88, v88, v24
  v_mul_f32 v89, v89, v24
  v_mul_f32 v90, v90, v24
  v_mul_f32 v91, v91, v24
  v_mul_f32 v92, v92, v25
  v_mul_f32 v93, v93, v25
  v_mul_f32 v94, v94, v25
  v_mul_f32 v95, v95, v25
  v_mul_f32 v96, v96, v26
  v_mul_f32 v97, v97, v26
  v_mul_f32 v98, v98, v26
  v_mul_f32 v99, v99, v26
  v_mul_f32 v100, v100, v27
  v_mul_f32 v101, v101, v27
  v_mul_f32 v102, v102, v27
  v_mul_f32 v103, v103, v27
  v_cvt_pk_bf16_f32 v56, v88, v89
  v_cvt_pk_bf16_f32 v57, v90, v91
  v_cvt_pk_bf16_f32 v60, v92, v93
  v_cvt_pk_bf16_f32 v61, v94, v95
  v_cvt_pk_bf16_f32 v64, v96, v97
  v_cvt_pk_bf16_f32 v65, v98, v99
  v_cvt_pk_bf16_f32 v68, v100, v101
  v_cvt_pk_bf16_f32 v69, v102, v103
  s_add_u32 s31, s30, 0
  buffer_store_dwordx2 v[56:57], v1, s[44:47], s31 offen
  s_add_u32 s31, s30, 18432
  buffer_store_dwordx2 v[60:61], v1, s[44:47], s31 offen
  s_add_u32 s31, s30, 36864
  buffer_store_dwordx2 v[64:65], v1, s[44:47], s31 offen
  s_add_u32 s31, s30, 55296
  buffer_store_dwordx2 v[68:69], v1, s[44:47], s31 offen
k45_mlp_end:
  s_endpgm
k45_mlp_codeend:
.globl k6_red0_kernel
.p2align 8
.type k6_red0_kernel,@function
k6_red0_kernel:
  s_mov_b32 s34, 0x0
  s_branch k6_red_body
.globl k6_red1_kernel
.p2align 8
.type k6_red1_kernel,@function
k6_red1_kernel:
  s_mov_b32 s34, 0x3000000
  s_branch k6_red_body
.p2align 6
k6_red_body:
  s_cmp_ge_u32 s2, 256
  s_cbranch_scc1 k6_red_end
  s_load_dwordx2 s[4:5], s[0:1], 64
  s_load_dwordx2 s[6:7], s[0:1], 48
  v_lshrrev_b32 v1, 6, v0
  v_and_b32 v2, 63, v0
  s_nop 0
  v_readfirstlane_b32 s3, v1
  v_and_b32 v3, 7, v2
  v_lshrrev_b32 v4, 3, v0
  v_lshrrev_b32 v5, 2, v4
  v_and_b32 v6, 3, v4
  s_lshr_b32 s12, s2, 1
  s_and_b32 s13, s2, 1
  v_lshlrev_b32 v7, 10, v5
  v_lshlrev_b32 v8, 4, v6
  s_lshl_b32 s14, s13, 3
  v_add_u32 v8, s14, v8
  v_add_u32 v8, v8, v3
  v_lshlrev_b32 v8, 4, v8
  v_add_u32 v7, v7, v8
  s_mul_i32 s15, s12, 18432
  s_waitcnt lgkmcnt(0)
  s_add_u32 s44, s4, s34
  s_addc_u32 s45, s5, 0
  s_mov_b32 s46, 0x6000000
  s_mov_b32 s47, 0x20000
  s_add_u32 s16, s15, 61865984
  buffer_load_dwordx4 v[12:15], v7, s[44:47], s16 offen
  s_add_u32 s16, s15, 67108864
  buffer_load_dwordx4 v[16:19], v7, s[44:47], s16 offen
  s_add_u32 s16, s15, 69468160
  buffer_load_dwordx4 v[20:23], v7, s[44:47], s16 offen
  s_add_u32 s16, s15, 71827456
  buffer_load_dwordx4 v[24:27], v7, s[44:47], s16 offen
  s_add_u32 s16, s15, 74186752
  buffer_load_dwordx4 v[28:31], v7, s[44:47], s16 offen
  s_add_u32 s16, s15, 76546048
  buffer_load_dwordx4 v[32:35], v7, s[44:47], s16 offen
  s_add_u32 s16, s15, 78905344
  buffer_load_dwordx4 v[36:39], v7, s[44:47], s16 offen
  s_add_u32 s16, s15, 81264640
  buffer_load_dwordx4 v[40:43], v7, s[44:47], s16 offen
  s_add_u32 s16, s15, 83623936
  buffer_load_dwordx4 v[44:47], v7, s[44:47], s16 offen
  s_waitcnt vmcnt(8)
  v_lshlrev_b32 v48, 16, v12
  v_and_b32 v49, 0xffff0000, v12
  v_lshlrev_b32 v50, 16, v13
  v_and_b32 v51, 0xffff0000, v13
  v_lshlrev_b32 v52, 16, v14
  v_and_b32 v53, 0xffff0000, v14
  v_lshlrev_b32 v54, 16, v15
  v_and_b32 v55, 0xffff0000, v15
  s_waitcnt vmcnt(7)
  v_lshlrev_b32 v9, 16, v16
  v_and_b32 v10, 0xffff0000, v16
  v_add_f32 v48, v48, v9
  v_add_f32 v49, v49, v10
  v_lshlrev_b32 v9, 16, v17
  v_and_b32 v10, 0xffff0000, v17
  v_add_f32 v50, v50, v9
  v_add_f32 v51, v51, v10
  v_lshlrev_b32 v9, 16, v18
  v_and_b32 v10, 0xffff0000, v18
  v_add_f32 v52, v52, v9
  v_add_f32 v53, v53, v10
  v_lshlrev_b32 v9, 16, v19
  v_and_b32 v10, 0xffff0000, v19
  v_add_f32 v54, v54, v9
  v_add_f32 v55, v55, v10
  s_waitcnt vmcnt(6)
  v_lshlrev_b32 v9, 16, v20
  v_and_b32 v10, 0xffff0000, v20
  v_add_f32 v48, v48, v9
  v_add_f32 v49, v49, v10
  v_lshlrev_b32 v9, 16, v21
  v_and_b32 v10, 0xffff0000, v21
  v_add_f32 v50, v50, v9
  v_add_f32 v51, v51, v10
  v_lshlrev_b32 v9, 16, v22
  v_and_b32 v10, 0xffff0000, v22
  v_add_f32 v52, v52, v9
  v_add_f32 v53, v53, v10
  v_lshlrev_b32 v9, 16, v23
  v_and_b32 v10, 0xffff0000, v23
  v_add_f32 v54, v54, v9
  v_add_f32 v55, v55, v10
  s_waitcnt vmcnt(5)
  v_lshlrev_b32 v9, 16, v24
  v_and_b32 v10, 0xffff0000, v24
  v_add_f32 v48, v48, v9
  v_add_f32 v49, v49, v10
  v_lshlrev_b32 v9, 16, v25
  v_and_b32 v10, 0xffff0000, v25
  v_add_f32 v50, v50, v9
  v_add_f32 v51, v51, v10
  v_lshlrev_b32 v9, 16, v26
  v_and_b32 v10, 0xffff0000, v26
  v_add_f32 v52, v52, v9
  v_add_f32 v53, v53, v10
  v_lshlrev_b32 v9, 16, v27
  v_and_b32 v10, 0xffff0000, v27
  v_add_f32 v54, v54, v9
  v_add_f32 v55, v55, v10
  s_waitcnt vmcnt(4)
  v_lshlrev_b32 v9, 16, v28
  v_and_b32 v10, 0xffff0000, v28
  v_add_f32 v48, v48, v9
  v_add_f32 v49, v49, v10
  v_lshlrev_b32 v9, 16, v29
  v_and_b32 v10, 0xffff0000, v29
  v_add_f32 v50, v50, v9
  v_add_f32 v51, v51, v10
  v_lshlrev_b32 v9, 16, v30
  v_and_b32 v10, 0xffff0000, v30
  v_add_f32 v52, v52, v9
  v_add_f32 v53, v53, v10
  v_lshlrev_b32 v9, 16, v31
  v_and_b32 v10, 0xffff0000, v31
  v_add_f32 v54, v54, v9
  v_add_f32 v55, v55, v10
  s_waitcnt vmcnt(3)
  v_lshlrev_b32 v9, 16, v32
  v_and_b32 v10, 0xffff0000, v32
  v_add_f32 v48, v48, v9
  v_add_f32 v49, v49, v10
  v_lshlrev_b32 v9, 16, v33
  v_and_b32 v10, 0xffff0000, v33
  v_add_f32 v50, v50, v9
  v_add_f32 v51, v51, v10
  v_lshlrev_b32 v9, 16, v34
  v_and_b32 v10, 0xffff0000, v34
  v_add_f32 v52, v52, v9
  v_add_f32 v53, v53, v10
  v_lshlrev_b32 v9, 16, v35
  v_and_b32 v10, 0xffff0000, v35
  v_add_f32 v54, v54, v9
  v_add_f32 v55, v55, v10
  s_waitcnt vmcnt(2)
  v_lshlrev_b32 v9, 16, v36
  v_and_b32 v10, 0xffff0000, v36
  v_add_f32 v48, v48, v9
  v_add_f32 v49, v49, v10
  v_lshlrev_b32 v9, 16, v37
  v_and_b32 v10, 0xffff0000, v37
  v_add_f32 v50, v50, v9
  v_add_f32 v51, v51, v10
  v_lshlrev_b32 v9, 16, v38
  v_and_b32 v10, 0xffff0000, v38
  v_add_f32 v52, v52, v9
  v_add_f32 v53, v53, v10
  v_lshlrev_b32 v9, 16, v39
  v_and_b32 v10, 0xffff0000, v39
  v_add_f32 v54, v54, v9
  v_add_f32 v55, v55, v10
  s_waitcnt vmcnt(1)
  v_lshlrev_b32 v9, 16, v40
  v_and_b32 v10, 0xffff0000, v40
  v_add_f32 v48, v48, v9
  v_add_f32 v49, v49, v10
  v_lshlrev_b32 v9, 16, v41
  v_and_b32 v10, 0xffff0000, v41
  v_add_f32 v50, v50, v9
  v_add_f32 v51, v51, v10
  v_lshlrev_b32 v9, 16, v42
  v_and_b32 v10, 0xffff0000, v42
  v_add_f32 v52, v52, v9
  v_add_f32 v53, v53, v10
  v_lshlrev_b32 v9, 16, v43
  v_and_b32 v10, 0xffff0000, v43
  v_add_f32 v54, v54, v9
  v_add_f32 v55, v55, v10
  s_waitcnt vmcnt(0)
  v_lshlrev_b32 v9, 16, v44
  v_and_b32 v10, 0xffff0000, v44
  v_add_f32 v48, v48, v9
  v_add_f32 v49, v49, v10
  v_lshlrev_b32 v9, 16, v45
  v_and_b32 v10, 0xffff0000, v45
  v_add_f32 v50, v50, v9
  v_add_f32 v51, v51, v10
  v_lshlrev_b32 v9, 16, v46
  v_and_b32 v10, 0xffff0000, v46
  v_add_f32 v52, v52, v9
  v_add_f32 v53, v53, v10
  v_lshlrev_b32 v9, 16, v47
  v_and_b32 v10, 0xffff0000, v47
  v_add_f32 v54, v54, v9
  v_add_f32 v55, v55, v10
  v_cvt_pk_bf16_f32 v56, v48, v49
  v_cvt_pk_bf16_f32 v57, v50, v51
  v_cvt_pk_bf16_f32 v58, v52, v53
  v_cvt_pk_bf16_f32 v59, v54, v55
  s_cmp_eq_u32 s34, 0
  s_cbranch_scc1 k6_red_l0
  s_mov_b32 s20, s6
  s_mov_b32 s21, s7
  s_mov_b32 s22, 0x240000
  s_mov_b32 s23, 0x20000
  s_lshl_b32 s16, s12, 4
  s_add_u32 s16, s16, s14
  v_add_u32 v9, s16, v3
  v_mul_u32_u24 v9, 1152, v9
  v_lshlrev_b32 v10, 6, v5
  v_add_u32 v9, v9, v10
  v_and_b32 v10, 2, v6
  v_lshlrev_b32 v10, 3, v10
  v_add_u32 v9, v9, v10
  v_and_b32 v10, 1, v6
  v_cmp_eq_u32 vcc, 0, v10
  v_lshlrev_b32 v10, 5, v10
  v_add_u32 v9, v9, v10
  v_mov_b32_dpp v60, v56 row_ror:8 row_mask:0xf bank_mask:0xf
  v_mov_b32_dpp v61, v57 row_ror:8 row_mask:0xf bank_mask:0xf
  v_mov_b32_dpp v62, v58 row_ror:8 row_mask:0xf bank_mask:0xf
  v_mov_b32_dpp v63, v59 row_ror:8 row_mask:0xf bank_mask:0xf
  v_cndmask_b32 v12, v62, v56, vcc
  v_cndmask_b32 v13, v63, v57, vcc
  v_cndmask_b32 v14, v58, v60, vcc
  v_cndmask_b32 v15, v59, v61, vcc
  buffer_store_dwordx4 v[12:15], v9, s[20:23], 0 offen sc1
  s_branch k6_red_fin
k6_red_l0:
  s_add_u32 s16, s15, 88080384
  buffer_store_dwordx4 v[56:59], v7, s[44:47], s16 offen sc1
  v_lshlrev_b32 v48, 16, v56
  v_and_b32 v49, 0xffff0000, v56
  v_lshlrev_b32 v50, 16, v57
  v_and_b32 v51, 0xffff0000, v57
  v_lshlrev_b32 v52, 16, v58
  v_and_b32 v53, 0xffff0000, v58
  v_lshlrev_b32 v54, 16, v59
  v_and_b32 v55, 0xffff0000, v59
  v_add_f32 v30, v48, v49
  v_mul_f32 v31, v48, v48
  v_add_f32 v30, v30, v50
  v_add_f32 v30, v30, v51
  v_add_f32 v30, v30, v52
  v_add_f32 v30, v30, v53
  v_add_f32 v30, v30, v54
  v_add_f32 v30, v30, v55
  v_fmac_f32 v31, v49, v49
  v_fmac_f32 v31, v50, v50
  v_fmac_f32 v31, v51, v51
  v_fmac_f32 v31, v52, v52
  v_fmac_f32 v31, v53, v53
  v_fmac_f32 v31, v54, v54
  v_fmac_f32 v31, v55, v55
  s_nop 1
  v_add_f32_dpp v30, v30, v30 row_ror:8 row_mask:0xf bank_mask:0xf
  s_nop 1
  v_add_f32_dpp v31, v31, v31 row_ror:8 row_mask:0xf bank_mask:0xf
  v_mov_b32 v32, v30
  v_mov_b32 v33, v31
  s_nop 1
  v_permlane16_swap_b32 v30, v32
  v_permlane16_swap_b32 v31, v33
  s_nop 1
  v_add_f32 v30, v30, v32
  v_add_f32 v31, v31, v33
  v_mov_b32 v32, v30
  v_mov_b32 v33, v31
  s_nop 1
  v_permlane32_swap_b32 v30, v32
  v_permlane32_swap_b32 v31, v33
  s_nop 1
  v_add_f32 v30, v30, v32
  v_add_f32 v31, v31, v33
  s_lshl_b32 s17, s3, 6
  v_lshlrev_b32 v11, 3, v3
  v_add_u32 v9, s17, v11
  ds_write_b64 v9, v[30:31]
  s_waitcnt lgkmcnt(0)
  s_barrier
  ds_read_b64 v[12:13], v11 offset:0
  ds_read_b64 v[14:15], v11 offset:64
  ds_read_b64 v[16:17], v11 offset:128
  ds_read_b64 v[18:19], v11 offset:192
  ds_read_b64 v[20:21], v11 offset:256
  ds_read_b64 v[22:23], v11 offset:320
  ds_read_b64 v[24:25], v11 offset:384
  ds_read_b64 v[26:27], v11 offset:448
  ds_read_b64 v[28:29], v11 offset:512
  s_waitcnt lgkmcnt(0)
  v_add_f32 v30, v12, v14
  v_add_f32 v31, v13, v15
  v_add_f32 v30, v30, v16
  v_add_f32 v31, v31, v17
  v_add_f32 v30, v30, v18
  v_add_f32 v31, v31, v19
  v_add_f32 v30, v30, v20
  v_add_f32 v31, v31, v21
  v_add_f32 v30, v30, v22
  v_add_f32 v31, v31, v23
  v_add_f32 v30, v30, v24
  v_add_f32 v31, v31, v25
  v_add_f32 v30, v30, v26
  v_add_f32 v31, v31, v27
  v_add_f32 v30, v30, v28
  v_add_f32 v31, v31, v29
  v_mul_f32 v30, 0x3ae38e39, v30
  v_mul_f32 v31, 0x3ae38e39, v31
  v_fma_f32 v31, -v30, v30, v31
  v_max_f32 v31, 0, v31
  v_add_f32 v32, 0x3727c5ac, v31
  v_rsq_f32 v32, v32
  v_sub_f32 v48, v48, v30
  v_sub_f32 v49, v49, v30
  v_sub_f32 v50, v50, v30
  v_sub_f32 v51, v51, v30
  v_sub_f32 v52, v52, v30
  v_sub_f32 v53, v53, v30
  v_sub_f32 v54, v54, v30
  v_sub_f32 v55, v55, v30
  v_mul_f32 v48, v48, v32
  v_mul_f32 v49, v49, v32
  v_mul_f32 v50, v50, v32
  v_mul_f32 v51, v51, v32
  v_mul_f32 v52, v52, v32
  v_mul_f32 v53, v53, v32
  v_mul_f32 v54, v54, v32
  v_mul_f32 v55, v55, v32
  v_cvt_pk_bf16_f32 v60, v48, v49
  v_cvt_pk_bf16_f32 v61, v50, v51
  v_cvt_pk_bf16_f32 v62, v52, v53
  v_cvt_pk_bf16_f32 v63, v54, v55
  s_lshr_b32 s16, s12, 1
  s_mul_i32 s16, s16, 36864
  s_add_u32 s16, s16, 91226112
  s_and_b32 s17, s12, 1
  s_lshl_b32 s17, s17, 4
  s_add_u32 s17, s17, s14
  v_add_u32 v9, s17, v3
  v_and_b32 v10, 1, v6
  v_lshlrev_b32 v10, 5, v10
  v_add_u32 v9, v9, v10
  v_lshlrev_b32 v9, 4, v9
  v_lshrrev_b32 v10, 1, v6
  v_lshlrev_b32 v10, 10, v10
  v_add_u32 v9, v9, v10
  v_lshlrev_b32 v10, 11, v5
  v_add_u32 v9, v9, v10
  v_permlane16_swap_b32 v60, v62
  v_permlane16_swap_b32 v61, v63
  s_nop 0
  buffer_store_dwordx4 v[60:63], v9, s[44:47], s16 offen sc1
k6_red_fin:
k6_red_end:
  s_endpgm
k6_red_codeend:
.section .rodata,"a"
.p2align 6
.amdhsa_kernel k0_prep_kernel
  .amdhsa_next_free_vgpr 128
  .amdhsa_next_free_sgpr 64
  .amdhsa_accum_offset 128
  .amdhsa_group_segment_fixed_size 0
  .amdhsa_kernarg_size 72
  .amdhsa_user_sgpr_count 2
  .amdhsa_user_sgpr_kernarg_segment_ptr 1
  .amdhsa_system_sgpr_workgroup_id_x 1
  .amdhsa_float_denorm_mode_32 3
.end_amdhsa_kernel
.p2align 6
.amdhsa_kernel k1_qkv0_kernel
  .amdhsa_next_free_vgpr 512
  .amdhsa_next_free_sgpr 64
  .amdhsa_accum_offset 256
  .amdhsa_group_segment_fixed_size 0
  .amdhsa_kernarg_size 72
  .amdhsa_user_sgpr_count 2
  .amdhsa_user_sgpr_kernarg_segment_ptr 1
  .amdhsa_system_sgpr_workgroup_id_x 1
  .amdhsa_float_denorm_mode_32 3
.end_amdhsa_kernel
.p2align 6
.amdhsa_kernel k1_qkv1_kernel
  .amdhsa_next_free_vgpr 512
  .amdhsa_next_free_sgpr 64
  .amdhsa_accum_offset 256
  .amdhsa_group_segment_fixed_size 0
  .amdhsa_kernarg_size 72
  .amdhsa_user_sgpr_count 2
  .amdhsa_user_sgpr_kernarg_segment_ptr 1
  .amdhsa_system_sgpr_workgroup_id_x 1
  .amdhsa_float_denorm_mode_32 3
.end_amdhsa_kernel
.p2align 6
.amdhsa_kernel k2_attn0_kernel
  .amdhsa_next_free_vgpr 128
  .amdhsa_next_free_sgpr 64
  .amdhsa_accum_offset 128
  .amdhsa_group_segment_fixed_size 0
  .amdhsa_kernarg_size 72
  .amdhsa_user_sgpr_count 2
  .amdhsa_user_sgpr_kernarg_segment_ptr 1
  .amdhsa_system_sgpr_workgroup_id_x 1
  .amdhsa_float_denorm_mode_32 3
.end_amdhsa_kernel
.p2align 6
.amdhsa_kernel k2_attn1_kernel
  .amdhsa_next_free_vgpr 128
  .amdhsa_next_free_sgpr 64
  .amdhsa_accum_offset 128
  .amdhsa_group_segment_fixed_size 0
  .amdhsa_kernarg_size 72
  .amdhsa_user_sgpr_count 2
  .amdhsa_user_sgpr_kernarg_segment_ptr 1
  .amdhsa_system_sgpr_workgroup_id_x 1
  .amdhsa_float_denorm_mode_32 3
.end_amdhsa_kernel
.p2align 6
.amdhsa_kernel k3_wo0_kernel
  .amdhsa_next_free_vgpr 512
  .amdhsa_next_free_sgpr 64
  .amdhsa_accum_offset 256
  .amdhsa_group_segment_fixed_size 0
  .amdhsa_kernarg_size 72
  .amdhsa_user_sgpr_count 2
  .amdhsa_user_sgpr_kernarg_segment_ptr 1
  .amdhsa_system_sgpr_workgroup_id_x 1
  .amdhsa_float_denorm_mode_32 3
.end_amdhsa_kernel
.p2align 6
.amdhsa_kernel k3_wo1_kernel
  .amdhsa_next_free_vgpr 512
  .amdhsa_next_free_sgpr 64
  .amdhsa_accum_offset 256
  .amdhsa_group_segment_fixed_size 0
  .amdhsa_kernarg_size 72
  .amdhsa_user_sgpr_count 2
  .amdhsa_user_sgpr_kernarg_segment_ptr 1
  .amdhsa_system_sgpr_workgroup_id_x 1
  .amdhsa_float_denorm_mode_32 3
.end_amdhsa_kernel
.p2align 6
.amdhsa_kernel k45_mlp0_kernel
  .amdhsa_next_free_vgpr 512
  .amdhsa_next_free_sgpr 64
  .amdhsa_accum_offset 256
  .amdhsa_group_segment_fixed_size 0
  .amdhsa_kernarg_size 72
  .amdhsa_user_sgpr_count 2
  .amdhsa_user_sgpr_kernarg_segment_ptr 1
  .amdhsa_system_sgpr_workgroup_id_x 1
  .amdhsa_float_denorm_mode_32 3
.end_amdhsa_kernel
.p2align 6
.amdhsa_kernel k45_mlp1_kernel
  .amdhsa_next_free_vgpr 512
  .amdhsa_next_free_sgpr 64
  .amdhsa_accum_offset 256
  .amdhsa_group_segment_fixed_size 0
  .amdhsa_kernarg_size 72
  .amdhsa_user_sgpr_count 2
  .amdhsa_user_sgpr_kernarg_segment_ptr 1
  .amdhsa_system_sgpr_workgroup_id_x 1
  .amdhsa_float_denorm_mode_32 3
.end_amdhsa_kernel
.p2align 6
.amdhsa_kernel k6_red0_kernel
  .amdhsa_next_free_vgpr 64
  .amdhsa_next_free_sgpr 64
  .amdhsa_accum_offset 64
  .amdhsa_group_segment_fixed_size 0
  .amdhsa_kernarg_size 72
  .amdhsa_user_sgpr_count 2
  .amdhsa_user_sgpr_kernarg_segment_ptr 1
  .amdhsa_system_sgpr_workgroup_id_x 1
  .amdhsa_float_denorm_mode_32 3
.end_amdhsa_kernel
.p2align 6
.amdhsa_kernel k6_red1_kernel
  .amdhsa_next_free_vgpr 64
  .amdhsa_next_free_sgpr 64
  .amdhsa_accum_offset 64
  .amdhsa_group_segment_fixed_size 0
  .amdhsa_kernarg_size 72
  .amdhsa_user_sgpr_count 2
  .amdhsa_user_sgpr_kernarg_segment_ptr 1
  .amdhsa_system_sgpr_workgroup_id_x 1
  .amdhsa_float_denorm_mode_32 3
.end_amdhsa_kernel
```
